```python
import torch

def _softmax(x, axis=-1):
    return torch.softmax(x, dim=axis)
def _gelu(x):
    return torch.nn.functional.gelu(x, approximate="tanh")
def _silu(x):
    return torch.nn.functional.silu(x)
def _sigmoid(x):
    return torch.sigmoid(x)
def _layernorm(x, axis=-1, eps=1e-5):
    m = x.mean(dim=axis, keepdim=True)
    v = x.var(dim=axis, keepdim=True, unbiased=False)
    return (x - m) / torch.sqrt(v + eps)
def _scatter_add(tgt, idx, src, axis=0):
    return tgt.clone().index_add_(axis, idx, src)
def _segment_sum(src, seg, n):
    out = torch.zeros((n,) + src.shape[1:], dtype=src.dtype)
    return out.index_add_(0, seg, src)
def _pad(x, pw):
    flat = tuple(v for pair in reversed(pw) for v in pair)
    return torch.nn.functional.pad(x, flat)

kernel_name = 'concat_heads__gqa_block_cached__gqa_block_cached__near_ridge'

def setup_inputs():

    _w = (lambda a: (lambda t: t.to(torch.bfloat16) if t.is_floating_point() else t)(torch.as_tensor(a)))
    def _A_setup():
        B, Sq, D = 8, 192, 640
        Hq, Hkv, Sk, Dh = 32, 32, 1024, 128
        assert Hq % Hkv == 0, (Hq, Hkv)
        return {
            "x": _w((lambda *s: torch.randn(*s, dtype=torch.bfloat16) * 0.8)(B, Sq, D)),
            "k_cache": _w((lambda *s: torch.randn(*s, dtype=torch.bfloat16) * 0.8)(B, Hkv, Sk, Dh)),
            "v_cache": _w((lambda *s: torch.randn(*s, dtype=torch.bfloat16) * 0.05)(B, Hkv, Sk, Dh)),
            "wq": _w((lambda *s: torch.randn(*s, dtype=torch.bfloat16) * 0.8)(D, Hq * Dh) * (D ** -0.5)),
            "wo": _w((lambda *s: torch.randn(*s, dtype=torch.bfloat16) * 0.05)(Hq * Dh, D) * ((Hq * Dh) ** -0.5)),
        }
    _A_in = _A_setup()

    def _B_setup():
        B, Sq, D = 8, 192, 640
        Hq, Hkv, Sk, Dh = 32, 32, 1024, 128
        assert Hq % Hkv == 0, (Hq, Hkv)
        return {
            "x": _w((lambda *s: torch.randn(*s, dtype=torch.bfloat16) * 0.8)(B, Sq, D)),
            "k_cache": _w((lambda *s: torch.randn(*s, dtype=torch.bfloat16) * 0.8)(B, Hkv, Sk, Dh)),
            "v_cache": _w((lambda *s: torch.randn(*s, dtype=torch.bfloat16) * 0.05)(B, Hkv, Sk, Dh)),
            "wq": _w((lambda *s: torch.randn(*s, dtype=torch.bfloat16) * 0.8)(D, Hq * Dh) * (D ** -0.5)),
            "wo": _w((lambda *s: torch.randn(*s, dtype=torch.bfloat16) * 0.05)(Hq * Dh, D) * ((Hq * Dh) ** -0.5)),
        }
    _B_in = _B_setup()

    return {
        "A_x": _A_in["x"],
        "A_k_cache": _A_in["k_cache"],
        "A_v_cache": _A_in["v_cache"],
        "A_wq": _A_in["wq"],
        "A_wo": _A_in["wo"],
        "B_x": _B_in["x"],
        "B_k_cache": _B_in["k_cache"],
        "B_v_cache": _B_in["v_cache"],
        "B_wq": _B_in["wq"],
        "B_wo": _B_in["wo"],
    }

def reference(A_x, A_k_cache, A_v_cache, A_wq, A_wo, B_x, B_k_cache, B_v_cache, B_wq, B_wo):
    def _A_ref(x, k_cache, v_cache, wq, wo):
        B, Sq, D = x.shape
        Hq, Dh = 32, 128
        Hkv = k_cache.shape[1]
        rep = Hq // Hkv
        q = (lambda x, *d: x.permute(*d))((x @ wq).reshape(B, Sq, Hq, Dh), 0, 2, 1, 3)
        k = (lambda x, n, axis: torch.repeat_interleave(x, n, dim=axis))(k_cache, rep, axis=1)
        v = (lambda x, n, axis: torch.repeat_interleave(x, n, dim=axis))(v_cache, rep, axis=1)
        scores = torch.einsum("bhqd,bhkd->bhqk", q, k) * (Dh ** -0.5)
        p = _softmax(scores, axis=-1)
        o = torch.einsum("bhqk,bhkd->bhqd", p, v)
        return (lambda x, *d: x.permute(*d))(o, 0, 2, 1, 3).reshape(B, Sq, Hq * Dh) @ wo

    def _B_ref(x, k_cache, v_cache, wq, wo):
        B, Sq, D = x.shape
        Hq, Dh = 32, 128
        Hkv = k_cache.shape[1]
        rep = Hq // Hkv
        q = (lambda x, *d: x.permute(*d))((x @ wq).reshape(B, Sq, Hq, Dh), 0, 2, 1, 3)
        k = (lambda x, n, axis: torch.repeat_interleave(x, n, dim=axis))(k_cache, rep, axis=1)
        v = (lambda x, n, axis: torch.repeat_interleave(x, n, dim=axis))(v_cache, rep, axis=1)
        scores = torch.einsum("bhqd,bhkd->bhqk", q, k) * (Dh ** -0.5)
        p = _softmax(scores, axis=-1)
        o = torch.einsum("bhqk,bhkd->bhqd", p, v)
        return (lambda x, *d: x.permute(*d))(o, 0, 2, 1, 3).reshape(B, Sq, Hq * Dh) @ wo

    a = _A_ref(A_x, A_k_cache, A_v_cache, A_wq, A_wo)
    b = _B_ref(B_x, B_k_cache, B_v_cache, B_wq, B_wo)
    return torch.concatenate([a, b], axis=-1)
```

```asm
; @launch kernel=concat_heads__gqa_block_cached__gqa_block_cached__near_ridge_kernel grid=(512,1,1) block=(256,1,1) lds=81920
; @launch kernel=oproj_kernel grid=(256,1,1) block=(256,1,1) lds=122880
.amdgcn_target "amdgcn-amd-amdhsa--gfx950"
.text
.globl concat_heads__gqa_block_cached__gqa_block_cached__near_ridge_kernel
.p2align 8
.type concat_heads__gqa_block_cached__gqa_block_cached__near_ridge_kernel,@function
concat_heads__gqa_block_cached__gqa_block_cached__near_ridge_kernel:
    s_cmp_ge_u32 s2, 512
    s_cbranch_scc1 K1_end
    s_load_dwordx8 s[36:43], s[0:1], 0
    s_load_dwordx8 s[44:51], s[0:1], 40
    s_load_dwordx2 s[52:53], s[0:1], 96
    s_load_dwordx2 s[80:81], s[0:1], 32
    s_load_dwordx2 s[82:83], s[0:1], 72
    v_lshrrev_b32 v1, 6, v0
    v_and_b32 v0, 63, v0
    v_readfirstlane_b32 s24, v1
    s_and_b32 s31, s2, 7
    s_lshr_b32 s32, s2, 3
    s_lshr_b32 s33, s31, 2
    s_and_b32 s34, s31, 2
    s_lshl_b32 s34, s34, 1
    s_and_b32 s54, s32, 3
    s_add_u32 s34, s34, s54
    s_and_b32 s35, s31, 1
    s_lshl_b32 s35, s35, 4
    s_lshr_b32 s54, s32, 2
    s_add_u32 s35, s35, s54
    s_mul_i32 s27, s32, 1
    s_mul_i32 s54, s31, 0
    s_add_u32 s27, s27, s54
    s_and_b32 s27, s27, 31
    s_lshl_b32 s27, s27, 13
    s_setprio 0
    s_cmp_lt_u32 s2, 256
    s_cbranch_scc0 K1_pr0
    s_setprio 1
K1_pr0:
    v_and_b32 v1, 15, v0
    v_lshrrev_b32 v2, 4, v0
    v_lshlrev_b32 v255, 4, v0
    s_lshr_b32 s57, s24, 1
    s_and_b32 s58, s24, 1
    s_lshl_b32 s56, s24, 11
    v_lshrrev_b32 v3, 1, v1
    v_xor_b32 v3, v3, v2
    v_lshlrev_b32 v3, 5, v3
    v_and_b32 v4, 1, v1
    v_lshl_add_u32 v3, v4, 4, v3
    v_lshl_add_u32 v216, v2, 13, v3
    v_xor_b32 v217, 128, v216
    s_mul_i32 s28, s57, 40960
    s_lshl_b32 s54, s58, 12
    s_add_u32 s59, s28, s54
    s_lshl_b32 s55, s24, 17
    s_mul_i32 s54, s24, 48
    v_lshrrev_b32 v3, 3, v0
    v_add_u32 v3, s54, v3
    v_mul_u32_u24 v3, 1280, v3
    v_and_b32 v4, 7, v0
    v_xor_b32 v4, v4, v2
    v_lshl_add_u32 v220, v4, 4, v3
    v_xor_b32 v4, 4, v4
    v_lshl_add_u32 v4, v4, 4, v3
    v_add_u32 v221, 9216, v4
    s_lshl_b32 s29, s58, 13
    s_add_u32 s29, s29, s28
    s_add_u32 s29, s29, 24576
    s_waitcnt lgkmcnt(0)
    s_cmp_eq_u32 s33, 0
    s_cselect_b32 s4, s36, s44
    s_cselect_b32 s5, s37, s45
    s_cselect_b32 s12, s38, s46
    s_cselect_b32 s13, s39, s47
    s_cselect_b32 s16, s40, s48
    s_cselect_b32 s17, s41, s49
    s_cselect_b32 s8, s42, s50
    s_cselect_b32 s9, s43, s51
    s_lshl_b32 s54, s35, 8
    s_add_u32 s8, s8, s54
    s_addc_u32 s9, s9, 0
    s_sub_u32 s10, 5242880, s54
    s_mov_b32 s11, 0x20000
    s_mul_i32 s54, s34, 245760
    s_add_u32 s4, s4, s54
    s_addc_u32 s5, s5, 0
    s_mov_b32 s6, 245760
    s_mov_b32 s7, 0x20000
    s_cmp_ge_u32 s2, 256
    s_cbranch_scc1 K1_wpt
    s_bitcmp0_b32 s2, 7
    s_cselect_b32 s84, s80, s82
    s_cselect_b32 s85, s81, s83
    s_mov_b32 s86, 5242880
    s_mov_b32 s87, 0x20000
    s_and_b32 s92, s2, 127
    s_mul_i32 s93, s92, 40960
    s_mul_i32 s94, s24, 10240
    s_add_u32 s93, s93, s94
    v_lshlrev_b32 v204, 3, v255
    buffer_load_dword v205, v204, s[84:87], s93 offen
    buffer_load_dword v206, v204, s[84:87], s93 offen offset:2048
K1_wpt:
    s_add_u32 m0, s59, 16384
    s_add_u32 s54, s55, 0
    buffer_load_dwordx4 v216, s[8:11], s54 offen offset:0 lds
    s_add_u32 s54, s55, 31744
    buffer_load_dwordx4 v216, s[8:11], s54 offen offset:1024 lds
    s_add_u32 s54, s55, 63488
    buffer_load_dwordx4 v217, s[8:11], s54 offen offset:2048 lds
    s_add_u32 s54, s55, 95232
    buffer_load_dwordx4 v217, s[8:11], s54 offen offset:3072 lds
    s_add_u32 m0, s29, 0
    s_mov_b32 s30, 0
    buffer_load_dwordx4 v220, s[4:7], s30 offen lds
    buffer_load_dwordx4 v221, s[4:7], s30 offen offset:1024 lds
    s_add_u32 m0, s29, 2048
    s_mov_b32 s30, 20480
    buffer_load_dwordx4 v220, s[4:7], s30 offen lds
    buffer_load_dwordx4 v221, s[4:7], s30 offen offset:1024 lds
    s_add_u32 m0, s29, 4096
    s_mov_b32 s30, 40960
    buffer_load_dwordx4 v220, s[4:7], s30 offen lds
    buffer_load_dwordx4 v221, s[4:7], s30 offen offset:1024 lds
    s_add_u32 m0, s29, 6144
    s_mov_b32 s30, 128
    buffer_load_dwordx4 v220, s[4:7], s30 offen lds
    buffer_load_dwordx4 v221, s[4:7], s30 offen offset:1024 lds
    s_add_u32 m0, s59, 0
    s_add_u32 s54, s55, 524288
    buffer_load_dwordx4 v216, s[8:11], s54 offen offset:0 lds
    s_add_u32 s54, s55, 556032
    buffer_load_dwordx4 v216, s[8:11], s54 offen offset:1024 lds
    s_add_u32 s54, s55, 587776
    buffer_load_dwordx4 v217, s[8:11], s54 offen offset:2048 lds
    s_add_u32 s54, s55, 619520
    buffer_load_dwordx4 v217, s[8:11], s54 offen offset:3072 lds
    s_lshl_b32 s54, s34, 5
    s_add_u32 s54, s54, s35
    s_lshl_b32 s54, s54, 18
    s_add_u32 s12, s12, s54
    s_addc_u32 s13, s13, 0
    s_mov_b32 s14, 262144
    s_mov_b32 s15, 0x20000
    s_add_u32 s16, s16, s54
    s_addc_u32 s17, s17, 0
    s_mov_b32 s18, 262144
    s_mov_b32 s19, 0x20000
    s_lshl_b32 s54, s33, 3
    s_add_u32 s54, s54, s34
    s_mul_i32 s54, s54, 1572864
    s_mul_i32 s30, s24, 393216
    s_add_u32 s54, s54, s30
    s_lshl_b32 s30, s35, 12
    s_add_u32 s54, s54, s30
    s_add_u32 s20, s52, s54
    s_addc_u32 s21, s53, 0
    s_mov_b32 s22, 266240
    s_mov_b32 s23, 0x20000
    v_lshrrev_b32 v3, 1, v1
    v_xor_b32 v3, v3, v2
    v_lshlrev_b32 v3, 4, v3
    v_lshl_add_u32 v3, v1, 7, v3
    v_add_u32 v222, s29, v3
    v_xor_b32 v223, 64, v222
    v_lshrrev_b32 v3, 2, v1
    v_and_b32 v5, 3, v1
    v_lshl_add_u32 v4, v2, 3, v3
    v_and_b32 v6, 1, v2
    v_lshl_add_u32 v6, v6, 2, v3
    v_lshlrev_b32 v6, 5, v6
    v_lshl_add_u32 v6, v4, 8, v6
    v_lshl_add_u32 v208, v5, 3, v6
    v_xor_b32 v209, 32, v208
    v_xor_b32 v210, 64, v208
    v_xor_b32 v211, 96, v208
    v_xor_b32 v212, 128, v208
    v_xor_b32 v213, 160, v208
    v_xor_b32 v214, 192, v208
    v_xor_b32 v215, 224, v208
    v_bfe_u32 v4, v0, 3, 2
    v_and_b32 v6, 1, v2
    v_lshlrev_b32 v6, 1, v6
    v_and_b32 v7, 7, v0
    v_xor_b32 v6, v6, v7
    v_lshlrev_b32 v6, 4, v6
    v_lshl_add_u32 v6, v4, 8, v6
    v_lshrrev_b32 v7, 5, v0
    v_lshl_add_u32 v6, v7, 7, v6
    v_add_u32 v248, s56, v6
    v_xor_b32 v249, 64, v248
    v_and_b32 v6, 6, v1
    v_xor_b32 v6, v6, v2
    v_lshlrev_b32 v6, 4, v6
    v_lshl_add_u32 v6, v5, 7, v6
    v_lshl_add_u32 v242, v3, 10, v6
    v_xor_b32 v243, 64, v242
    v_lshl_add_u32 v4, v2, 2, v3
    v_and_b32 v6, 6, v4
    v_lshrrev_b32 v7, 1, v5
    v_xor_b32 v6, v6, v7
    v_lshlrev_b32 v6, 4, v6
    v_lshl_add_u32 v6, v3, 7, v6
    v_lshl_add_u32 v6, v2, 10, v6
    v_and_b32 v7, 1, v1
    v_lshl_add_u32 v6, v7, 3, v6
    v_add_u32 v244, 40960, v6
    v_xor_b32 v245, 32, v244
    v_xor_b32 v246, 64, v244
    v_xor_b32 v247, 96, v244
    s_waitcnt vmcnt(10)
    ds_read_b128 v[96:99], v222 offset:0
    ds_read_b128 v[108:111], v223 offset:0
    s_waitcnt vmcnt(8)
    ds_read_b128 v[100:103], v222 offset:2048
    ds_read_b128 v[112:115], v223 offset:2048
    s_waitcnt vmcnt(6)
    ds_read_b128 v[104:107], v222 offset:4096
    ds_read_b128 v[116:119], v223 offset:4096
    s_waitcnt lgkmcnt(0)
    s_add_u32 m0, s29, 0
    s_mov_b32 s30, 20608
    buffer_load_dwordx4 v220, s[4:7], s30 offen lds
    buffer_load_dwordx4 v221, s[4:7], s30 offen offset:1024 lds
    s_add_u32 m0, s29, 2048
    s_mov_b32 s30, 41088
    buffer_load_dwordx4 v220, s[4:7], s30 offen lds
    buffer_load_dwordx4 v221, s[4:7], s30 offen offset:1024 lds
    s_add_u32 m0, s29, 4096
    s_mov_b32 s30, 256
    buffer_load_dwordx4 v220, s[4:7], s30 offen lds
    buffer_load_dwordx4 v221, s[4:7], s30 offen offset:1024 lds
    s_add_u32 m0, s59, 8192
    s_add_u32 s54, s55, 1048576
    buffer_load_dwordx4 v216, s[8:11], s54 offen offset:0 lds
    s_add_u32 s54, s55, 1080320
    buffer_load_dwordx4 v216, s[8:11], s54 offen offset:1024 lds
    s_add_u32 s54, s55, 1112064
    buffer_load_dwordx4 v217, s[8:11], s54 offen offset:2048 lds
    s_add_u32 s54, s55, 1143808
    buffer_load_dwordx4 v217, s[8:11], s54 offen offset:3072 lds
    s_barrier
    ds_read_b64_tr_b16 v[176:177], v208 offset:16384
    ds_read_b64_tr_b16 v[178:179], v208 offset:17408
    ds_read_b64_tr_b16 v[180:181], v209 offset:16384
    ds_read_b64_tr_b16 v[182:183], v209 offset:17408
    ds_read_b64_tr_b16 v[184:185], v210 offset:16384
    ds_read_b64_tr_b16 v[186:187], v210 offset:17408
    ds_read_b64_tr_b16 v[188:189], v211 offset:16384
    ds_read_b64_tr_b16 v[190:191], v211 offset:17408
    ds_read_b64_tr_b16 v[192:193], v212 offset:16384
    ds_read_b64_tr_b16 v[194:195], v212 offset:17408
    ds_read_b64_tr_b16 v[196:197], v213 offset:16384
    ds_read_b64_tr_b16 v[198:199], v213 offset:17408
    s_waitcnt lgkmcnt(10)
    v_mfma_f32_16x16x32_bf16 v[0:3], v[176:179], v[96:99], 0
    ds_read_b64_tr_b16 v[200:201], v214 offset:16384
    v_mfma_f32_16x16x32_bf16 v[4:7], v[176:179], v[100:103], 0
    ds_read_b64_tr_b16 v[202:203], v214 offset:17408
    v_mfma_f32_16x16x32_bf16 v[8:11], v[176:179], v[104:107], 0
    s_waitcnt lgkmcnt(10)
    v_mfma_f32_16x16x32_bf16 v[12:15], v[180:183], v[96:99], 0
    s_waitcnt vmcnt(14)
    ds_read_b128 v[120:123], v222 offset:6144
    ds_read_b128 v[132:135], v223 offset:6144
    v_mfma_f32_16x16x32_bf16 v[16:19], v[180:183], v[100:103], 0
    ds_read_b64_tr_b16 v[204:205], v215 offset:16384
    v_mfma_f32_16x16x32_bf16 v[20:23], v[180:183], v[104:107], 0
    ds_read_b64_tr_b16 v[206:207], v215 offset:17408
    s_waitcnt lgkmcnt(12)
    v_mfma_f32_16x16x32_bf16 v[24:27], v[184:187], v[96:99], 0
    ds_read_b64_tr_b16 v[176:177], v208 offset:57344
    v_mfma_f32_16x16x32_bf16 v[28:31], v[184:187], v[100:103], 0
    ds_read_b64_tr_b16 v[178:179], v208 offset:58368
    v_mfma_f32_16x16x32_bf16 v[32:35], v[184:187], v[104:107], 0
    s_waitcnt lgkmcnt(12)
    v_mfma_f32_16x16x32_bf16 v[36:39], v[188:191], v[96:99], 0
    ds_read_b64_tr_b16 v[180:181], v209 offset:57344
    v_mfma_f32_16x16x32_bf16 v[40:43], v[188:191], v[100:103], 0
    ds_read_b64_tr_b16 v[182:183], v209 offset:58368
    v_mfma_f32_16x16x32_bf16 v[44:47], v[188:191], v[104:107], 0
    s_waitcnt lgkmcnt(6)
    s_add_u32 m0, s29, 6144
    s_mov_b32 s30, 20736
    buffer_load_dwordx4 v220, s[4:7], s30 offen lds
    buffer_load_dwordx4 v221, s[4:7], s30 offen offset:1024 lds
    v_mfma_f32_16x16x32_bf16 v[48:51], v[192:195], v[96:99], 0
    s_waitcnt vmcnt(10)
    ds_read_b128 v[124:127], v222 offset:0
    ds_read_b128 v[136:139], v223 offset:0
    v_mfma_f32_16x16x32_bf16 v[52:55], v[192:195], v[100:103], 0
    ds_read_b64_tr_b16 v[184:185], v210 offset:57344
    v_mfma_f32_16x16x32_bf16 v[56:59], v[192:195], v[104:107], 0
    ds_read_b64_tr_b16 v[186:187], v210 offset:58368
    v_mfma_f32_16x16x32_bf16 v[60:63], v[196:199], v[96:99], 0
    ds_read_b64_tr_b16 v[188:189], v211 offset:57344
    v_mfma_f32_16x16x32_bf16 v[64:67], v[196:199], v[100:103], 0
    ds_read_b64_tr_b16 v[190:191], v211 offset:58368
    v_mfma_f32_16x16x32_bf16 v[68:71], v[196:199], v[104:107], 0
    v_mfma_f32_16x16x32_bf16 v[72:75], v[200:203], v[96:99], 0
    ds_read_b64_tr_b16 v[192:193], v212 offset:57344
    v_mfma_f32_16x16x32_bf16 v[76:79], v[200:203], v[100:103], 0
    ds_read_b64_tr_b16 v[194:195], v212 offset:58368
    v_mfma_f32_16x16x32_bf16 v[80:83], v[200:203], v[104:107], 0
    s_waitcnt lgkmcnt(6)
    s_add_u32 m0, s29, 0
    s_mov_b32 s30, 41216
    buffer_load_dwordx4 v220, s[4:7], s30 offen lds
    buffer_load_dwordx4 v221, s[4:7], s30 offen offset:1024 lds
    v_mfma_f32_16x16x32_bf16 v[84:87], v[204:207], v[96:99], 0
    s_waitcnt vmcnt(10)
    ds_read_b128 v[128:131], v222 offset:2048
    ds_read_b128 v[140:143], v223 offset:2048
    v_mfma_f32_16x16x32_bf16 v[88:91], v[204:207], v[100:103], 0
    ds_read_b64_tr_b16 v[196:197], v213 offset:57344
    v_mfma_f32_16x16x32_bf16 v[92:95], v[204:207], v[104:107], 0
    ds_read_b64_tr_b16 v[198:199], v213 offset:58368
    v_mfma_f32_16x16x32_bf16 v[0:3], v[176:179], v[108:111], v[0:3]
    ds_read_b64_tr_b16 v[200:201], v214 offset:57344
    v_mfma_f32_16x16x32_bf16 v[4:7], v[176:179], v[112:115], v[4:7]
    ds_read_b64_tr_b16 v[202:203], v214 offset:58368
    v_mfma_f32_16x16x32_bf16 v[8:11], v[176:179], v[116:119], v[8:11]
    v_mfma_f32_16x16x32_bf16 v[12:15], v[180:183], v[108:111], v[12:15]
    ds_read_b64_tr_b16 v[204:205], v215 offset:57344
    v_mfma_f32_16x16x32_bf16 v[16:19], v[180:183], v[112:115], v[16:19]
    ds_read_b64_tr_b16 v[206:207], v215 offset:58368
    v_mfma_f32_16x16x32_bf16 v[20:23], v[180:183], v[116:119], v[20:23]
    s_waitcnt lgkmcnt(6)
    s_add_u32 m0, s29, 2048
    s_mov_b32 s30, 384
    buffer_load_dwordx4 v220, s[4:7], s30 offen lds
    buffer_load_dwordx4 v221, s[4:7], s30 offen offset:1024 lds
    v_mfma_f32_16x16x32_bf16 v[24:27], v[184:187], v[108:111], v[24:27]
    v_mfma_f32_16x16x32_bf16 v[28:31], v[184:187], v[112:115], v[28:31]
    v_mfma_f32_16x16x32_bf16 v[32:35], v[184:187], v[116:119], v[32:35]
    v_mfma_f32_16x16x32_bf16 v[36:39], v[188:191], v[108:111], v[36:39]
    v_mfma_f32_16x16x32_bf16 v[40:43], v[188:191], v[112:115], v[40:43]
    v_mfma_f32_16x16x32_bf16 v[44:47], v[188:191], v[116:119], v[44:47]
    s_waitcnt lgkmcnt(0)
    s_barrier
    v_mfma_f32_16x16x32_bf16 v[48:51], v[192:195], v[108:111], v[48:51]
    ds_read_b64_tr_b16 v[176:177], v208 offset:0
    ds_read_b64_tr_b16 v[178:179], v208 offset:1024
    v_mfma_f32_16x16x32_bf16 v[52:55], v[192:195], v[112:115], v[52:55]
    ds_read_b64_tr_b16 v[180:181], v209 offset:0
    ds_read_b64_tr_b16 v[182:183], v209 offset:1024
    v_mfma_f32_16x16x32_bf16 v[56:59], v[192:195], v[116:119], v[56:59]
    s_add_u32 m0, s59, 16384
    s_add_u32 s54, s55, 1572864
    buffer_load_dwordx4 v216, s[8:11], s54 offen offset:0 lds
    v_mfma_f32_16x16x32_bf16 v[60:63], v[196:199], v[108:111], v[60:63]
    ds_read_b64_tr_b16 v[184:185], v210 offset:0
    ds_read_b64_tr_b16 v[186:187], v210 offset:1024
    v_mfma_f32_16x16x32_bf16 v[64:67], v[196:199], v[112:115], v[64:67]
    ds_read_b64_tr_b16 v[188:189], v211 offset:0
    ds_read_b64_tr_b16 v[190:191], v211 offset:1024
    v_mfma_f32_16x16x32_bf16 v[68:71], v[196:199], v[116:119], v[68:71]
    s_add_u32 s54, s55, 1604608
    buffer_load_dwordx4 v216, s[8:11], s54 offen offset:1024 lds
    v_mfma_f32_16x16x32_bf16 v[72:75], v[200:203], v[108:111], v[72:75]
    ds_read_b64_tr_b16 v[192:193], v212 offset:0
    v_mfma_f32_16x16x32_bf16 v[76:79], v[200:203], v[112:115], v[76:79]
    ds_read_b64_tr_b16 v[194:195], v212 offset:1024
    v_mfma_f32_16x16x32_bf16 v[80:83], v[200:203], v[116:119], v[80:83]
    s_add_u32 s54, s55, 1636352
    buffer_load_dwordx4 v217, s[8:11], s54 offen offset:2048 lds
    v_mfma_f32_16x16x32_bf16 v[84:87], v[204:207], v[108:111], v[84:87]
    ds_read_b64_tr_b16 v[196:197], v213 offset:0
    v_mfma_f32_16x16x32_bf16 v[88:91], v[204:207], v[112:115], v[88:91]
    ds_read_b64_tr_b16 v[198:199], v213 offset:1024
    v_mfma_f32_16x16x32_bf16 v[92:95], v[204:207], v[116:119], v[92:95]
    s_add_u32 s54, s55, 1668096
    buffer_load_dwordx4 v217, s[8:11], s54 offen offset:3072 lds
    s_waitcnt lgkmcnt(10)
    v_mfma_f32_16x16x32_bf16 v[0:3], v[176:179], v[120:123], v[0:3]
    ds_read_b64_tr_b16 v[200:201], v214 offset:0
    v_mfma_f32_16x16x32_bf16 v[4:7], v[176:179], v[124:127], v[4:7]
    ds_read_b64_tr_b16 v[202:203], v214 offset:1024
    v_mfma_f32_16x16x32_bf16 v[8:11], v[176:179], v[128:131], v[8:11]
    s_waitcnt lgkmcnt(10)
    v_mfma_f32_16x16x32_bf16 v[12:15], v[180:183], v[120:123], v[12:15]
    s_waitcnt vmcnt(14)
    ds_read_b128 v[96:99], v222 offset:4096
    ds_read_b128 v[108:111], v223 offset:4096
    v_mfma_f32_16x16x32_bf16 v[16:19], v[180:183], v[124:127], v[16:19]
    ds_read_b64_tr_b16 v[204:205], v215 offset:0
    v_mfma_f32_16x16x32_bf16 v[20:23], v[180:183], v[128:131], v[20:23]
    ds_read_b64_tr_b16 v[206:207], v215 offset:1024
    s_waitcnt lgkmcnt(12)
    v_mfma_f32_16x16x32_bf16 v[24:27], v[184:187], v[120:123], v[24:27]
    ds_read_b64_tr_b16 v[176:177], v208 offset:40960
    v_mfma_f32_16x16x32_bf16 v[28:31], v[184:187], v[124:127], v[28:31]
    ds_read_b64_tr_b16 v[178:179], v208 offset:41984
    v_mfma_f32_16x16x32_bf16 v[32:35], v[184:187], v[128:131], v[32:35]
    s_waitcnt lgkmcnt(12)
    v_mfma_f32_16x16x32_bf16 v[36:39], v[188:191], v[120:123], v[36:39]
    ds_read_b64_tr_b16 v[180:181], v209 offset:40960
    v_mfma_f32_16x16x32_bf16 v[40:43], v[188:191], v[124:127], v[40:43]
    ds_read_b64_tr_b16 v[182:183], v209 offset:41984
    v_mfma_f32_16x16x32_bf16 v[44:47], v[188:191], v[128:131], v[44:47]
    s_waitcnt lgkmcnt(6)
    s_add_u32 m0, s29, 4096
    s_mov_b32 s30, 20864
    buffer_load_dwordx4 v220, s[4:7], s30 offen lds
    buffer_load_dwordx4 v221, s[4:7], s30 offen offset:1024 lds
    v_mfma_f32_16x16x32_bf16 v[48:51], v[192:195], v[120:123], v[48:51]
    s_waitcnt vmcnt(10)
    ds_read_b128 v[100:103], v222 offset:6144
    ds_read_b128 v[112:115], v223 offset:6144
    v_mfma_f32_16x16x32_bf16 v[52:55], v[192:195], v[124:127], v[52:55]
    ds_read_b64_tr_b16 v[184:185], v210 offset:40960
    v_mfma_f32_16x16x32_bf16 v[56:59], v[192:195], v[128:131], v[56:59]
    ds_read_b64_tr_b16 v[186:187], v210 offset:41984
    v_mfma_f32_16x16x32_bf16 v[60:63], v[196:199], v[120:123], v[60:63]
    ds_read_b64_tr_b16 v[188:189], v211 offset:40960
    v_mfma_f32_16x16x32_bf16 v[64:67], v[196:199], v[124:127], v[64:67]
    ds_read_b64_tr_b16 v[190:191], v211 offset:41984
    v_mfma_f32_16x16x32_bf16 v[68:71], v[196:199], v[128:131], v[68:71]
    v_mfma_f32_16x16x32_bf16 v[72:75], v[200:203], v[120:123], v[72:75]
    ds_read_b64_tr_b16 v[192:193], v212 offset:40960
    v_mfma_f32_16x16x32_bf16 v[76:79], v[200:203], v[124:127], v[76:79]
    ds_read_b64_tr_b16 v[194:195], v212 offset:41984
    v_mfma_f32_16x16x32_bf16 v[80:83], v[200:203], v[128:131], v[80:83]
    s_waitcnt lgkmcnt(6)
    s_add_u32 m0, s29, 6144
    s_mov_b32 s30, 41344
    buffer_load_dwordx4 v220, s[4:7], s30 offen lds
    buffer_load_dwordx4 v221, s[4:7], s30 offen offset:1024 lds
    v_mfma_f32_16x16x32_bf16 v[84:87], v[204:207], v[120:123], v[84:87]
    s_waitcnt vmcnt(10)
    ds_read_b128 v[104:107], v222 offset:0
    ds_read_b128 v[116:119], v223 offset:0
    v_mfma_f32_16x16x32_bf16 v[88:91], v[204:207], v[124:127], v[88:91]
    ds_read_b64_tr_b16 v[196:197], v213 offset:40960
    v_mfma_f32_16x16x32_bf16 v[92:95], v[204:207], v[128:131], v[92:95]
    ds_read_b64_tr_b16 v[198:199], v213 offset:41984
    v_mfma_f32_16x16x32_bf16 v[0:3], v[176:179], v[132:135], v[0:3]
    ds_read_b64_tr_b16 v[200:201], v214 offset:40960
    v_mfma_f32_16x16x32_bf16 v[4:7], v[176:179], v[136:139], v[4:7]
    ds_read_b64_tr_b16 v[202:203], v214 offset:41984
    v_mfma_f32_16x16x32_bf16 v[8:11], v[176:179], v[140:143], v[8:11]
    v_mfma_f32_16x16x32_bf16 v[12:15], v[180:183], v[132:135], v[12:15]
    ds_read_b64_tr_b16 v[204:205], v215 offset:40960
    v_mfma_f32_16x16x32_bf16 v[16:19], v[180:183], v[136:139], v[16:19]
    ds_read_b64_tr_b16 v[206:207], v215 offset:41984
    v_mfma_f32_16x16x32_bf16 v[20:23], v[180:183], v[140:143], v[20:23]
    s_waitcnt lgkmcnt(6)
    s_add_u32 m0, s29, 0
    s_mov_b32 s30, 512
    buffer_load_dwordx4 v220, s[4:7], s30 offen lds
    buffer_load_dwordx4 v221, s[4:7], s30 offen offset:1024 lds
    v_mfma_f32_16x16x32_bf16 v[24:27], v[184:187], v[132:135], v[24:27]
    v_mfma_f32_16x16x32_bf16 v[28:31], v[184:187], v[136:139], v[28:31]
    v_mfma_f32_16x16x32_bf16 v[32:35], v[184:187], v[140:143], v[32:35]
    v_mfma_f32_16x16x32_bf16 v[36:39], v[188:191], v[132:135], v[36:39]
    v_mfma_f32_16x16x32_bf16 v[40:43], v[188:191], v[136:139], v[40:43]
    v_mfma_f32_16x16x32_bf16 v[44:47], v[188:191], v[140:143], v[44:47]
    s_waitcnt lgkmcnt(0)
    s_barrier
    v_mfma_f32_16x16x32_bf16 v[48:51], v[192:195], v[132:135], v[48:51]
    ds_read_b64_tr_b16 v[176:177], v208 offset:8192
    ds_read_b64_tr_b16 v[178:179], v208 offset:9216
    v_mfma_f32_16x16x32_bf16 v[52:55], v[192:195], v[136:139], v[52:55]
    ds_read_b64_tr_b16 v[180:181], v209 offset:8192
    ds_read_b64_tr_b16 v[182:183], v209 offset:9216
    v_mfma_f32_16x16x32_bf16 v[56:59], v[192:195], v[140:143], v[56:59]
    s_add_u32 m0, s59, 0
    s_add_u32 s54, s55, 2097152
    buffer_load_dwordx4 v216, s[8:11], s54 offen offset:0 lds
    v_mfma_f32_16x16x32_bf16 v[60:63], v[196:199], v[132:135], v[60:63]
    ds_read_b64_tr_b16 v[184:185], v210 offset:8192
    ds_read_b64_tr_b16 v[186:187], v210 offset:9216
    v_mfma_f32_16x16x32_bf16 v[64:67], v[196:199], v[136:139], v[64:67]
    ds_read_b64_tr_b16 v[188:189], v211 offset:8192
    ds_read_b64_tr_b16 v[190:191], v211 offset:9216
    v_mfma_f32_16x16x32_bf16 v[68:71], v[196:199], v[140:143], v[68:71]
    s_add_u32 s54, s55, 2128896
    buffer_load_dwordx4 v216, s[8:11], s54 offen offset:1024 lds
    v_mfma_f32_16x16x32_bf16 v[72:75], v[200:203], v[132:135], v[72:75]
    ds_read_b64_tr_b16 v[192:193], v212 offset:8192
    v_mfma_f32_16x16x32_bf16 v[76:79], v[200:203], v[136:139], v[76:79]
    ds_read_b64_tr_b16 v[194:195], v212 offset:9216
    v_mfma_f32_16x16x32_bf16 v[80:83], v[200:203], v[140:143], v[80:83]
    s_add_u32 s54, s55, 2160640
    buffer_load_dwordx4 v217, s[8:11], s54 offen offset:2048 lds
    v_mfma_f32_16x16x32_bf16 v[84:87], v[204:207], v[132:135], v[84:87]
    ds_read_b64_tr_b16 v[196:197], v213 offset:8192
    v_mfma_f32_16x16x32_bf16 v[88:91], v[204:207], v[136:139], v[88:91]
    ds_read_b64_tr_b16 v[198:199], v213 offset:9216
    v_mfma_f32_16x16x32_bf16 v[92:95], v[204:207], v[140:143], v[92:95]
    s_add_u32 s54, s55, 2192384
    buffer_load_dwordx4 v217, s[8:11], s54 offen offset:3072 lds
    s_waitcnt lgkmcnt(10)
    v_mfma_f32_16x16x32_bf16 v[0:3], v[176:179], v[96:99], v[0:3]
    ds_read_b64_tr_b16 v[200:201], v214 offset:8192
    v_mfma_f32_16x16x32_bf16 v[4:7], v[176:179], v[100:103], v[4:7]
    ds_read_b64_tr_b16 v[202:203], v214 offset:9216
    v_mfma_f32_16x16x32_bf16 v[8:11], v[176:179], v[104:107], v[8:11]
    s_waitcnt lgkmcnt(10)
    v_mfma_f32_16x16x32_bf16 v[12:15], v[180:183], v[96:99], v[12:15]
    s_waitcnt vmcnt(14)
    ds_read_b128 v[120:123], v222 offset:2048
    ds_read_b128 v[132:135], v223 offset:2048
    v_mfma_f32_16x16x32_bf16 v[16:19], v[180:183], v[100:103], v[16:19]
    ds_read_b64_tr_b16 v[204:205], v215 offset:8192
    v_mfma_f32_16x16x32_bf16 v[20:23], v[180:183], v[104:107], v[20:23]
    ds_read_b64_tr_b16 v[206:207], v215 offset:9216
    s_waitcnt lgkmcnt(12)
    v_mfma_f32_16x16x32_bf16 v[24:27], v[184:187], v[96:99], v[24:27]
    ds_read_b64_tr_b16 v[176:177], v208 offset:49152
    v_mfma_f32_16x16x32_bf16 v[28:31], v[184:187], v[100:103], v[28:31]
    ds_read_b64_tr_b16 v[178:179], v208 offset:50176
    v_mfma_f32_16x16x32_bf16 v[32:35], v[184:187], v[104:107], v[32:35]
    s_waitcnt lgkmcnt(12)
    v_mfma_f32_16x16x32_bf16 v[36:39], v[188:191], v[96:99], v[36:39]
    ds_read_b64_tr_b16 v[180:181], v209 offset:49152
    v_mfma_f32_16x16x32_bf16 v[40:43], v[188:191], v[100:103], v[40:43]
    ds_read_b64_tr_b16 v[182:183], v209 offset:50176
    v_mfma_f32_16x16x32_bf16 v[44:47], v[188:191], v[104:107], v[44:47]
    s_waitcnt lgkmcnt(6)
    s_add_u32 m0, s29, 2048
    s_mov_b32 s30, 20992
    buffer_load_dwordx4 v220, s[4:7], s30 offen lds
    buffer_load_dwordx4 v221, s[4:7], s30 offen offset:1024 lds
    v_mfma_f32_16x16x32_bf16 v[48:51], v[192:195], v[96:99], v[48:51]
    s_waitcnt vmcnt(10)
    ds_read_b128 v[124:127], v222 offset:4096
    ds_read_b128 v[136:139], v223 offset:4096
    v_mfma_f32_16x16x32_bf16 v[52:55], v[192:195], v[100:103], v[52:55]
    ds_read_b64_tr_b16 v[184:185], v210 offset:49152
    v_mfma_f32_16x16x32_bf16 v[56:59], v[192:195], v[104:107], v[56:59]
    ds_read_b64_tr_b16 v[186:187], v210 offset:50176
    v_mfma_f32_16x16x32_bf16 v[60:63], v[196:199], v[96:99], v[60:63]
    ds_read_b64_tr_b16 v[188:189], v211 offset:49152
    v_mfma_f32_16x16x32_bf16 v[64:67], v[196:199], v[100:103], v[64:67]
    ds_read_b64_tr_b16 v[190:191], v211 offset:50176
    v_mfma_f32_16x16x32_bf16 v[68:71], v[196:199], v[104:107], v[68:71]
    v_mfma_f32_16x16x32_bf16 v[72:75], v[200:203], v[96:99], v[72:75]
    ds_read_b64_tr_b16 v[192:193], v212 offset:49152
    v_mfma_f32_16x16x32_bf16 v[76:79], v[200:203], v[100:103], v[76:79]
    ds_read_b64_tr_b16 v[194:195], v212 offset:50176
    v_mfma_f32_16x16x32_bf16 v[80:83], v[200:203], v[104:107], v[80:83]
    s_waitcnt lgkmcnt(6)
    s_add_u32 m0, s29, 4096
    s_mov_b32 s30, 41472
    buffer_load_dwordx4 v220, s[4:7], s30 offen lds
    buffer_load_dwordx4 v221, s[4:7], s30 offen offset:1024 lds
    v_mfma_f32_16x16x32_bf16 v[84:87], v[204:207], v[96:99], v[84:87]
    s_waitcnt vmcnt(10)
    ds_read_b128 v[128:131], v222 offset:6144
    ds_read_b128 v[140:143], v223 offset:6144
    v_mfma_f32_16x16x32_bf16 v[88:91], v[204:207], v[100:103], v[88:91]
    ds_read_b64_tr_b16 v[196:197], v213 offset:49152
    v_mfma_f32_16x16x32_bf16 v[92:95], v[204:207], v[104:107], v[92:95]
    ds_read_b64_tr_b16 v[198:199], v213 offset:50176
    v_mfma_f32_16x16x32_bf16 v[0:3], v[176:179], v[108:111], v[0:3]
    ds_read_b64_tr_b16 v[200:201], v214 offset:49152
    v_mfma_f32_16x16x32_bf16 v[4:7], v[176:179], v[112:115], v[4:7]
    ds_read_b64_tr_b16 v[202:203], v214 offset:50176
    v_mfma_f32_16x16x32_bf16 v[8:11], v[176:179], v[116:119], v[8:11]
    v_mfma_f32_16x16x32_bf16 v[12:15], v[180:183], v[108:111], v[12:15]
    ds_read_b64_tr_b16 v[204:205], v215 offset:49152
    v_mfma_f32_16x16x32_bf16 v[16:19], v[180:183], v[112:115], v[16:19]
    ds_read_b64_tr_b16 v[206:207], v215 offset:50176
    v_mfma_f32_16x16x32_bf16 v[20:23], v[180:183], v[116:119], v[20:23]
    s_waitcnt lgkmcnt(6)
    s_add_u32 m0, s29, 6144
    s_mov_b32 s30, 640
    buffer_load_dwordx4 v220, s[4:7], s30 offen lds
    buffer_load_dwordx4 v221, s[4:7], s30 offen offset:1024 lds
    v_mfma_f32_16x16x32_bf16 v[24:27], v[184:187], v[108:111], v[24:27]
    v_mfma_f32_16x16x32_bf16 v[28:31], v[184:187], v[112:115], v[28:31]
    v_mfma_f32_16x16x32_bf16 v[32:35], v[184:187], v[116:119], v[32:35]
    v_mfma_f32_16x16x32_bf16 v[36:39], v[188:191], v[108:111], v[36:39]
    v_mfma_f32_16x16x32_bf16 v[40:43], v[188:191], v[112:115], v[40:43]
    v_mfma_f32_16x16x32_bf16 v[44:47], v[188:191], v[116:119], v[44:47]
    s_waitcnt lgkmcnt(0)
    s_barrier
    v_mfma_f32_16x16x32_bf16 v[48:51], v[192:195], v[108:111], v[48:51]
    ds_read_b64_tr_b16 v[176:177], v208 offset:16384
    ds_read_b64_tr_b16 v[178:179], v208 offset:17408
    v_mfma_f32_16x16x32_bf16 v[52:55], v[192:195], v[112:115], v[52:55]
    ds_read_b64_tr_b16 v[180:181], v209 offset:16384
    ds_read_b64_tr_b16 v[182:183], v209 offset:17408
    v_mfma_f32_16x16x32_bf16 v[56:59], v[192:195], v[116:119], v[56:59]
    s_add_u32 m0, s59, 8192
    s_add_u32 s54, s55, 2621440
    buffer_load_dwordx4 v216, s[8:11], s54 offen offset:0 lds
    v_mfma_f32_16x16x32_bf16 v[60:63], v[196:199], v[108:111], v[60:63]
    ds_read_b64_tr_b16 v[184:185], v210 offset:16384
    ds_read_b64_tr_b16 v[186:187], v210 offset:17408
    v_mfma_f32_16x16x32_bf16 v[64:67], v[196:199], v[112:115], v[64:67]
    ds_read_b64_tr_b16 v[188:189], v211 offset:16384
    ds_read_b64_tr_b16 v[190:191], v211 offset:17408
    v_mfma_f32_16x16x32_bf16 v[68:71], v[196:199], v[116:119], v[68:71]
    s_add_u32 s54, s55, 2653184
    buffer_load_dwordx4 v216, s[8:11], s54 offen offset:1024 lds
    v_mfma_f32_16x16x32_bf16 v[72:75], v[200:203], v[108:111], v[72:75]
    ds_read_b64_tr_b16 v[192:193], v212 offset:16384
    v_mfma_f32_16x16x32_bf16 v[76:79], v[200:203], v[112:115], v[76:79]
    ds_read_b64_tr_b16 v[194:195], v212 offset:17408
    v_mfma_f32_16x16x32_bf16 v[80:83], v[200:203], v[116:119], v[80:83]
    s_add_u32 s54, s55, 2684928
    buffer_load_dwordx4 v217, s[8:11], s54 offen offset:2048 lds
    v_mfma_f32_16x16x32_bf16 v[84:87], v[204:207], v[108:111], v[84:87]
    ds_read_b64_tr_b16 v[196:197], v213 offset:16384
    v_mfma_f32_16x16x32_bf16 v[88:91], v[204:207], v[112:115], v[88:91]
    ds_read_b64_tr_b16 v[198:199], v213 offset:17408
    v_mfma_f32_16x16x32_bf16 v[92:95], v[204:207], v[116:119], v[92:95]
    s_add_u32 s54, s55, 2716672
    buffer_load_dwordx4 v217, s[8:11], s54 offen offset:3072 lds
    s_waitcnt lgkmcnt(10)
    v_mfma_f32_16x16x32_bf16 v[0:3], v[176:179], v[120:123], v[0:3]
    ds_read_b64_tr_b16 v[200:201], v214 offset:16384
    v_mfma_f32_16x16x32_bf16 v[4:7], v[176:179], v[124:127], v[4:7]
    ds_read_b64_tr_b16 v[202:203], v214 offset:17408
    v_mfma_f32_16x16x32_bf16 v[8:11], v[176:179], v[128:131], v[8:11]
    s_waitcnt lgkmcnt(10)
    v_mfma_f32_16x16x32_bf16 v[12:15], v[180:183], v[120:123], v[12:15]
    s_waitcnt vmcnt(14)
    ds_read_b128 v[96:99], v222 offset:0
    ds_read_b128 v[108:111], v223 offset:0
    v_mfma_f32_16x16x32_bf16 v[16:19], v[180:183], v[124:127], v[16:19]
    ds_read_b64_tr_b16 v[204:205], v215 offset:16384
    v_mfma_f32_16x16x32_bf16 v[20:23], v[180:183], v[128:131], v[20:23]
    ds_read_b64_tr_b16 v[206:207], v215 offset:17408
    s_waitcnt lgkmcnt(12)
    v_mfma_f32_16x16x32_bf16 v[24:27], v[184:187], v[120:123], v[24:27]
    ds_read_b64_tr_b16 v[176:177], v208 offset:57344
    v_mfma_f32_16x16x32_bf16 v[28:31], v[184:187], v[124:127], v[28:31]
    ds_read_b64_tr_b16 v[178:179], v208 offset:58368
    v_mfma_f32_16x16x32_bf16 v[32:35], v[184:187], v[128:131], v[32:35]
    s_waitcnt lgkmcnt(12)
    v_mfma_f32_16x16x32_bf16 v[36:39], v[188:191], v[120:123], v[36:39]
    ds_read_b64_tr_b16 v[180:181], v209 offset:57344
    v_mfma_f32_16x16x32_bf16 v[40:43], v[188:191], v[124:127], v[40:43]
    ds_read_b64_tr_b16 v[182:183], v209 offset:58368
    v_mfma_f32_16x16x32_bf16 v[44:47], v[188:191], v[128:131], v[44:47]
    s_waitcnt lgkmcnt(6)
    s_add_u32 m0, s29, 0
    s_mov_b32 s30, 21120
    buffer_load_dwordx4 v220, s[4:7], s30 offen lds
    buffer_load_dwordx4 v221, s[4:7], s30 offen offset:1024 lds
    v_mfma_f32_16x16x32_bf16 v[48:51], v[192:195], v[120:123], v[48:51]
    s_waitcnt vmcnt(10)
    ds_read_b128 v[100:103], v222 offset:2048
    ds_read_b128 v[112:115], v223 offset:2048
    v_mfma_f32_16x16x32_bf16 v[52:55], v[192:195], v[124:127], v[52:55]
    ds_read_b64_tr_b16 v[184:185], v210 offset:57344
    v_mfma_f32_16x16x32_bf16 v[56:59], v[192:195], v[128:131], v[56:59]
    ds_read_b64_tr_b16 v[186:187], v210 offset:58368
    v_mfma_f32_16x16x32_bf16 v[60:63], v[196:199], v[120:123], v[60:63]
    ds_read_b64_tr_b16 v[188:189], v211 offset:57344
    v_mfma_f32_16x16x32_bf16 v[64:67], v[196:199], v[124:127], v[64:67]
    ds_read_b64_tr_b16 v[190:191], v211 offset:58368
    v_mfma_f32_16x16x32_bf16 v[68:71], v[196:199], v[128:131], v[68:71]
    v_mfma_f32_16x16x32_bf16 v[72:75], v[200:203], v[120:123], v[72:75]
    ds_read_b64_tr_b16 v[192:193], v212 offset:57344
    v_mfma_f32_16x16x32_bf16 v[76:79], v[200:203], v[124:127], v[76:79]
    ds_read_b64_tr_b16 v[194:195], v212 offset:58368
    v_mfma_f32_16x16x32_bf16 v[80:83], v[200:203], v[128:131], v[80:83]
    s_waitcnt lgkmcnt(6)
    s_add_u32 m0, s29, 2048
    s_mov_b32 s30, 41600
    buffer_load_dwordx4 v220, s[4:7], s30 offen lds
    buffer_load_dwordx4 v221, s[4:7], s30 offen offset:1024 lds
    v_mfma_f32_16x16x32_bf16 v[84:87], v[204:207], v[120:123], v[84:87]
    s_waitcnt vmcnt(10)
    ds_read_b128 v[104:107], v222 offset:4096
    ds_read_b128 v[116:119], v223 offset:4096
    v_mfma_f32_16x16x32_bf16 v[88:91], v[204:207], v[124:127], v[88:91]
    ds_read_b64_tr_b16 v[196:197], v213 offset:57344
    v_mfma_f32_16x16x32_bf16 v[92:95], v[204:207], v[128:131], v[92:95]
    ds_read_b64_tr_b16 v[198:199], v213 offset:58368
    v_mfma_f32_16x16x32_bf16 v[0:3], v[176:179], v[132:135], v[0:3]
    ds_read_b64_tr_b16 v[200:201], v214 offset:57344
    v_mfma_f32_16x16x32_bf16 v[4:7], v[176:179], v[136:139], v[4:7]
    ds_read_b64_tr_b16 v[202:203], v214 offset:58368
    v_mfma_f32_16x16x32_bf16 v[8:11], v[176:179], v[140:143], v[8:11]
    v_mfma_f32_16x16x32_bf16 v[12:15], v[180:183], v[132:135], v[12:15]
    ds_read_b64_tr_b16 v[204:205], v215 offset:57344
    v_mfma_f32_16x16x32_bf16 v[16:19], v[180:183], v[136:139], v[16:19]
    ds_read_b64_tr_b16 v[206:207], v215 offset:58368
    v_mfma_f32_16x16x32_bf16 v[20:23], v[180:183], v[140:143], v[20:23]
    s_waitcnt lgkmcnt(6)
    s_add_u32 m0, s29, 4096
    s_mov_b32 s30, 768
    buffer_load_dwordx4 v220, s[4:7], s30 offen lds
    buffer_load_dwordx4 v221, s[4:7], s30 offen offset:1024 lds
    v_mfma_f32_16x16x32_bf16 v[24:27], v[184:187], v[132:135], v[24:27]
    v_mfma_f32_16x16x32_bf16 v[28:31], v[184:187], v[136:139], v[28:31]
    v_mfma_f32_16x16x32_bf16 v[32:35], v[184:187], v[140:143], v[32:35]
    v_mfma_f32_16x16x32_bf16 v[36:39], v[188:191], v[132:135], v[36:39]
    v_mfma_f32_16x16x32_bf16 v[40:43], v[188:191], v[136:139], v[40:43]
    v_mfma_f32_16x16x32_bf16 v[44:47], v[188:191], v[140:143], v[44:47]
    s_waitcnt lgkmcnt(0)
    s_barrier
    v_mfma_f32_16x16x32_bf16 v[48:51], v[192:195], v[132:135], v[48:51]
    ds_read_b64_tr_b16 v[176:177], v208 offset:0
    ds_read_b64_tr_b16 v[178:179], v208 offset:1024
    v_mfma_f32_16x16x32_bf16 v[52:55], v[192:195], v[136:139], v[52:55]
    ds_read_b64_tr_b16 v[180:181], v209 offset:0
    ds_read_b64_tr_b16 v[182:183], v209 offset:1024
    v_mfma_f32_16x16x32_bf16 v[56:59], v[192:195], v[140:143], v[56:59]
    s_add_u32 m0, s59, 16384
    s_add_u32 s54, s55, 3145728
    buffer_load_dwordx4 v216, s[8:11], s54 offen offset:0 lds
    v_mfma_f32_16x16x32_bf16 v[60:63], v[196:199], v[132:135], v[60:63]
    ds_read_b64_tr_b16 v[184:185], v210 offset:0
    ds_read_b64_tr_b16 v[186:187], v210 offset:1024
    v_mfma_f32_16x16x32_bf16 v[64:67], v[196:199], v[136:139], v[64:67]
    ds_read_b64_tr_b16 v[188:189], v211 offset:0
    ds_read_b64_tr_b16 v[190:191], v211 offset:1024
    v_mfma_f32_16x16x32_bf16 v[68:71], v[196:199], v[140:143], v[68:71]
    s_add_u32 s54, s55, 3177472
    buffer_load_dwordx4 v216, s[8:11], s54 offen offset:1024 lds
    v_mfma_f32_16x16x32_bf16 v[72:75], v[200:203], v[132:135], v[72:75]
    ds_read_b64_tr_b16 v[192:193], v212 offset:0
    v_mfma_f32_16x16x32_bf16 v[76:79], v[200:203], v[136:139], v[76:79]
    ds_read_b64_tr_b16 v[194:195], v212 offset:1024
    v_mfma_f32_16x16x32_bf16 v[80:83], v[200:203], v[140:143], v[80:83]
    s_add_u32 s54, s55, 3209216
    buffer_load_dwordx4 v217, s[8:11], s54 offen offset:2048 lds
    v_mfma_f32_16x16x32_bf16 v[84:87], v[204:207], v[132:135], v[84:87]
    ds_read_b64_tr_b16 v[196:197], v213 offset:0
    v_mfma_f32_16x16x32_bf16 v[88:91], v[204:207], v[136:139], v[88:91]
    ds_read_b64_tr_b16 v[198:199], v213 offset:1024
    v_mfma_f32_16x16x32_bf16 v[92:95], v[204:207], v[140:143], v[92:95]
    s_add_u32 s54, s55, 3240960
    buffer_load_dwordx4 v217, s[8:11], s54 offen offset:3072 lds
    s_waitcnt lgkmcnt(10)
    v_mfma_f32_16x16x32_bf16 v[0:3], v[176:179], v[96:99], v[0:3]
    ds_read_b64_tr_b16 v[200:201], v214 offset:0
    v_mfma_f32_16x16x32_bf16 v[4:7], v[176:179], v[100:103], v[4:7]
    ds_read_b64_tr_b16 v[202:203], v214 offset:1024
    v_mfma_f32_16x16x32_bf16 v[8:11], v[176:179], v[104:107], v[8:11]
    s_waitcnt lgkmcnt(10)
    v_mfma_f32_16x16x32_bf16 v[12:15], v[180:183], v[96:99], v[12:15]
    s_waitcnt vmcnt(14)
    ds_read_b128 v[120:123], v222 offset:6144
    ds_read_b128 v[132:135], v223 offset:6144
    v_mfma_f32_16x16x32_bf16 v[16:19], v[180:183], v[100:103], v[16:19]
    ds_read_b64_tr_b16 v[204:205], v215 offset:0
    v_mfma_f32_16x16x32_bf16 v[20:23], v[180:183], v[104:107], v[20:23]
    ds_read_b64_tr_b16 v[206:207], v215 offset:1024
    s_waitcnt lgkmcnt(12)
    v_mfma_f32_16x16x32_bf16 v[24:27], v[184:187], v[96:99], v[24:27]
    ds_read_b64_tr_b16 v[176:177], v208 offset:40960
    v_mfma_f32_16x16x32_bf16 v[28:31], v[184:187], v[100:103], v[28:31]
    ds_read_b64_tr_b16 v[178:179], v208 offset:41984
    v_mfma_f32_16x16x32_bf16 v[32:35], v[184:187], v[104:107], v[32:35]
    s_waitcnt lgkmcnt(12)
    v_mfma_f32_16x16x32_bf16 v[36:39], v[188:191], v[96:99], v[36:39]
    ds_read_b64_tr_b16 v[180:181], v209 offset:40960
    v_mfma_f32_16x16x32_bf16 v[40:43], v[188:191], v[100:103], v[40:43]
    ds_read_b64_tr_b16 v[182:183], v209 offset:41984
    v_mfma_f32_16x16x32_bf16 v[44:47], v[188:191], v[104:107], v[44:47]
    s_waitcnt lgkmcnt(6)
    s_add_u32 m0, s29, 6144
    s_mov_b32 s30, 21248
    buffer_load_dwordx4 v220, s[4:7], s30 offen lds
    buffer_load_dwordx4 v221, s[4:7], s30 offen offset:1024 lds
    v_mfma_f32_16x16x32_bf16 v[48:51], v[192:195], v[96:99], v[48:51]
    s_waitcnt vmcnt(10)
    ds_read_b128 v[124:127], v222 offset:0
    ds_read_b128 v[136:139], v223 offset:0
    v_mfma_f32_16x16x32_bf16 v[52:55], v[192:195], v[100:103], v[52:55]
    ds_read_b64_tr_b16 v[184:185], v210 offset:40960
    v_mfma_f32_16x16x32_bf16 v[56:59], v[192:195], v[104:107], v[56:59]
    ds_read_b64_tr_b16 v[186:187], v210 offset:41984
    v_mfma_f32_16x16x32_bf16 v[60:63], v[196:199], v[96:99], v[60:63]
    ds_read_b64_tr_b16 v[188:189], v211 offset:40960
    v_mfma_f32_16x16x32_bf16 v[64:67], v[196:199], v[100:103], v[64:67]
    ds_read_b64_tr_b16 v[190:191], v211 offset:41984
    v_mfma_f32_16x16x32_bf16 v[68:71], v[196:199], v[104:107], v[68:71]
    v_mfma_f32_16x16x32_bf16 v[72:75], v[200:203], v[96:99], v[72:75]
    ds_read_b64_tr_b16 v[192:193], v212 offset:40960
    v_mfma_f32_16x16x32_bf16 v[76:79], v[200:203], v[100:103], v[76:79]
    ds_read_b64_tr_b16 v[194:195], v212 offset:41984
    v_mfma_f32_16x16x32_bf16 v[80:83], v[200:203], v[104:107], v[80:83]
    s_waitcnt lgkmcnt(6)
    s_add_u32 m0, s29, 0
    s_mov_b32 s30, 41728
    buffer_load_dwordx4 v220, s[4:7], s30 offen lds
    buffer_load_dwordx4 v221, s[4:7], s30 offen offset:1024 lds
    v_mfma_f32_16x16x32_bf16 v[84:87], v[204:207], v[96:99], v[84:87]
    s_waitcnt vmcnt(10)
    ds_read_b128 v[128:131], v222 offset:2048
    ds_read_b128 v[140:143], v223 offset:2048
    v_mfma_f32_16x16x32_bf16 v[88:91], v[204:207], v[100:103], v[88:91]
    ds_read_b64_tr_b16 v[196:197], v213 offset:40960
    v_mfma_f32_16x16x32_bf16 v[92:95], v[204:207], v[104:107], v[92:95]
    ds_read_b64_tr_b16 v[198:199], v213 offset:41984
    v_mfma_f32_16x16x32_bf16 v[0:3], v[176:179], v[108:111], v[0:3]
    ds_read_b64_tr_b16 v[200:201], v214 offset:40960
    v_mfma_f32_16x16x32_bf16 v[4:7], v[176:179], v[112:115], v[4:7]
    ds_read_b64_tr_b16 v[202:203], v214 offset:41984
    v_mfma_f32_16x16x32_bf16 v[8:11], v[176:179], v[116:119], v[8:11]
    v_mfma_f32_16x16x32_bf16 v[12:15], v[180:183], v[108:111], v[12:15]
    ds_read_b64_tr_b16 v[204:205], v215 offset:40960
    v_mfma_f32_16x16x32_bf16 v[16:19], v[180:183], v[112:115], v[16:19]
    ds_read_b64_tr_b16 v[206:207], v215 offset:41984
    v_mfma_f32_16x16x32_bf16 v[20:23], v[180:183], v[116:119], v[20:23]
    s_waitcnt lgkmcnt(6)
    s_add_u32 m0, s29, 2048
    s_mov_b32 s30, 896
    buffer_load_dwordx4 v220, s[4:7], s30 offen lds
    buffer_load_dwordx4 v221, s[4:7], s30 offen offset:1024 lds
    v_mfma_f32_16x16x32_bf16 v[24:27], v[184:187], v[108:111], v[24:27]
    v_mfma_f32_16x16x32_bf16 v[28:31], v[184:187], v[112:115], v[28:31]
    v_mfma_f32_16x16x32_bf16 v[32:35], v[184:187], v[116:119], v[32:35]
    v_mfma_f32_16x16x32_bf16 v[36:39], v[188:191], v[108:111], v[36:39]
    v_mfma_f32_16x16x32_bf16 v[40:43], v[188:191], v[112:115], v[40:43]
    v_mfma_f32_16x16x32_bf16 v[44:47], v[188:191], v[116:119], v[44:47]
    s_waitcnt lgkmcnt(0)
    s_barrier
    v_mfma_f32_16x16x32_bf16 v[48:51], v[192:195], v[108:111], v[48:51]
    ds_read_b64_tr_b16 v[176:177], v208 offset:8192
    ds_read_b64_tr_b16 v[178:179], v208 offset:9216
    v_mfma_f32_16x16x32_bf16 v[52:55], v[192:195], v[112:115], v[52:55]
    ds_read_b64_tr_b16 v[180:181], v209 offset:8192
    ds_read_b64_tr_b16 v[182:183], v209 offset:9216
    v_mfma_f32_16x16x32_bf16 v[56:59], v[192:195], v[116:119], v[56:59]
    s_add_u32 m0, s59, 0
    s_add_u32 s54, s55, 3670016
    buffer_load_dwordx4 v216, s[8:11], s54 offen offset:0 lds
    v_mfma_f32_16x16x32_bf16 v[60:63], v[196:199], v[108:111], v[60:63]
    ds_read_b64_tr_b16 v[184:185], v210 offset:8192
    ds_read_b64_tr_b16 v[186:187], v210 offset:9216
    v_mfma_f32_16x16x32_bf16 v[64:67], v[196:199], v[112:115], v[64:67]
    ds_read_b64_tr_b16 v[188:189], v211 offset:8192
    ds_read_b64_tr_b16 v[190:191], v211 offset:9216
    v_mfma_f32_16x16x32_bf16 v[68:71], v[196:199], v[116:119], v[68:71]
    s_add_u32 s54, s55, 3701760
    buffer_load_dwordx4 v216, s[8:11], s54 offen offset:1024 lds
    v_mfma_f32_16x16x32_bf16 v[72:75], v[200:203], v[108:111], v[72:75]
    ds_read_b64_tr_b16 v[192:193], v212 offset:8192
    v_mfma_f32_16x16x32_bf16 v[76:79], v[200:203], v[112:115], v[76:79]
    ds_read_b64_tr_b16 v[194:195], v212 offset:9216
    v_mfma_f32_16x16x32_bf16 v[80:83], v[200:203], v[116:119], v[80:83]
    s_add_u32 s54, s55, 3733504
    buffer_load_dwordx4 v217, s[8:11], s54 offen offset:2048 lds
    v_mfma_f32_16x16x32_bf16 v[84:87], v[204:207], v[108:111], v[84:87]
    ds_read_b64_tr_b16 v[196:197], v213 offset:8192
    v_mfma_f32_16x16x32_bf16 v[88:91], v[204:207], v[112:115], v[88:91]
    ds_read_b64_tr_b16 v[198:199], v213 offset:9216
    v_mfma_f32_16x16x32_bf16 v[92:95], v[204:207], v[116:119], v[92:95]
    s_add_u32 s54, s55, 3765248
    buffer_load_dwordx4 v217, s[8:11], s54 offen offset:3072 lds
    s_waitcnt lgkmcnt(10)
    v_mfma_f32_16x16x32_bf16 v[0:3], v[176:179], v[120:123], v[0:3]
    ds_read_b64_tr_b16 v[200:201], v214 offset:8192
    v_mfma_f32_16x16x32_bf16 v[4:7], v[176:179], v[124:127], v[4:7]
    ds_read_b64_tr_b16 v[202:203], v214 offset:9216
    v_mfma_f32_16x16x32_bf16 v[8:11], v[176:179], v[128:131], v[8:11]
    s_waitcnt lgkmcnt(10)
    v_mfma_f32_16x16x32_bf16 v[12:15], v[180:183], v[120:123], v[12:15]
    s_waitcnt vmcnt(14)
    ds_read_b128 v[96:99], v222 offset:4096
    ds_read_b128 v[108:111], v223 offset:4096
    v_mfma_f32_16x16x32_bf16 v[16:19], v[180:183], v[124:127], v[16:19]
    ds_read_b64_tr_b16 v[204:205], v215 offset:8192
    v_mfma_f32_16x16x32_bf16 v[20:23], v[180:183], v[128:131], v[20:23]
    ds_read_b64_tr_b16 v[206:207], v215 offset:9216
    s_waitcnt lgkmcnt(12)
    v_mfma_f32_16x16x32_bf16 v[24:27], v[184:187], v[120:123], v[24:27]
    ds_read_b64_tr_b16 v[176:177], v208 offset:49152
    v_mfma_f32_16x16x32_bf16 v[28:31], v[184:187], v[124:127], v[28:31]
    ds_read_b64_tr_b16 v[178:179], v208 offset:50176
    v_mfma_f32_16x16x32_bf16 v[32:35], v[184:187], v[128:131], v[32:35]
    s_waitcnt lgkmcnt(12)
    v_mfma_f32_16x16x32_bf16 v[36:39], v[188:191], v[120:123], v[36:39]
    ds_read_b64_tr_b16 v[180:181], v209 offset:49152
    v_mfma_f32_16x16x32_bf16 v[40:43], v[188:191], v[124:127], v[40:43]
    ds_read_b64_tr_b16 v[182:183], v209 offset:50176
    v_mfma_f32_16x16x32_bf16 v[44:47], v[188:191], v[128:131], v[44:47]
    s_waitcnt lgkmcnt(6)
    s_add_u32 m0, s29, 4096
    s_mov_b32 s30, 21376
    buffer_load_dwordx4 v220, s[4:7], s30 offen lds
    buffer_load_dwordx4 v221, s[4:7], s30 offen offset:1024 lds
    v_mfma_f32_16x16x32_bf16 v[48:51], v[192:195], v[120:123], v[48:51]
    s_waitcnt vmcnt(10)
    ds_read_b128 v[100:103], v222 offset:6144
    ds_read_b128 v[112:115], v223 offset:6144
    v_mfma_f32_16x16x32_bf16 v[52:55], v[192:195], v[124:127], v[52:55]
    ds_read_b64_tr_b16 v[184:185], v210 offset:49152
    v_mfma_f32_16x16x32_bf16 v[56:59], v[192:195], v[128:131], v[56:59]
    ds_read_b64_tr_b16 v[186:187], v210 offset:50176
    v_mfma_f32_16x16x32_bf16 v[60:63], v[196:199], v[120:123], v[60:63]
    ds_read_b64_tr_b16 v[188:189], v211 offset:49152
    v_mfma_f32_16x16x32_bf16 v[64:67], v[196:199], v[124:127], v[64:67]
    ds_read_b64_tr_b16 v[190:191], v211 offset:50176
    v_mfma_f32_16x16x32_bf16 v[68:71], v[196:199], v[128:131], v[68:71]
    v_mfma_f32_16x16x32_bf16 v[72:75], v[200:203], v[120:123], v[72:75]
    ds_read_b64_tr_b16 v[192:193], v212 offset:49152
    v_mfma_f32_16x16x32_bf16 v[76:79], v[200:203], v[124:127], v[76:79]
    ds_read_b64_tr_b16 v[194:195], v212 offset:50176
    v_mfma_f32_16x16x32_bf16 v[80:83], v[200:203], v[128:131], v[80:83]
    s_waitcnt lgkmcnt(6)
    s_add_u32 m0, s29, 6144
    s_mov_b32 s30, 41856
    buffer_load_dwordx4 v220, s[4:7], s30 offen lds
    buffer_load_dwordx4 v221, s[4:7], s30 offen offset:1024 lds
    v_mfma_f32_16x16x32_bf16 v[84:87], v[204:207], v[120:123], v[84:87]
    s_waitcnt vmcnt(10)
    ds_read_b128 v[104:107], v222 offset:0
    ds_read_b128 v[116:119], v223 offset:0
    v_mfma_f32_16x16x32_bf16 v[88:91], v[204:207], v[124:127], v[88:91]
    ds_read_b64_tr_b16 v[196:197], v213 offset:49152
    v_mfma_f32_16x16x32_bf16 v[92:95], v[204:207], v[128:131], v[92:95]
    ds_read_b64_tr_b16 v[198:199], v213 offset:50176
    v_mfma_f32_16x16x32_bf16 v[0:3], v[176:179], v[132:135], v[0:3]
    ds_read_b64_tr_b16 v[200:201], v214 offset:49152
    v_mfma_f32_16x16x32_bf16 v[4:7], v[176:179], v[136:139], v[4:7]
    ds_read_b64_tr_b16 v[202:203], v214 offset:50176
    v_mfma_f32_16x16x32_bf16 v[8:11], v[176:179], v[140:143], v[8:11]
    v_mfma_f32_16x16x32_bf16 v[12:15], v[180:183], v[132:135], v[12:15]
    ds_read_b64_tr_b16 v[204:205], v215 offset:49152
    v_mfma_f32_16x16x32_bf16 v[16:19], v[180:183], v[136:139], v[16:19]
    ds_read_b64_tr_b16 v[206:207], v215 offset:50176
    v_mfma_f32_16x16x32_bf16 v[20:23], v[180:183], v[140:143], v[20:23]
    s_waitcnt lgkmcnt(6)
    s_add_u32 m0, s29, 0
    s_mov_b32 s30, 1024
    buffer_load_dwordx4 v220, s[4:7], s30 offen lds
    buffer_load_dwordx4 v221, s[4:7], s30 offen offset:1024 lds
    v_mfma_f32_16x16x32_bf16 v[24:27], v[184:187], v[132:135], v[24:27]
    v_mfma_f32_16x16x32_bf16 v[28:31], v[184:187], v[136:139], v[28:31]
    v_mfma_f32_16x16x32_bf16 v[32:35], v[184:187], v[140:143], v[32:35]
    v_mfma_f32_16x16x32_bf16 v[36:39], v[188:191], v[132:135], v[36:39]
    v_mfma_f32_16x16x32_bf16 v[40:43], v[188:191], v[136:139], v[40:43]
    v_mfma_f32_16x16x32_bf16 v[44:47], v[188:191], v[140:143], v[44:47]
    s_waitcnt lgkmcnt(0)
    s_barrier
    v_mfma_f32_16x16x32_bf16 v[48:51], v[192:195], v[132:135], v[48:51]
    ds_read_b64_tr_b16 v[176:177], v208 offset:16384
    ds_read_b64_tr_b16 v[178:179], v208 offset:17408
    v_mfma_f32_16x16x32_bf16 v[52:55], v[192:195], v[136:139], v[52:55]
    ds_read_b64_tr_b16 v[180:181], v209 offset:16384
    ds_read_b64_tr_b16 v[182:183], v209 offset:17408
    v_mfma_f32_16x16x32_bf16 v[56:59], v[192:195], v[140:143], v[56:59]
    s_add_u32 m0, s59, 8192
    s_add_u32 s54, s55, 4194304
    buffer_load_dwordx4 v216, s[8:11], s54 offen offset:0 lds
    v_mfma_f32_16x16x32_bf16 v[60:63], v[196:199], v[132:135], v[60:63]
    ds_read_b64_tr_b16 v[184:185], v210 offset:16384
    ds_read_b64_tr_b16 v[186:187], v210 offset:17408
    v_mfma_f32_16x16x32_bf16 v[64:67], v[196:199], v[136:139], v[64:67]
    ds_read_b64_tr_b16 v[188:189], v211 offset:16384
    ds_read_b64_tr_b16 v[190:191], v211 offset:17408
    v_mfma_f32_16x16x32_bf16 v[68:71], v[196:199], v[140:143], v[68:71]
    s_add_u32 s54, s55, 4226048
    buffer_load_dwordx4 v216, s[8:11], s54 offen offset:1024 lds
    v_mfma_f32_16x16x32_bf16 v[72:75], v[200:203], v[132:135], v[72:75]
    ds_read_b64_tr_b16 v[192:193], v212 offset:16384
    v_mfma_f32_16x16x32_bf16 v[76:79], v[200:203], v[136:139], v[76:79]
    ds_read_b64_tr_b16 v[194:195], v212 offset:17408
    v_mfma_f32_16x16x32_bf16 v[80:83], v[200:203], v[140:143], v[80:83]
    s_add_u32 s54, s55, 4257792
    buffer_load_dwordx4 v217, s[8:11], s54 offen offset:2048 lds
    v_mfma_f32_16x16x32_bf16 v[84:87], v[204:207], v[132:135], v[84:87]
    ds_read_b64_tr_b16 v[196:197], v213 offset:16384
    v_mfma_f32_16x16x32_bf16 v[88:91], v[204:207], v[136:139], v[88:91]
    ds_read_b64_tr_b16 v[198:199], v213 offset:17408
    v_mfma_f32_16x16x32_bf16 v[92:95], v[204:207], v[140:143], v[92:95]
    s_add_u32 s54, s55, 4289536
    buffer_load_dwordx4 v217, s[8:11], s54 offen offset:3072 lds
    s_waitcnt lgkmcnt(10)
    v_mfma_f32_16x16x32_bf16 v[0:3], v[176:179], v[96:99], v[0:3]
    ds_read_b64_tr_b16 v[200:201], v214 offset:16384
    v_mfma_f32_16x16x32_bf16 v[4:7], v[176:179], v[100:103], v[4:7]
    ds_read_b64_tr_b16 v[202:203], v214 offset:17408
    v_mfma_f32_16x16x32_bf16 v[8:11], v[176:179], v[104:107], v[8:11]
    s_waitcnt lgkmcnt(10)
    v_mfma_f32_16x16x32_bf16 v[12:15], v[180:183], v[96:99], v[12:15]
    s_waitcnt vmcnt(14)
    ds_read_b128 v[120:123], v222 offset:2048
    ds_read_b128 v[132:135], v223 offset:2048
    v_mfma_f32_16x16x32_bf16 v[16:19], v[180:183], v[100:103], v[16:19]
    ds_read_b64_tr_b16 v[204:205], v215 offset:16384
    v_mfma_f32_16x16x32_bf16 v[20:23], v[180:183], v[104:107], v[20:23]
    ds_read_b64_tr_b16 v[206:207], v215 offset:17408
    s_waitcnt lgkmcnt(12)
    v_mfma_f32_16x16x32_bf16 v[24:27], v[184:187], v[96:99], v[24:27]
    ds_read_b64_tr_b16 v[176:177], v208 offset:57344
    v_mfma_f32_16x16x32_bf16 v[28:31], v[184:187], v[100:103], v[28:31]
    ds_read_b64_tr_b16 v[178:179], v208 offset:58368
    v_mfma_f32_16x16x32_bf16 v[32:35], v[184:187], v[104:107], v[32:35]
    s_waitcnt lgkmcnt(12)
    v_mfma_f32_16x16x32_bf16 v[36:39], v[188:191], v[96:99], v[36:39]
    ds_read_b64_tr_b16 v[180:181], v209 offset:57344
    v_mfma_f32_16x16x32_bf16 v[40:43], v[188:191], v[100:103], v[40:43]
    ds_read_b64_tr_b16 v[182:183], v209 offset:58368
    v_mfma_f32_16x16x32_bf16 v[44:47], v[188:191], v[104:107], v[44:47]
    s_waitcnt lgkmcnt(6)
    s_add_u32 m0, s29, 2048
    s_mov_b32 s30, 21504
    buffer_load_dwordx4 v220, s[4:7], s30 offen lds
    buffer_load_dwordx4 v221, s[4:7], s30 offen offset:1024 lds
    v_mfma_f32_16x16x32_bf16 v[48:51], v[192:195], v[96:99], v[48:51]
    s_waitcnt vmcnt(10)
    ds_read_b128 v[124:127], v222 offset:4096
    ds_read_b128 v[136:139], v223 offset:4096
    v_mfma_f32_16x16x32_bf16 v[52:55], v[192:195], v[100:103], v[52:55]
    ds_read_b64_tr_b16 v[184:185], v210 offset:57344
    v_mfma_f32_16x16x32_bf16 v[56:59], v[192:195], v[104:107], v[56:59]
    ds_read_b64_tr_b16 v[186:187], v210 offset:58368
    v_mfma_f32_16x16x32_bf16 v[60:63], v[196:199], v[96:99], v[60:63]
    ds_read_b64_tr_b16 v[188:189], v211 offset:57344
    v_mfma_f32_16x16x32_bf16 v[64:67], v[196:199], v[100:103], v[64:67]
    ds_read_b64_tr_b16 v[190:191], v211 offset:58368
    v_mfma_f32_16x16x32_bf16 v[68:71], v[196:199], v[104:107], v[68:71]
    v_mfma_f32_16x16x32_bf16 v[72:75], v[200:203], v[96:99], v[72:75]
    ds_read_b64_tr_b16 v[192:193], v212 offset:57344
    v_mfma_f32_16x16x32_bf16 v[76:79], v[200:203], v[100:103], v[76:79]
    ds_read_b64_tr_b16 v[194:195], v212 offset:58368
    v_mfma_f32_16x16x32_bf16 v[80:83], v[200:203], v[104:107], v[80:83]
    s_waitcnt lgkmcnt(6)
    s_add_u32 m0, s29, 4096
    s_mov_b32 s30, 41984
    buffer_load_dwordx4 v220, s[4:7], s30 offen lds
    buffer_load_dwordx4 v221, s[4:7], s30 offen offset:1024 lds
    v_mfma_f32_16x16x32_bf16 v[84:87], v[204:207], v[96:99], v[84:87]
    s_waitcnt vmcnt(10)
    ds_read_b128 v[128:131], v222 offset:6144
    ds_read_b128 v[140:143], v223 offset:6144
    v_mfma_f32_16x16x32_bf16 v[88:91], v[204:207], v[100:103], v[88:91]
    ds_read_b64_tr_b16 v[196:197], v213 offset:57344
    v_mfma_f32_16x16x32_bf16 v[92:95], v[204:207], v[104:107], v[92:95]
    ds_read_b64_tr_b16 v[198:199], v213 offset:58368
    v_mfma_f32_16x16x32_bf16 v[0:3], v[176:179], v[108:111], v[0:3]
    ds_read_b64_tr_b16 v[200:201], v214 offset:57344
    v_mfma_f32_16x16x32_bf16 v[4:7], v[176:179], v[112:115], v[4:7]
    ds_read_b64_tr_b16 v[202:203], v214 offset:58368
    v_mfma_f32_16x16x32_bf16 v[8:11], v[176:179], v[116:119], v[8:11]
    v_mfma_f32_16x16x32_bf16 v[12:15], v[180:183], v[108:111], v[12:15]
    ds_read_b64_tr_b16 v[204:205], v215 offset:57344
    v_mfma_f32_16x16x32_bf16 v[16:19], v[180:183], v[112:115], v[16:19]
    ds_read_b64_tr_b16 v[206:207], v215 offset:58368
    v_mfma_f32_16x16x32_bf16 v[20:23], v[180:183], v[116:119], v[20:23]
    s_waitcnt lgkmcnt(6)
    s_add_u32 m0, s29, 6144
    s_mov_b32 s30, 1152
    buffer_load_dwordx4 v220, s[4:7], s30 offen lds
    buffer_load_dwordx4 v221, s[4:7], s30 offen offset:1024 lds
    v_mfma_f32_16x16x32_bf16 v[24:27], v[184:187], v[108:111], v[24:27]
    v_mfma_f32_16x16x32_bf16 v[28:31], v[184:187], v[112:115], v[28:31]
    v_mfma_f32_16x16x32_bf16 v[32:35], v[184:187], v[116:119], v[32:35]
    v_mfma_f32_16x16x32_bf16 v[36:39], v[188:191], v[108:111], v[36:39]
    v_mfma_f32_16x16x32_bf16 v[40:43], v[188:191], v[112:115], v[40:43]
    v_mfma_f32_16x16x32_bf16 v[44:47], v[188:191], v[116:119], v[44:47]
    s_waitcnt lgkmcnt(0)
    s_barrier
    v_mfma_f32_16x16x32_bf16 v[48:51], v[192:195], v[108:111], v[48:51]
    ds_read_b64_tr_b16 v[176:177], v208 offset:0
    ds_read_b64_tr_b16 v[178:179], v208 offset:1024
    v_mfma_f32_16x16x32_bf16 v[52:55], v[192:195], v[112:115], v[52:55]
    ds_read_b64_tr_b16 v[180:181], v209 offset:0
    ds_read_b64_tr_b16 v[182:183], v209 offset:1024
    v_mfma_f32_16x16x32_bf16 v[56:59], v[192:195], v[116:119], v[56:59]
    s_add_u32 m0, s59, 16384
    s_add_u32 s54, s55, 4718592
    buffer_load_dwordx4 v216, s[8:11], s54 offen offset:0 lds
    v_mfma_f32_16x16x32_bf16 v[60:63], v[196:199], v[108:111], v[60:63]
    ds_read_b64_tr_b16 v[184:185], v210 offset:0
    ds_read_b64_tr_b16 v[186:187], v210 offset:1024
    v_mfma_f32_16x16x32_bf16 v[64:67], v[196:199], v[112:115], v[64:67]
    ds_read_b64_tr_b16 v[188:189], v211 offset:0
    ds_read_b64_tr_b16 v[190:191], v211 offset:1024
    v_mfma_f32_16x16x32_bf16 v[68:71], v[196:199], v[116:119], v[68:71]
    s_add_u32 s54, s55, 4750336
    buffer_load_dwordx4 v216, s[8:11], s54 offen offset:1024 lds
    v_mfma_f32_16x16x32_bf16 v[72:75], v[200:203], v[108:111], v[72:75]
    ds_read_b64_tr_b16 v[192:193], v212 offset:0
    v_mfma_f32_16x16x32_bf16 v[76:79], v[200:203], v[112:115], v[76:79]
    ds_read_b64_tr_b16 v[194:195], v212 offset:1024
    v_mfma_f32_16x16x32_bf16 v[80:83], v[200:203], v[116:119], v[80:83]
    s_add_u32 s54, s55, 4782080
    buffer_load_dwordx4 v217, s[8:11], s54 offen offset:2048 lds
    v_mfma_f32_16x16x32_bf16 v[84:87], v[204:207], v[108:111], v[84:87]
    ds_read_b64_tr_b16 v[196:197], v213 offset:0
    v_mfma_f32_16x16x32_bf16 v[88:91], v[204:207], v[112:115], v[88:91]
    ds_read_b64_tr_b16 v[198:199], v213 offset:1024
    v_mfma_f32_16x16x32_bf16 v[92:95], v[204:207], v[116:119], v[92:95]
    s_add_u32 s54, s55, 4813824
    buffer_load_dwordx4 v217, s[8:11], s54 offen offset:3072 lds
    s_waitcnt lgkmcnt(10)
    v_mfma_f32_16x16x32_bf16 v[0:3], v[176:179], v[120:123], v[0:3]
    ds_read_b64_tr_b16 v[200:201], v214 offset:0
    v_mfma_f32_16x16x32_bf16 v[4:7], v[176:179], v[124:127], v[4:7]
    ds_read_b64_tr_b16 v[202:203], v214 offset:1024
    v_mfma_f32_16x16x32_bf16 v[8:11], v[176:179], v[128:131], v[8:11]
    s_waitcnt lgkmcnt(10)
    v_mfma_f32_16x16x32_bf16 v[12:15], v[180:183], v[120:123], v[12:15]
    s_waitcnt vmcnt(14)
    ds_read_b128 v[96:99], v222 offset:0
    ds_read_b128 v[108:111], v223 offset:0
    v_mfma_f32_16x16x32_bf16 v[16:19], v[180:183], v[124:127], v[16:19]
    ds_read_b64_tr_b16 v[204:205], v215 offset:0
    v_mfma_f32_16x16x32_bf16 v[20:23], v[180:183], v[128:131], v[20:23]
    ds_read_b64_tr_b16 v[206:207], v215 offset:1024
    s_waitcnt lgkmcnt(12)
    v_mfma_f32_16x16x32_bf16 v[24:27], v[184:187], v[120:123], v[24:27]
    ds_read_b64_tr_b16 v[176:177], v208 offset:40960
    v_mfma_f32_16x16x32_bf16 v[28:31], v[184:187], v[124:127], v[28:31]
    ds_read_b64_tr_b16 v[178:179], v208 offset:41984
    v_mfma_f32_16x16x32_bf16 v[32:35], v[184:187], v[128:131], v[32:35]
    s_waitcnt lgkmcnt(12)
    v_mfma_f32_16x16x32_bf16 v[36:39], v[188:191], v[120:123], v[36:39]
    ds_read_b64_tr_b16 v[180:181], v209 offset:40960
    v_mfma_f32_16x16x32_bf16 v[40:43], v[188:191], v[124:127], v[40:43]
    ds_read_b64_tr_b16 v[182:183], v209 offset:41984
    v_mfma_f32_16x16x32_bf16 v[44:47], v[188:191], v[128:131], v[44:47]
    s_waitcnt lgkmcnt(6)
    s_add_u32 m0, s29, 0
    s_mov_b32 s30, 21632
    buffer_load_dwordx4 v220, s[4:7], s30 offen lds
    buffer_load_dwordx4 v221, s[4:7], s30 offen offset:1024 lds
    v_mfma_f32_16x16x32_bf16 v[48:51], v[192:195], v[120:123], v[48:51]
    s_waitcnt vmcnt(10)
    ds_read_b128 v[100:103], v222 offset:2048
    ds_read_b128 v[112:115], v223 offset:2048
    v_mfma_f32_16x16x32_bf16 v[52:55], v[192:195], v[124:127], v[52:55]
    ds_read_b64_tr_b16 v[184:185], v210 offset:40960
    v_mfma_f32_16x16x32_bf16 v[56:59], v[192:195], v[128:131], v[56:59]
    ds_read_b64_tr_b16 v[186:187], v210 offset:41984
    v_mfma_f32_16x16x32_bf16 v[60:63], v[196:199], v[120:123], v[60:63]
    ds_read_b64_tr_b16 v[188:189], v211 offset:40960
    v_mfma_f32_16x16x32_bf16 v[64:67], v[196:199], v[124:127], v[64:67]
    ds_read_b64_tr_b16 v[190:191], v211 offset:41984
    v_mfma_f32_16x16x32_bf16 v[68:71], v[196:199], v[128:131], v[68:71]
    v_mfma_f32_16x16x32_bf16 v[72:75], v[200:203], v[120:123], v[72:75]
    ds_read_b64_tr_b16 v[192:193], v212 offset:40960
    v_mfma_f32_16x16x32_bf16 v[76:79], v[200:203], v[124:127], v[76:79]
    ds_read_b64_tr_b16 v[194:195], v212 offset:41984
    v_mfma_f32_16x16x32_bf16 v[80:83], v[200:203], v[128:131], v[80:83]
    s_waitcnt lgkmcnt(6)
    s_add_u32 m0, s29, 2048
    s_mov_b32 s30, 42112
    buffer_load_dwordx4 v220, s[4:7], s30 offen lds
    buffer_load_dwordx4 v221, s[4:7], s30 offen offset:1024 lds
    v_mfma_f32_16x16x32_bf16 v[84:87], v[204:207], v[120:123], v[84:87]
    s_waitcnt vmcnt(10)
    ds_read_b128 v[104:107], v222 offset:4096
    ds_read_b128 v[116:119], v223 offset:4096
    v_mfma_f32_16x16x32_bf16 v[88:91], v[204:207], v[124:127], v[88:91]
    ds_read_b64_tr_b16 v[196:197], v213 offset:40960
    v_mfma_f32_16x16x32_bf16 v[92:95], v[204:207], v[128:131], v[92:95]
    ds_read_b64_tr_b16 v[198:199], v213 offset:41984
    v_mfma_f32_16x16x32_bf16 v[0:3], v[176:179], v[132:135], v[0:3]
    ds_read_b64_tr_b16 v[200:201], v214 offset:40960
    v_mfma_f32_16x16x32_bf16 v[4:7], v[176:179], v[136:139], v[4:7]
    ds_read_b64_tr_b16 v[202:203], v214 offset:41984
    v_mfma_f32_16x16x32_bf16 v[8:11], v[176:179], v[140:143], v[8:11]
    v_mfma_f32_16x16x32_bf16 v[12:15], v[180:183], v[132:135], v[12:15]
    ds_read_b64_tr_b16 v[204:205], v215 offset:40960
    v_mfma_f32_16x16x32_bf16 v[16:19], v[180:183], v[136:139], v[16:19]
    ds_read_b64_tr_b16 v[206:207], v215 offset:41984
    v_mfma_f32_16x16x32_bf16 v[20:23], v[180:183], v[140:143], v[20:23]
    s_waitcnt lgkmcnt(6)
    v_mfma_f32_16x16x32_bf16 v[24:27], v[184:187], v[132:135], v[24:27]
    v_mfma_f32_16x16x32_bf16 v[28:31], v[184:187], v[136:139], v[28:31]
    v_mfma_f32_16x16x32_bf16 v[32:35], v[184:187], v[140:143], v[32:35]
    v_mfma_f32_16x16x32_bf16 v[36:39], v[188:191], v[132:135], v[36:39]
    v_mfma_f32_16x16x32_bf16 v[40:43], v[188:191], v[136:139], v[40:43]
    v_mfma_f32_16x16x32_bf16 v[44:47], v[188:191], v[140:143], v[44:47]
    s_waitcnt lgkmcnt(0)
    s_barrier
    v_mfma_f32_16x16x32_bf16 v[48:51], v[192:195], v[132:135], v[48:51]
    ds_read_b64_tr_b16 v[176:177], v208 offset:8192
    ds_read_b64_tr_b16 v[178:179], v208 offset:9216
    v_mfma_f32_16x16x32_bf16 v[52:55], v[192:195], v[136:139], v[52:55]
    ds_read_b64_tr_b16 v[180:181], v209 offset:8192
    ds_read_b64_tr_b16 v[182:183], v209 offset:9216
    v_mfma_f32_16x16x32_bf16 v[56:59], v[192:195], v[140:143], v[56:59]
    s_add_u32 m0, s56, 0
    s_add_u32 s26, s27, 0
    s_and_b32 s26, s26, 0x3ffff
    buffer_load_dwordx4 v248, s[12:15], s26 offen nt lds
    v_mfma_f32_16x16x32_bf16 v[60:63], v[196:199], v[132:135], v[60:63]
    ds_read_b64_tr_b16 v[184:185], v210 offset:8192
    ds_read_b64_tr_b16 v[186:187], v210 offset:9216
    v_mfma_f32_16x16x32_bf16 v[64:67], v[196:199], v[136:139], v[64:67]
    ds_read_b64_tr_b16 v[188:189], v211 offset:8192
    ds_read_b64_tr_b16 v[190:191], v211 offset:9216
    v_mfma_f32_16x16x32_bf16 v[68:71], v[196:199], v[140:143], v[68:71]
    buffer_load_dwordx4 v249, s[12:15], s26 offen offset:1024 nt lds
    v_mfma_f32_16x16x32_bf16 v[72:75], v[200:203], v[132:135], v[72:75]
    ds_read_b64_tr_b16 v[192:193], v212 offset:8192
    v_mfma_f32_16x16x32_bf16 v[76:79], v[200:203], v[136:139], v[76:79]
    ds_read_b64_tr_b16 v[194:195], v212 offset:9216
    v_mfma_f32_16x16x32_bf16 v[80:83], v[200:203], v[140:143], v[80:83]
    s_add_u32 m0, s56, 40960
    s_nop 0
    buffer_load_dwordx4 v248, s[16:19], s26 offen nt lds
    v_mfma_f32_16x16x32_bf16 v[84:87], v[204:207], v[132:135], v[84:87]
    ds_read_b64_tr_b16 v[196:197], v213 offset:8192
    v_mfma_f32_16x16x32_bf16 v[88:91], v[204:207], v[136:139], v[88:91]
    ds_read_b64_tr_b16 v[198:199], v213 offset:9216
    v_mfma_f32_16x16x32_bf16 v[92:95], v[204:207], v[140:143], v[92:95]
    buffer_load_dwordx4 v249, s[16:19], s26 offen offset:1024 nt lds
    s_waitcnt lgkmcnt(10)
    v_mfma_f32_16x16x32_bf16 v[0:3], v[176:179], v[96:99], v[0:3]
    ds_read_b64_tr_b16 v[200:201], v214 offset:8192
    v_mfma_f32_16x16x32_bf16 v[4:7], v[176:179], v[100:103], v[4:7]
    ds_read_b64_tr_b16 v[202:203], v214 offset:9216
    v_mfma_f32_16x16x32_bf16 v[8:11], v[176:179], v[104:107], v[8:11]
    s_waitcnt lgkmcnt(10)
    v_mfma_f32_16x16x32_bf16 v[12:15], v[180:183], v[96:99], v[12:15]
    s_waitcnt vmcnt(12)
    ds_read_b128 v[120:123], v222 offset:6144
    ds_read_b128 v[132:135], v223 offset:6144
    v_mfma_f32_16x16x32_bf16 v[16:19], v[180:183], v[100:103], v[16:19]
    ds_read_b64_tr_b16 v[204:205], v215 offset:8192
    v_mfma_f32_16x16x32_bf16 v[20:23], v[180:183], v[104:107], v[20:23]
    ds_read_b64_tr_b16 v[206:207], v215 offset:9216
    s_waitcnt lgkmcnt(12)
    v_mfma_f32_16x16x32_bf16 v[24:27], v[184:187], v[96:99], v[24:27]
    ds_read_b64_tr_b16 v[176:177], v208 offset:49152
    v_mfma_f32_16x16x32_bf16 v[28:31], v[184:187], v[100:103], v[28:31]
    ds_read_b64_tr_b16 v[178:179], v208 offset:50176
    v_mfma_f32_16x16x32_bf16 v[32:35], v[184:187], v[104:107], v[32:35]
    s_waitcnt lgkmcnt(12)
    v_mfma_f32_16x16x32_bf16 v[36:39], v[188:191], v[96:99], v[36:39]
    ds_read_b64_tr_b16 v[180:181], v209 offset:49152
    v_mfma_f32_16x16x32_bf16 v[40:43], v[188:191], v[100:103], v[40:43]
    ds_read_b64_tr_b16 v[182:183], v209 offset:50176
    v_mfma_f32_16x16x32_bf16 v[44:47], v[188:191], v[104:107], v[44:47]
    s_waitcnt lgkmcnt(6)
    v_mfma_f32_16x16x32_bf16 v[48:51], v[192:195], v[96:99], v[48:51]
    s_waitcnt vmcnt(6)
    ds_read_b128 v[124:127], v222 offset:0
    ds_read_b128 v[136:139], v223 offset:0
    v_mfma_f32_16x16x32_bf16 v[52:55], v[192:195], v[100:103], v[52:55]
    ds_read_b64_tr_b16 v[184:185], v210 offset:49152
    v_mfma_f32_16x16x32_bf16 v[56:59], v[192:195], v[104:107], v[56:59]
    ds_read_b64_tr_b16 v[186:187], v210 offset:50176
    v_mfma_f32_16x16x32_bf16 v[60:63], v[196:199], v[96:99], v[60:63]
    ds_read_b64_tr_b16 v[188:189], v211 offset:49152
    v_mfma_f32_16x16x32_bf16 v[64:67], v[196:199], v[100:103], v[64:67]
    ds_read_b64_tr_b16 v[190:191], v211 offset:50176
    v_mfma_f32_16x16x32_bf16 v[68:71], v[196:199], v[104:107], v[68:71]
    v_mfma_f32_16x16x32_bf16 v[72:75], v[200:203], v[96:99], v[72:75]
    ds_read_b64_tr_b16 v[192:193], v212 offset:49152
    v_mfma_f32_16x16x32_bf16 v[76:79], v[200:203], v[100:103], v[76:79]
    ds_read_b64_tr_b16 v[194:195], v212 offset:50176
    v_mfma_f32_16x16x32_bf16 v[80:83], v[200:203], v[104:107], v[80:83]
    s_waitcnt lgkmcnt(6)
    v_mfma_f32_16x16x32_bf16 v[84:87], v[204:207], v[96:99], v[84:87]
    s_waitcnt vmcnt(4)
    ds_read_b128 v[128:131], v222 offset:2048
    ds_read_b128 v[140:143], v223 offset:2048
    v_mfma_f32_16x16x32_bf16 v[88:91], v[204:207], v[100:103], v[88:91]
    ds_read_b64_tr_b16 v[196:197], v213 offset:49152
    v_mfma_f32_16x16x32_bf16 v[92:95], v[204:207], v[104:107], v[92:95]
    ds_read_b64_tr_b16 v[198:199], v213 offset:50176
    v_mfma_f32_16x16x32_bf16 v[0:3], v[176:179], v[108:111], v[0:3]
    ds_read_b64_tr_b16 v[200:201], v214 offset:49152
    v_mfma_f32_16x16x32_bf16 v[4:7], v[176:179], v[112:115], v[4:7]
    ds_read_b64_tr_b16 v[202:203], v214 offset:50176
    v_mfma_f32_16x16x32_bf16 v[8:11], v[176:179], v[116:119], v[8:11]
    v_mfma_f32_16x16x32_bf16 v[12:15], v[180:183], v[108:111], v[12:15]
    ds_read_b64_tr_b16 v[204:205], v215 offset:49152
    v_mfma_f32_16x16x32_bf16 v[16:19], v[180:183], v[112:115], v[16:19]
    ds_read_b64_tr_b16 v[206:207], v215 offset:50176
    v_mfma_f32_16x16x32_bf16 v[20:23], v[180:183], v[116:119], v[20:23]
    s_waitcnt lgkmcnt(6)
    v_mfma_f32_16x16x32_bf16 v[24:27], v[184:187], v[108:111], v[24:27]
    v_mfma_f32_16x16x32_bf16 v[28:31], v[184:187], v[112:115], v[28:31]
    v_mfma_f32_16x16x32_bf16 v[32:35], v[184:187], v[116:119], v[32:35]
    v_mfma_f32_16x16x32_bf16 v[36:39], v[188:191], v[108:111], v[36:39]
    v_mfma_f32_16x16x32_bf16 v[40:43], v[188:191], v[112:115], v[40:43]
    v_mfma_f32_16x16x32_bf16 v[44:47], v[188:191], v[116:119], v[44:47]
    s_waitcnt lgkmcnt(0)
    s_barrier
    v_mfma_f32_16x16x32_bf16 v[48:51], v[192:195], v[108:111], v[48:51]
    ds_read_b64_tr_b16 v[176:177], v208 offset:16384
    ds_read_b64_tr_b16 v[178:179], v208 offset:17408
    v_mfma_f32_16x16x32_bf16 v[52:55], v[192:195], v[112:115], v[52:55]
    ds_read_b64_tr_b16 v[180:181], v209 offset:16384
    ds_read_b64_tr_b16 v[182:183], v209 offset:17408
    v_mfma_f32_16x16x32_bf16 v[56:59], v[192:195], v[116:119], v[56:59]
    s_add_u32 m0, s56, 8192
    s_add_u32 s26, s27, 8192
    s_and_b32 s26, s26, 0x3ffff
    buffer_load_dwordx4 v248, s[12:15], s26 offen nt lds
    v_mfma_f32_16x16x32_bf16 v[60:63], v[196:199], v[108:111], v[60:63]
    ds_read_b64_tr_b16 v[184:185], v210 offset:16384
    ds_read_b64_tr_b16 v[186:187], v210 offset:17408
    v_mfma_f32_16x16x32_bf16 v[64:67], v[196:199], v[112:115], v[64:67]
    ds_read_b64_tr_b16 v[188:189], v211 offset:16384
    ds_read_b64_tr_b16 v[190:191], v211 offset:17408
    v_mfma_f32_16x16x32_bf16 v[68:71], v[196:199], v[116:119], v[68:71]
    buffer_load_dwordx4 v249, s[12:15], s26 offen offset:1024 nt lds
    v_mfma_f32_16x16x32_bf16 v[72:75], v[200:203], v[108:111], v[72:75]
    ds_read_b64_tr_b16 v[192:193], v212 offset:16384
    v_mfma_f32_16x16x32_bf16 v[76:79], v[200:203], v[112:115], v[76:79]
    ds_read_b64_tr_b16 v[194:195], v212 offset:17408
    v_mfma_f32_16x16x32_bf16 v[80:83], v[200:203], v[116:119], v[80:83]
    s_add_u32 m0, s56, 49152
    s_nop 0
    buffer_load_dwordx4 v248, s[16:19], s26 offen nt lds
    v_mfma_f32_16x16x32_bf16 v[84:87], v[204:207], v[108:111], v[84:87]
    ds_read_b64_tr_b16 v[196:197], v213 offset:16384
    v_mfma_f32_16x16x32_bf16 v[88:91], v[204:207], v[112:115], v[88:91]
    ds_read_b64_tr_b16 v[198:199], v213 offset:17408
    v_mfma_f32_16x16x32_bf16 v[92:95], v[204:207], v[116:119], v[92:95]
    buffer_load_dwordx4 v249, s[16:19], s26 offen offset:1024 nt lds
    s_waitcnt lgkmcnt(10)
    v_mfma_f32_16x16x32_bf16 v[0:3], v[176:179], v[120:123], v[0:3]
    ds_read_b64_tr_b16 v[200:201], v214 offset:16384
    v_mfma_f32_16x16x32_bf16 v[4:7], v[176:179], v[124:127], v[4:7]
    ds_read_b64_tr_b16 v[202:203], v214 offset:17408
    v_mfma_f32_16x16x32_bf16 v[8:11], v[176:179], v[128:131], v[8:11]
    s_waitcnt lgkmcnt(10)
    v_mfma_f32_16x16x32_bf16 v[12:15], v[180:183], v[120:123], v[12:15]
    ds_read_b64_tr_b16 v[204:205], v215 offset:16384
    v_mfma_f32_16x16x32_bf16 v[16:19], v[180:183], v[124:127], v[16:19]
    ds_read_b64_tr_b16 v[206:207], v215 offset:17408
    v_mfma_f32_16x16x32_bf16 v[20:23], v[180:183], v[128:131], v[20:23]
    s_waitcnt lgkmcnt(10)
    v_mfma_f32_16x16x32_bf16 v[24:27], v[184:187], v[120:123], v[24:27]
    ds_read_b64_tr_b16 v[176:177], v208 offset:57344
    v_mfma_f32_16x16x32_bf16 v[28:31], v[184:187], v[124:127], v[28:31]
    ds_read_b64_tr_b16 v[178:179], v208 offset:58368
    v_mfma_f32_16x16x32_bf16 v[32:35], v[184:187], v[128:131], v[32:35]
    s_waitcnt lgkmcnt(10)
    v_mfma_f32_16x16x32_bf16 v[36:39], v[188:191], v[120:123], v[36:39]
    ds_read_b64_tr_b16 v[180:181], v209 offset:57344
    v_mfma_f32_16x16x32_bf16 v[40:43], v[188:191], v[124:127], v[40:43]
    ds_read_b64_tr_b16 v[182:183], v209 offset:58368
    v_mfma_f32_16x16x32_bf16 v[44:47], v[188:191], v[128:131], v[44:47]
    s_waitcnt lgkmcnt(10)
    v_mfma_f32_16x16x32_bf16 v[48:51], v[192:195], v[120:123], v[48:51]
    ds_read_b64_tr_b16 v[184:185], v210 offset:57344
    v_mfma_f32_16x16x32_bf16 v[52:55], v[192:195], v[124:127], v[52:55]
    ds_read_b64_tr_b16 v[186:187], v210 offset:58368
    v_mfma_f32_16x16x32_bf16 v[56:59], v[192:195], v[128:131], v[56:59]
    s_waitcnt lgkmcnt(10)
    v_mfma_f32_16x16x32_bf16 v[60:63], v[196:199], v[120:123], v[60:63]
    ds_read_b64_tr_b16 v[188:189], v211 offset:57344
    v_mfma_f32_16x16x32_bf16 v[64:67], v[196:199], v[124:127], v[64:67]
    ds_read_b64_tr_b16 v[190:191], v211 offset:58368
    v_mfma_f32_16x16x32_bf16 v[68:71], v[196:199], v[128:131], v[68:71]
    s_waitcnt lgkmcnt(10)
    v_mfma_f32_16x16x32_bf16 v[72:75], v[200:203], v[120:123], v[72:75]
    ds_read_b64_tr_b16 v[192:193], v212 offset:57344
    v_mfma_f32_16x16x32_bf16 v[76:79], v[200:203], v[124:127], v[76:79]
    ds_read_b64_tr_b16 v[194:195], v212 offset:58368
    v_mfma_f32_16x16x32_bf16 v[80:83], v[200:203], v[128:131], v[80:83]
    s_waitcnt lgkmcnt(10)
    v_mfma_f32_16x16x32_bf16 v[84:87], v[204:207], v[120:123], v[84:87]
    ds_read_b64_tr_b16 v[196:197], v213 offset:57344
    v_mfma_f32_16x16x32_bf16 v[88:91], v[204:207], v[124:127], v[88:91]
    ds_read_b64_tr_b16 v[198:199], v213 offset:58368
    v_mfma_f32_16x16x32_bf16 v[92:95], v[204:207], v[128:131], v[92:95]
    s_waitcnt lgkmcnt(10)
    v_mfma_f32_16x16x32_bf16 v[0:3], v[176:179], v[132:135], v[0:3]
    ds_read_b64_tr_b16 v[200:201], v214 offset:57344
    v_mfma_f32_16x16x32_bf16 v[4:7], v[176:179], v[136:139], v[4:7]
    ds_read_b64_tr_b16 v[202:203], v214 offset:58368
    v_mfma_f32_16x16x32_bf16 v[8:11], v[176:179], v[140:143], v[8:11]
    s_waitcnt lgkmcnt(10)
    v_mfma_f32_16x16x32_bf16 v[12:15], v[180:183], v[132:135], v[12:15]
    ds_read_b64_tr_b16 v[204:205], v215 offset:57344
    v_mfma_f32_16x16x32_bf16 v[16:19], v[180:183], v[136:139], v[16:19]
    ds_read_b64_tr_b16 v[206:207], v215 offset:58368
    v_mfma_f32_16x16x32_bf16 v[20:23], v[180:183], v[140:143], v[20:23]
    s_waitcnt lgkmcnt(10)
    v_mfma_f32_16x16x32_bf16 v[24:27], v[184:187], v[132:135], v[24:27]
    v_mfma_f32_16x16x32_bf16 v[28:31], v[184:187], v[136:139], v[28:31]
    v_mfma_f32_16x16x32_bf16 v[32:35], v[184:187], v[140:143], v[32:35]
    s_waitcnt lgkmcnt(8)
    v_mfma_f32_16x16x32_bf16 v[36:39], v[188:191], v[132:135], v[36:39]
    v_mfma_f32_16x16x32_bf16 v[40:43], v[188:191], v[136:139], v[40:43]
    v_mfma_f32_16x16x32_bf16 v[44:47], v[188:191], v[140:143], v[44:47]
    s_waitcnt vmcnt(4) lgkmcnt(0)
    s_barrier
    v_mfma_f32_16x16x32_bf16 v[48:51], v[192:195], v[132:135], v[48:51]
    ds_read_b128 v[144:147], v242 offset:0
    ds_read_b128 v[160:163], v242 offset:4096
    v_mfma_f32_16x16x32_bf16 v[52:55], v[192:195], v[136:139], v[52:55]
    s_add_u32 m0, s56, 16384
    s_add_u32 s26, s27, 16384
    s_and_b32 s26, s26, 0x3ffff
    buffer_load_dwordx4 v248, s[12:15], s26 offen nt lds
    buffer_load_dwordx4 v249, s[12:15], s26 offen offset:1024 nt lds
    v_mfma_f32_16x16x32_bf16 v[56:59], v[192:195], v[140:143], v[56:59]
    s_add_u32 m0, s56, 57344
    s_nop 0
    buffer_load_dwordx4 v248, s[16:19], s26 offen nt lds
    v_mfma_f32_16x16x32_bf16 v[60:63], v[196:199], v[132:135], v[60:63]
    ds_read_b128 v[148:151], v243 offset:0
    ds_read_b128 v[164:167], v243 offset:4096
    v_mfma_f32_16x16x32_bf16 v[64:67], v[196:199], v[136:139], v[64:67]
    buffer_load_dwordx4 v249, s[16:19], s26 offen offset:1024 nt lds
    s_add_u32 m0, s56, 24576
    s_add_u32 s26, s27, 24576
    s_and_b32 s26, s26, 0x3ffff
    buffer_load_dwordx4 v248, s[12:15], s26 offen nt lds
    v_mfma_f32_16x16x32_bf16 v[68:71], v[196:199], v[140:143], v[68:71]
    buffer_load_dwordx4 v249, s[12:15], s26 offen offset:1024 nt lds
    v_mfma_f32_16x16x32_bf16 v[72:75], v[200:203], v[132:135], v[72:75]
    ds_read_b128 v[152:155], v242 offset:512
    ds_read_b128 v[168:171], v242 offset:4608
    v_mfma_f32_16x16x32_bf16 v[76:79], v[200:203], v[136:139], v[76:79]
    s_add_u32 m0, s56, 65536
    s_nop 0
    buffer_load_dwordx4 v248, s[16:19], s26 offen nt lds
    buffer_load_dwordx4 v249, s[16:19], s26 offen offset:1024 nt lds
    v_mfma_f32_16x16x32_bf16 v[80:83], v[200:203], v[140:143], v[80:83]
    s_add_u32 m0, s56, 32768
    s_add_u32 s26, s27, 32768
    s_and_b32 s26, s26, 0x3ffff
    buffer_load_dwordx4 v248, s[12:15], s26 offen nt lds
    v_mfma_f32_16x16x32_bf16 v[84:87], v[204:207], v[132:135], v[84:87]
    ds_read_b128 v[156:159], v243 offset:512
    ds_read_b128 v[172:175], v243 offset:4608
    v_mfma_f32_16x16x32_bf16 v[88:91], v[204:207], v[136:139], v[88:91]
    buffer_load_dwordx4 v249, s[12:15], s26 offen offset:1024 nt lds
    s_add_u32 m0, s56, 73728
    s_nop 0
    buffer_load_dwordx4 v248, s[16:19], s26 offen nt lds
    v_mfma_f32_16x16x32_bf16 v[92:95], v[204:207], v[140:143], v[92:95]
    buffer_load_dwordx4 v249, s[16:19], s26 offen offset:1024 nt lds
    s_setprio 1
    s_cmp_lt_u32 s2, 256
    s_cbranch_scc0 K1_pr1
    s_setprio 0
K1_pr1:
    ds_read_b64_tr_b16 v[176:177], v244 offset:0
    ds_read_b64_tr_b16 v[178:179], v244 offset:4096
    ds_read_b64_tr_b16 v[180:181], v245 offset:0
    ds_read_b64_tr_b16 v[182:183], v245 offset:4096
    ds_read_b64_tr_b16 v[184:185], v246 offset:0
    ds_read_b64_tr_b16 v[186:187], v246 offset:4096
    ds_read_b64_tr_b16 v[188:189], v247 offset:0
    ds_read_b64_tr_b16 v[190:191], v247 offset:4096
    ds_read_b64_tr_b16 v[192:193], v244 offset:512
    ds_read_b64_tr_b16 v[194:195], v244 offset:4608
    ds_read_b64_tr_b16 v[196:197], v245 offset:512
    ds_read_b64_tr_b16 v[198:199], v245 offset:4608
    ds_read_b64_tr_b16 v[200:201], v246 offset:512
    ds_read_b64_tr_b16 v[202:203], v246 offset:4608
    ds_read_b64_tr_b16 v[204:205], v247 offset:512
    ds_read_b64_tr_b16 v[206:207], v247 offset:4608
    s_mov_b32 s54, 1040356334
    s_mov_b32 s55, s54
    v_pk_mul_f32 v[0:1], v[0:1], s[54:55]
    v_pk_mul_f32 v[2:3], v[2:3], s[54:55]
    v_pk_mul_f32 v[12:13], v[12:13], s[54:55]
    v_pk_mul_f32 v[14:15], v[14:15], s[54:55]
    v_cvt_pk_bf16_f32 v96, v0, v1
    v_cvt_pk_bf16_f32 v97, v2, v3
    v_cvt_pk_bf16_f32 v98, v12, v13
    v_cvt_pk_bf16_f32 v99, v14, v15
    v_pk_mul_f32 v[24:25], v[24:25], s[54:55]
    v_pk_mul_f32 v[26:27], v[26:27], s[54:55]
    v_pk_mul_f32 v[36:37], v[36:37], s[54:55]
    v_pk_mul_f32 v[38:39], v[38:39], s[54:55]
    v_cvt_pk_bf16_f32 v100, v24, v25
    v_cvt_pk_bf16_f32 v101, v26, v27
    v_cvt_pk_bf16_f32 v102, v36, v37
    v_cvt_pk_bf16_f32 v103, v38, v39
    v_pk_mul_f32 v[48:49], v[48:49], s[54:55]
    v_pk_mul_f32 v[50:51], v[50:51], s[54:55]
    v_pk_mul_f32 v[60:61], v[60:61], s[54:55]
    v_pk_mul_f32 v[62:63], v[62:63], s[54:55]
    v_cvt_pk_bf16_f32 v104, v48, v49
    v_cvt_pk_bf16_f32 v105, v50, v51
    v_cvt_pk_bf16_f32 v106, v60, v61
    v_cvt_pk_bf16_f32 v107, v62, v63
    v_pk_mul_f32 v[72:73], v[72:73], s[54:55]
    v_pk_mul_f32 v[74:75], v[74:75], s[54:55]
    v_pk_mul_f32 v[84:85], v[84:85], s[54:55]
    v_pk_mul_f32 v[86:87], v[86:87], s[54:55]
    v_cvt_pk_bf16_f32 v108, v72, v73
    v_cvt_pk_bf16_f32 v109, v74, v75
    v_cvt_pk_bf16_f32 v110, v84, v85
    v_cvt_pk_bf16_f32 v111, v86, v87
    v_permlane32_swap_b32 v96, v98
    v_permlane32_swap_b32 v97, v99
    v_permlane32_swap_b32 v100, v102
    v_permlane32_swap_b32 v101, v103
    v_permlane32_swap_b32 v104, v106
    v_permlane32_swap_b32 v105, v107
    v_permlane32_swap_b32 v108, v110
    v_permlane32_swap_b32 v109, v111
    v_permlane16_swap_b32 v96, v98
    v_permlane16_swap_b32 v97, v99
    v_permlane16_swap_b32 v100, v102
    v_permlane16_swap_b32 v101, v103
    v_permlane16_swap_b32 v104, v106
    v_permlane16_swap_b32 v105, v107
    v_permlane16_swap_b32 v108, v110
    v_permlane16_swap_b32 v109, v111
    v_pk_mul_f32 v[4:5], v[4:5], s[54:55]
    v_pk_mul_f32 v[6:7], v[6:7], s[54:55]
    v_pk_mul_f32 v[16:17], v[16:17], s[54:55]
    v_pk_mul_f32 v[18:19], v[18:19], s[54:55]
    v_cvt_pk_bf16_f32 v112, v4, v5
    v_cvt_pk_bf16_f32 v113, v6, v7
    v_cvt_pk_bf16_f32 v114, v16, v17
    v_cvt_pk_bf16_f32 v115, v18, v19
    v_pk_mul_f32 v[28:29], v[28:29], s[54:55]
    v_pk_mul_f32 v[30:31], v[30:31], s[54:55]
    v_pk_mul_f32 v[40:41], v[40:41], s[54:55]
    v_pk_mul_f32 v[42:43], v[42:43], s[54:55]
    v_cvt_pk_bf16_f32 v116, v28, v29
    v_cvt_pk_bf16_f32 v117, v30, v31
    v_cvt_pk_bf16_f32 v118, v40, v41
    v_cvt_pk_bf16_f32 v119, v42, v43
    v_pk_mul_f32 v[52:53], v[52:53], s[54:55]
    v_pk_mul_f32 v[54:55], v[54:55], s[54:55]
    v_pk_mul_f32 v[64:65], v[64:65], s[54:55]
    v_pk_mul_f32 v[66:67], v[66:67], s[54:55]
    v_cvt_pk_bf16_f32 v120, v52, v53
    v_cvt_pk_bf16_f32 v121, v54, v55
    v_cvt_pk_bf16_f32 v122, v64, v65
    v_cvt_pk_bf16_f32 v123, v66, v67
    v_pk_mul_f32 v[76:77], v[76:77], s[54:55]
    v_pk_mul_f32 v[78:79], v[78:79], s[54:55]
    v_pk_mul_f32 v[88:89], v[88:89], s[54:55]
    v_pk_mul_f32 v[90:91], v[90:91], s[54:55]
    v_cvt_pk_bf16_f32 v124, v76, v77
    v_cvt_pk_bf16_f32 v125, v78, v79
    v_cvt_pk_bf16_f32 v126, v88, v89
    v_cvt_pk_bf16_f32 v127, v90, v91
    v_permlane32_swap_b32 v112, v114
    v_permlane32_swap_b32 v113, v115
    v_permlane32_swap_b32 v116, v118
    v_permlane32_swap_b32 v117, v119
    v_permlane32_swap_b32 v120, v122
    v_permlane32_swap_b32 v121, v123
    v_permlane32_swap_b32 v124, v126
    v_permlane32_swap_b32 v125, v127
    v_permlane16_swap_b32 v112, v114
    v_permlane16_swap_b32 v113, v115
    v_permlane16_swap_b32 v116, v118
    v_permlane16_swap_b32 v117, v119
    v_permlane16_swap_b32 v120, v122
    v_permlane16_swap_b32 v121, v123
    v_permlane16_swap_b32 v124, v126
    v_permlane16_swap_b32 v125, v127
    v_pk_mul_f32 v[8:9], v[8:9], s[54:55]
    v_pk_mul_f32 v[10:11], v[10:11], s[54:55]
    v_pk_mul_f32 v[20:21], v[20:21], s[54:55]
    v_pk_mul_f32 v[22:23], v[22:23], s[54:55]
    v_cvt_pk_bf16_f32 v128, v8, v9
    v_cvt_pk_bf16_f32 v129, v10, v11
    v_cvt_pk_bf16_f32 v130, v20, v21
    v_cvt_pk_bf16_f32 v131, v22, v23
    v_pk_mul_f32 v[32:33], v[32:33], s[54:55]
    v_pk_mul_f32 v[34:35], v[34:35], s[54:55]
    v_pk_mul_f32 v[44:45], v[44:45], s[54:55]
    v_pk_mul_f32 v[46:47], v[46:47], s[54:55]
    v_cvt_pk_bf16_f32 v132, v32, v33
    v_cvt_pk_bf16_f32 v133, v34, v35
    v_cvt_pk_bf16_f32 v134, v44, v45
    v_cvt_pk_bf16_f32 v135, v46, v47
    v_pk_mul_f32 v[56:57], v[56:57], s[54:55]
    v_pk_mul_f32 v[58:59], v[58:59], s[54:55]
    v_pk_mul_f32 v[68:69], v[68:69], s[54:55]
    v_pk_mul_f32 v[70:71], v[70:71], s[54:55]
    v_cvt_pk_bf16_f32 v136, v56, v57
    v_cvt_pk_bf16_f32 v137, v58, v59
    v_cvt_pk_bf16_f32 v138, v68, v69
    v_cvt_pk_bf16_f32 v139, v70, v71
    v_pk_mul_f32 v[80:81], v[80:81], s[54:55]
    v_pk_mul_f32 v[82:83], v[82:83], s[54:55]
    v_pk_mul_f32 v[92:93], v[92:93], s[54:55]
    v_pk_mul_f32 v[94:95], v[94:95], s[54:55]
    v_cvt_pk_bf16_f32 v140, v80, v81
    v_cvt_pk_bf16_f32 v141, v82, v83
    v_cvt_pk_bf16_f32 v142, v92, v93
    v_cvt_pk_bf16_f32 v143, v94, v95
    v_permlane32_swap_b32 v128, v130
    v_permlane32_swap_b32 v129, v131
    v_permlane32_swap_b32 v132, v134
    v_permlane32_swap_b32 v133, v135
    v_permlane32_swap_b32 v136, v138
    v_permlane32_swap_b32 v137, v139
    v_permlane32_swap_b32 v140, v142
    v_permlane32_swap_b32 v141, v143
    v_permlane16_swap_b32 v128, v130
    v_permlane16_swap_b32 v129, v131
    v_permlane16_swap_b32 v132, v134
    v_permlane16_swap_b32 v133, v135
    v_permlane16_swap_b32 v136, v138
    v_permlane16_swap_b32 v137, v139
    v_permlane16_swap_b32 v140, v142
    v_permlane16_swap_b32 v141, v143
    s_waitcnt lgkmcnt(0)
    v_mfma_f32_16x16x32_bf16 v[208:211], v[144:147], v[96:99], 0
    v_mov_b32 v8, 0
    v_mov_b32 v9, 0
    v_mfma_f32_16x16x32_bf16 v[212:215], v[160:163], v[96:99], 0
    v_mov_b32 v10, 0
    v_mov_b32 v11, 0
    v_mfma_f32_16x16x32_bf16 v[208:211], v[148:151], v[100:103], v[208:211]
    v_mov_b32 v20, 0
    v_mfma_f32_16x16x32_bf16 v[212:215], v[164:167], v[100:103], v[212:215]
    v_mov_b32 v21, 0
    v_mov_b32 v22, 0
    v_mfma_f32_16x16x32_bf16 v[208:211], v[152:155], v[104:107], v[208:211]
    v_mov_b32 v23, 0
    v_mfma_f32_16x16x32_bf16 v[212:215], v[168:171], v[104:107], v[212:215]
    v_mov_b32 v32, 0
    v_mov_b32 v33, 0
    v_mfma_f32_16x16x32_bf16 v[208:211], v[156:159], v[108:111], v[208:211]
    v_mov_b32 v34, 0
    v_mov_b32 v35, 0
    v_mfma_f32_16x16x32_bf16 v[212:215], v[172:175], v[108:111], v[212:215]
    v_mov_b32 v44, 0
    v_mfma_f32_16x16x32_bf16 v[216:219], v[144:147], v[112:115], 0
    v_mov_b32 v45, 0
    v_mov_b32 v46, 0
    v_mfma_f32_16x16x32_bf16 v[220:223], v[160:163], v[112:115], 0
    v_mov_b32 v47, 0
    v_mfma_f32_16x16x32_bf16 v[216:219], v[148:151], v[116:119], v[216:219]
    v_mov_b32 v56, 0
    v_mov_b32 v57, 0
    v_mfma_f32_16x16x32_bf16 v[220:223], v[164:167], v[116:119], v[220:223]
    v_mov_b32 v58, 0
    v_mfma_f32_16x16x32_bf16 v[216:219], v[152:155], v[120:123], v[216:219]
    v_mov_b32 v59, 0
    v_mov_b32 v68, 0
    v_mfma_f32_16x16x32_bf16 v[220:223], v[168:171], v[120:123], v[220:223]
    v_mov_b32 v69, 0
    v_mov_b32 v70, 0
    v_mfma_f32_16x16x32_bf16 v[216:219], v[156:159], v[124:127], v[216:219]
    v_mov_b32 v71, 0
    v_mfma_f32_16x16x32_bf16 v[220:223], v[172:175], v[124:127], v[220:223]
    v_mov_b32 v80, 0
    v_mov_b32 v81, 0
    v_mfma_f32_16x16x32_bf16 v[224:227], v[144:147], v[128:131], 0
    v_mov_b32 v82, 0
    v_mfma_f32_16x16x32_bf16 v[228:231], v[160:163], v[128:131], 0
    v_mov_b32 v83, 0
    v_mov_b32 v92, 0
    v_mfma_f32_16x16x32_bf16 v[224:227], v[148:151], v[132:135], v[224:227]
    v_mov_b32 v93, 0
    v_mov_b32 v94, 0
    v_mfma_f32_16x16x32_bf16 v[228:231], v[164:167], v[132:135], v[228:231]
    v_mov_b32 v95, 0
    v_mfma_f32_16x16x32_bf16 v[224:227], v[152:155], v[136:139], v[224:227]
    v_mov_b32 v236, 0
    v_mov_b32 v237, 0
    v_mfma_f32_16x16x32_bf16 v[228:231], v[168:171], v[136:139], v[228:231]
    v_mov_b32 v238, 0
    v_mfma_f32_16x16x32_bf16 v[224:227], v[156:159], v[140:143], v[224:227]
    v_mov_b32 v239, 0
    v_mov_b32 v240, 0
    v_mfma_f32_16x16x32_bf16 v[228:231], v[172:175], v[140:143], v[228:231]
    v_mov_b32 v241, 0
    v_max3_f32 v250, v208, v209, v210
    v_max3_f32 v250, v250, v211, v212
    v_max3_f32 v250, v250, v213, v214
    v_max3_f32 v250, v250, v215, v216
    v_max3_f32 v250, v250, v217, v218
    v_max3_f32 v250, v250, v219, v220
    v_max3_f32 v250, v250, v221, v222
    v_max3_f32 v250, v250, v223, v224
    v_max3_f32 v250, v250, v225, v226
    v_max3_f32 v250, v250, v227, v228
    v_max3_f32 v250, v250, v229, v230
    v_max_f32 v250, v250, v231
    v_mov_b32 v251, v250
    s_nop 1
    v_permlane32_swap_b32 v251, v250
    v_max_f32 v250, v250, v251
    v_mov_b32 v251, v250
    s_nop 1
    v_permlane16_swap_b32 v251, v250
    v_max_f32 v250, v250, v251
    v_sub_f32 v232, 0, v250
    v_sub_f32 v233, 0, v250
    v_sub_f32 v234, 0, v250
    v_sub_f32 v235, 0, v250
    v_pk_add_f32 v[208:209], v[208:209], v[232:233]
    v_pk_add_f32 v[210:211], v[210:211], v[232:233]
    v_pk_add_f32 v[212:213], v[212:213], v[232:233]
    v_pk_add_f32 v[214:215], v[214:215], v[232:233]
    v_pk_add_f32 v[216:217], v[216:217], v[232:233]
    v_pk_add_f32 v[218:219], v[218:219], v[232:233]
    v_pk_add_f32 v[220:221], v[220:221], v[232:233]
    v_pk_add_f32 v[222:223], v[222:223], v[232:233]
    v_pk_add_f32 v[224:225], v[224:225], v[232:233]
    v_pk_add_f32 v[226:227], v[226:227], v[232:233]
    v_pk_add_f32 v[228:229], v[228:229], v[232:233]
    v_pk_add_f32 v[230:231], v[230:231], v[232:233]
    s_waitcnt vmcnt(12)
    s_barrier
    ds_read_b128 v[144:147], v242 offset:8192
    ds_read_b128 v[160:163], v242 offset:12288
    ds_read_b128 v[148:151], v243 offset:8192
    ds_read_b128 v[164:167], v243 offset:12288
    ds_read_b128 v[152:155], v242 offset:8704
    ds_read_b128 v[168:171], v242 offset:12800
    ds_read_b128 v[156:159], v243 offset:8704
    ds_read_b128 v[172:175], v243 offset:12800
    v_exp_f32 v208, v208
    v_exp_f32 v209, v209
    v_exp_f32 v210, v210
    v_add_f32 v236, v236, v208
    v_add_f32 v237, v237, v209
    v_exp_f32 v211, v211
    v_cvt_pk_bf16_f32 v208, v208, v209
    v_add_f32 v236, v236, v210
    v_exp_f32 v212, v212
    v_exp_f32 v213, v213
    v_add_f32 v237, v237, v211
    v_cvt_pk_bf16_f32 v209, v210, v211
    v_exp_f32 v214, v214
    v_add_f32 v236, v236, v212
    v_add_f32 v237, v237, v213
    v_exp_f32 v215, v215
    v_cvt_pk_bf16_f32 v210, v212, v213
    v_add_f32 v236, v236, v214
    v_cvt_pk_bf16_f32 v211, v214, v215
    v_add_f32 v237, v237, v215
    s_nop 0
    v_mfma_f32_16x16x32_bf16 v[0:3], v[176:179], v[208:211], 0
    v_exp_f32 v216, v216
    v_exp_f32 v217, v217
    v_exp_f32 v218, v218
    v_mfma_f32_16x16x32_bf16 v[12:15], v[180:183], v[208:211], 0
    v_add_f32 v238, v238, v216
    v_add_f32 v239, v239, v217
    v_exp_f32 v219, v219
    v_mfma_f32_16x16x32_bf16 v[24:27], v[184:187], v[208:211], 0
    v_cvt_pk_bf16_f32 v216, v216, v217
    v_add_f32 v238, v238, v218
    v_exp_f32 v220, v220
    v_mfma_f32_16x16x32_bf16 v[36:39], v[188:191], v[208:211], 0
    v_exp_f32 v221, v221
    v_add_f32 v239, v239, v219
    v_cvt_pk_bf16_f32 v217, v218, v219
    v_mfma_f32_16x16x32_bf16 v[48:51], v[192:195], v[208:211], 0
    v_exp_f32 v222, v222
    v_add_f32 v238, v238, v220
    v_add_f32 v239, v239, v221
    v_mfma_f32_16x16x32_bf16 v[60:63], v[196:199], v[208:211], 0
    v_exp_f32 v223, v223
    v_cvt_pk_bf16_f32 v218, v220, v221
    v_add_f32 v238, v238, v222
    v_mfma_f32_16x16x32_bf16 v[72:75], v[200:203], v[208:211], 0
    v_cvt_pk_bf16_f32 v219, v222, v223
    v_add_f32 v239, v239, v223
    s_add_u32 m0, s56, 0
    s_add_u32 s26, s27, 40960
    s_and_b32 s26, s26, 0x3ffff
    buffer_load_dwordx4 v248, s[12:15], s26 offen nt lds
    v_mfma_f32_16x16x32_bf16 v[84:87], v[204:207], v[208:211], 0
    buffer_load_dwordx4 v249, s[12:15], s26 offen offset:1024 nt lds
    s_add_u32 m0, s56, 40960
    s_nop 0
    buffer_load_dwordx4 v248, s[16:19], s26 offen nt lds
    buffer_load_dwordx4 v249, s[16:19], s26 offen offset:1024 nt lds
    v_mfma_f32_16x16x32_bf16 v[4:7], v[176:179], v[216:219], 0
    v_mfma_f32_16x16x32_bf16 v[16:19], v[180:183], v[216:219], 0
    v_exp_f32 v224, v224
    v_mfma_f32_16x16x32_bf16 v[28:31], v[184:187], v[216:219], 0
    v_exp_f32 v225, v225
    v_mfma_f32_16x16x32_bf16 v[40:43], v[188:191], v[216:219], 0
    v_exp_f32 v226, v226
    v_mfma_f32_16x16x32_bf16 v[52:55], v[192:195], v[216:219], 0
    v_add_f32 v240, v240, v224
    v_add_f32 v241, v241, v225
    v_mfma_f32_16x16x32_bf16 v[64:67], v[196:199], v[216:219], 0
    v_exp_f32 v227, v227
    v_mfma_f32_16x16x32_bf16 v[76:79], v[200:203], v[216:219], 0
    v_cvt_pk_bf16_f32 v224, v224, v225
    v_add_f32 v240, v240, v226
    v_mfma_f32_16x16x32_bf16 v[88:91], v[204:207], v[216:219], 0
    v_exp_f32 v228, v228
    s_mov_b32 s88, 0
    s_mov_b32 s89, 0
    s_mov_b32 s25, 5
K1_loop:
    s_waitcnt lgkmcnt(0)
    v_mfma_f32_16x16x32_bf16 v[208:211], v[144:147], v[96:99], v[232:235]
    v_exp_f32 v229, v229
    v_mfma_f32_16x16x32_bf16 v[212:215], v[160:163], v[96:99], v[232:235]
    v_add_f32 v241, v241, v227
    v_cvt_pk_bf16_f32 v225, v226, v227
    v_mfma_f32_16x16x32_bf16 v[208:211], v[148:151], v[100:103], v[208:211]
    v_exp_f32 v230, v230
    v_mfma_f32_16x16x32_bf16 v[212:215], v[164:167], v[100:103], v[212:215]
    v_add_f32 v240, v240, v228
    v_add_f32 v241, v241, v229
    v_mfma_f32_16x16x32_bf16 v[208:211], v[152:155], v[104:107], v[208:211]
    v_exp_f32 v231, v231
    v_mfma_f32_16x16x32_bf16 v[212:215], v[168:171], v[104:107], v[212:215]
    v_cvt_pk_bf16_f32 v226, v228, v229
    v_add_f32 v240, v240, v230
    v_mfma_f32_16x16x32_bf16 v[208:211], v[156:159], v[108:111], v[208:211]
    v_cvt_pk_bf16_f32 v227, v230, v231
    v_add_f32 v241, v241, v231
    v_mfma_f32_16x16x32_bf16 v[212:215], v[172:175], v[108:111], v[212:215]
    v_mfma_f32_16x16x32_bf16 v[8:11], v[176:179], v[224:227], v[8:11]
    ds_read_b64_tr_b16 v[176:177], v244 offset:8192
    v_mfma_f32_16x16x32_bf16 v[20:23], v[180:183], v[224:227], v[20:23]
    s_nop 1
    v_exp_f32 v208, v208
    ds_read_b64_tr_b16 v[178:179], v244 offset:12288
    v_mfma_f32_16x16x32_bf16 v[32:35], v[184:187], v[224:227], v[32:35]
    v_exp_f32 v209, v209
    ds_read_b64_tr_b16 v[180:181], v245 offset:8192
    v_mfma_f32_16x16x32_bf16 v[44:47], v[188:191], v[224:227], v[44:47]
    v_exp_f32 v210, v210
    ds_read_b64_tr_b16 v[182:183], v245 offset:12288
    v_mfma_f32_16x16x32_bf16 v[56:59], v[192:195], v[224:227], v[56:59]
    v_add_f32 v236, v236, v208
    v_add_f32 v237, v237, v209
    ds_read_b64_tr_b16 v[184:185], v246 offset:8192
    v_mfma_f32_16x16x32_bf16 v[68:71], v[196:199], v[224:227], v[68:71]
    v_exp_f32 v211, v211
    ds_read_b64_tr_b16 v[186:187], v246 offset:12288
    v_mfma_f32_16x16x32_bf16 v[80:83], v[200:203], v[224:227], v[80:83]
    v_cvt_pk_bf16_f32 v208, v208, v209
    v_add_f32 v236, v236, v210
    ds_read_b64_tr_b16 v[188:189], v247 offset:8192
    v_mfma_f32_16x16x32_bf16 v[92:95], v[204:207], v[224:227], v[92:95]
    v_exp_f32 v212, v212
    ds_read_b64_tr_b16 v[190:191], v247 offset:12288
    v_mfma_f32_16x16x32_bf16 v[216:219], v[144:147], v[112:115], v[232:235]
    v_exp_f32 v213, v213
    ds_read_b64_tr_b16 v[192:193], v244 offset:8704
    v_mfma_f32_16x16x32_bf16 v[220:223], v[160:163], v[112:115], v[232:235]
    v_add_f32 v237, v237, v211
    v_cvt_pk_bf16_f32 v209, v210, v211
    ds_read_b64_tr_b16 v[194:195], v244 offset:12800
    v_mfma_f32_16x16x32_bf16 v[216:219], v[148:151], v[116:119], v[216:219]
    v_exp_f32 v214, v214
    ds_read_b64_tr_b16 v[196:197], v245 offset:8704
    v_mfma_f32_16x16x32_bf16 v[220:223], v[164:167], v[116:119], v[220:223]
    v_add_f32 v236, v236, v212
    v_add_f32 v237, v237, v213
    ds_read_b64_tr_b16 v[198:199], v245 offset:12800
    v_mfma_f32_16x16x32_bf16 v[216:219], v[152:155], v[120:123], v[216:219]
    v_exp_f32 v215, v215
    ds_read_b64_tr_b16 v[200:201], v246 offset:8704
    v_mfma_f32_16x16x32_bf16 v[220:223], v[168:171], v[120:123], v[220:223]
    v_cvt_pk_bf16_f32 v210, v212, v213
    v_add_f32 v236, v236, v214
    ds_read_b64_tr_b16 v[202:203], v246 offset:12800
    v_mfma_f32_16x16x32_bf16 v[216:219], v[156:159], v[124:127], v[216:219]
    v_cvt_pk_bf16_f32 v211, v214, v215
    v_add_f32 v237, v237, v215
    ds_read_b64_tr_b16 v[204:205], v247 offset:8704
    v_mfma_f32_16x16x32_bf16 v[220:223], v[172:175], v[124:127], v[220:223]
    ds_read_b64_tr_b16 v[206:207], v247 offset:12800
    s_waitcnt lgkmcnt(8)
    v_mfma_f32_16x16x32_bf16 v[0:3], v[176:179], v[208:211], v[0:3]
    v_mfma_f32_16x16x32_bf16 v[12:15], v[180:183], v[208:211], v[12:15]
    v_exp_f32 v216, v216
    v_mfma_f32_16x16x32_bf16 v[24:27], v[184:187], v[208:211], v[24:27]
    v_exp_f32 v217, v217
    v_mfma_f32_16x16x32_bf16 v[36:39], v[188:191], v[208:211], v[36:39]
    v_exp_f32 v218, v218
    s_waitcnt lgkmcnt(4)
    v_mfma_f32_16x16x32_bf16 v[48:51], v[192:195], v[208:211], v[48:51]
    v_add_f32 v238, v238, v216
    v_add_f32 v239, v239, v217
    v_mfma_f32_16x16x32_bf16 v[60:63], v[196:199], v[208:211], v[60:63]
    v_exp_f32 v219, v219
    s_waitcnt lgkmcnt(0)
    v_mfma_f32_16x16x32_bf16 v[72:75], v[200:203], v[208:211], v[72:75]
    v_cvt_pk_bf16_f32 v216, v216, v217
    v_add_f32 v238, v238, v218
    v_mfma_f32_16x16x32_bf16 v[84:87], v[204:207], v[208:211], v[84:87]
    v_exp_f32 v220, v220
    s_waitcnt vmcnt(12)
    s_barrier
    v_mfma_f32_16x16x32_bf16 v[224:227], v[144:147], v[128:131], v[232:235]
    v_exp_f32 v221, v221
    ds_read_b128 v[144:147], v242 offset:16384
    v_mfma_f32_16x16x32_bf16 v[228:231], v[160:163], v[128:131], v[232:235]
    v_add_f32 v239, v239, v219
    v_cvt_pk_bf16_f32 v217, v218, v219
    ds_read_b128 v[160:163], v242 offset:20480
    v_mfma_f32_16x16x32_bf16 v[224:227], v[148:151], v[132:135], v[224:227]
    v_exp_f32 v222, v222
    ds_read_b128 v[148:151], v243 offset:16384
    v_mfma_f32_16x16x32_bf16 v[228:231], v[164:167], v[132:135], v[228:231]
    v_add_f32 v238, v238, v220
    v_add_f32 v239, v239, v221
    ds_read_b128 v[164:167], v243 offset:20480
    v_mfma_f32_16x16x32_bf16 v[224:227], v[152:155], v[136:139], v[224:227]
    v_exp_f32 v223, v223
    ds_read_b128 v[152:155], v242 offset:16896
    v_mfma_f32_16x16x32_bf16 v[228:231], v[168:171], v[136:139], v[228:231]
    v_cvt_pk_bf16_f32 v218, v220, v221
    v_add_f32 v238, v238, v222
    ds_read_b128 v[168:171], v242 offset:20992
    v_mfma_f32_16x16x32_bf16 v[224:227], v[156:159], v[140:143], v[224:227]
    v_cvt_pk_bf16_f32 v219, v222, v223
    v_add_f32 v239, v239, v223
    ds_read_b128 v[156:159], v243 offset:16896
    v_mfma_f32_16x16x32_bf16 v[228:231], v[172:175], v[140:143], v[228:231]
    ds_read_b128 v[172:175], v243 offset:20992
    v_mfma_f32_16x16x32_bf16 v[4:7], v[176:179], v[216:219], v[4:7]
    s_add_u32 m0, s56, 8192
    s_add_u32 s26, s26, 8192
    s_and_b32 s26, s26, 0x3ffff
    buffer_load_dwordx4 v248, s[12:15], s26 offen nt lds
    v_mfma_f32_16x16x32_bf16 v[16:19], v[180:183], v[216:219], v[16:19]
    v_exp_f32 v224, v224
    v_mfma_f32_16x16x32_bf16 v[28:31], v[184:187], v[216:219], v[28:31]
    v_exp_f32 v225, v225
    buffer_load_dwordx4 v249, s[12:15], s26 offen offset:1024 nt lds
    v_mfma_f32_16x16x32_bf16 v[40:43], v[188:191], v[216:219], v[40:43]
    v_exp_f32 v226, v226
    v_mfma_f32_16x16x32_bf16 v[52:55], v[192:195], v[216:219], v[52:55]
    v_add_f32 v240, v240, v224
    v_add_f32 v241, v241, v225
    s_add_u32 m0, s56, 49152
    s_nop 0
    buffer_load_dwordx4 v248, s[16:19], s26 offen nt lds
    v_mfma_f32_16x16x32_bf16 v[64:67], v[196:199], v[216:219], v[64:67]
    v_exp_f32 v227, v227
    v_mfma_f32_16x16x32_bf16 v[76:79], v[200:203], v[216:219], v[76:79]
    v_cvt_pk_bf16_f32 v224, v224, v225
    v_add_f32 v240, v240, v226
    buffer_load_dwordx4 v249, s[16:19], s26 offen offset:1024 nt lds
    v_mfma_f32_16x16x32_bf16 v[88:91], v[204:207], v[216:219], v[88:91]
    v_exp_f32 v228, v228
    s_waitcnt lgkmcnt(0)
    v_mfma_f32_16x16x32_bf16 v[208:211], v[144:147], v[96:99], v[232:235]
    v_exp_f32 v229, v229
    v_mfma_f32_16x16x32_bf16 v[212:215], v[160:163], v[96:99], v[232:235]
    v_add_f32 v241, v241, v227
    v_cvt_pk_bf16_f32 v225, v226, v227
    v_mfma_f32_16x16x32_bf16 v[208:211], v[148:151], v[100:103], v[208:211]
    v_exp_f32 v230, v230
    v_mfma_f32_16x16x32_bf16 v[212:215], v[164:167], v[100:103], v[212:215]
    v_add_f32 v240, v240, v228
    v_add_f32 v241, v241, v229
    v_mfma_f32_16x16x32_bf16 v[208:211], v[152:155], v[104:107], v[208:211]
    v_exp_f32 v231, v231
    v_mfma_f32_16x16x32_bf16 v[212:215], v[168:171], v[104:107], v[212:215]
    v_cvt_pk_bf16_f32 v226, v228, v229
    v_add_f32 v240, v240, v230
    v_mfma_f32_16x16x32_bf16 v[208:211], v[156:159], v[108:111], v[208:211]
    v_cvt_pk_bf16_f32 v227, v230, v231
    v_add_f32 v241, v241, v231
    v_mfma_f32_16x16x32_bf16 v[212:215], v[172:175], v[108:111], v[212:215]
    v_mfma_f32_16x16x32_bf16 v[8:11], v[176:179], v[224:227], v[8:11]
    ds_read_b64_tr_b16 v[176:177], v244 offset:16384
    v_mfma_f32_16x16x32_bf16 v[20:23], v[180:183], v[224:227], v[20:23]
    s_nop 1
    v_exp_f32 v208, v208
    ds_read_b64_tr_b16 v[178:179], v244 offset:20480
    v_mfma_f32_16x16x32_bf16 v[32:35], v[184:187], v[224:227], v[32:35]
    v_exp_f32 v209, v209
    ds_read_b64_tr_b16 v[180:181], v245 offset:16384
    v_mfma_f32_16x16x32_bf16 v[44:47], v[188:191], v[224:227], v[44:47]
    v_exp_f32 v210, v210
    ds_read_b64_tr_b16 v[182:183], v245 offset:20480
    v_mfma_f32_16x16x32_bf16 v[56:59], v[192:195], v[224:227], v[56:59]
    v_add_f32 v236, v236, v208
    v_add_f32 v237, v237, v209
    ds_read_b64_tr_b16 v[184:185], v246 offset:16384
    v_mfma_f32_16x16x32_bf16 v[68:71], v[196:199], v[224:227], v[68:71]
    v_exp_f32 v211, v211
    ds_read_b64_tr_b16 v[186:187], v246 offset:20480
    v_mfma_f32_16x16x32_bf16 v[80:83], v[200:203], v[224:227], v[80:83]
    v_cvt_pk_bf16_f32 v208, v208, v209
    v_add_f32 v236, v236, v210
    ds_read_b64_tr_b16 v[188:189], v247 offset:16384
    v_mfma_f32_16x16x32_bf16 v[92:95], v[204:207], v[224:227], v[92:95]
    v_exp_f32 v212, v212
    ds_read_b64_tr_b16 v[190:191], v247 offset:20480
    v_mfma_f32_16x16x32_bf16 v[216:219], v[144:147], v[112:115], v[232:235]
    v_exp_f32 v213, v213
    ds_read_b64_tr_b16 v[192:193], v244 offset:16896
    v_mfma_f32_16x16x32_bf16 v[220:223], v[160:163], v[112:115], v[232:235]
    v_add_f32 v237, v237, v211
    v_cvt_pk_bf16_f32 v209, v210, v211
    ds_read_b64_tr_b16 v[194:195], v244 offset:20992
    v_mfma_f32_16x16x32_bf16 v[216:219], v[148:151], v[116:119], v[216:219]
    v_exp_f32 v214, v214
    ds_read_b64_tr_b16 v[196:197], v245 offset:16896
    v_mfma_f32_16x16x32_bf16 v[220:223], v[164:167], v[116:119], v[220:223]
    v_add_f32 v236, v236, v212
    v_add_f32 v237, v237, v213
    ds_read_b64_tr_b16 v[198:199], v245 offset:20992
    v_mfma_f32_16x16x32_bf16 v[216:219], v[152:155], v[120:123], v[216:219]
    v_exp_f32 v215, v215
    ds_read_b64_tr_b16 v[200:201], v246 offset:16896
    v_mfma_f32_16x16x32_bf16 v[220:223], v[168:171], v[120:123], v[220:223]
    v_cvt_pk_bf16_f32 v210, v212, v213
    v_add_f32 v236, v236, v214
    ds_read_b64_tr_b16 v[202:203], v246 offset:20992
    v_mfma_f32_16x16x32_bf16 v[216:219], v[156:159], v[124:127], v[216:219]
    v_cvt_pk_bf16_f32 v211, v214, v215
    v_add_f32 v237, v237, v215
    ds_read_b64_tr_b16 v[204:205], v247 offset:16896
    v_mfma_f32_16x16x32_bf16 v[220:223], v[172:175], v[124:127], v[220:223]
    ds_read_b64_tr_b16 v[206:207], v247 offset:20992
    s_waitcnt lgkmcnt(8)
    v_mfma_f32_16x16x32_bf16 v[0:3], v[176:179], v[208:211], v[0:3]
    v_mfma_f32_16x16x32_bf16 v[12:15], v[180:183], v[208:211], v[12:15]
    v_exp_f32 v216, v216
    v_mfma_f32_16x16x32_bf16 v[24:27], v[184:187], v[208:211], v[24:27]
    v_exp_f32 v217, v217
    v_mfma_f32_16x16x32_bf16 v[36:39], v[188:191], v[208:211], v[36:39]
    v_exp_f32 v218, v218
    s_waitcnt lgkmcnt(4)
    v_mfma_f32_16x16x32_bf16 v[48:51], v[192:195], v[208:211], v[48:51]
    v_add_f32 v238, v238, v216
    v_add_f32 v239, v239, v217
    v_mfma_f32_16x16x32_bf16 v[60:63], v[196:199], v[208:211], v[60:63]
    v_exp_f32 v219, v219
    s_waitcnt lgkmcnt(0)
    v_mfma_f32_16x16x32_bf16 v[72:75], v[200:203], v[208:211], v[72:75]
    v_cvt_pk_bf16_f32 v216, v216, v217
    v_add_f32 v238, v238, v218
    v_mfma_f32_16x16x32_bf16 v[84:87], v[204:207], v[208:211], v[84:87]
    v_exp_f32 v220, v220
    s_waitcnt vmcnt(12)
    s_barrier
    v_mfma_f32_16x16x32_bf16 v[224:227], v[144:147], v[128:131], v[232:235]
    v_exp_f32 v221, v221
    ds_read_b128 v[144:147], v242 offset:24576
    v_mfma_f32_16x16x32_bf16 v[228:231], v[160:163], v[128:131], v[232:235]
    v_add_f32 v239, v239, v219
    v_cvt_pk_bf16_f32 v217, v218, v219
    ds_read_b128 v[160:163], v242 offset:28672
    v_mfma_f32_16x16x32_bf16 v[224:227], v[148:151], v[132:135], v[224:227]
    v_exp_f32 v222, v222
    ds_read_b128 v[148:151], v243 offset:24576
    v_mfma_f32_16x16x32_bf16 v[228:231], v[164:167], v[132:135], v[228:231]
    v_add_f32 v238, v238, v220
    v_add_f32 v239, v239, v221
    ds_read_b128 v[164:167], v243 offset:28672
    v_mfma_f32_16x16x32_bf16 v[224:227], v[152:155], v[136:139], v[224:227]
    v_exp_f32 v223, v223
    ds_read_b128 v[152:155], v242 offset:25088
    v_mfma_f32_16x16x32_bf16 v[228:231], v[168:171], v[136:139], v[228:231]
    v_cvt_pk_bf16_f32 v218, v220, v221
    v_add_f32 v238, v238, v222
    ds_read_b128 v[168:171], v242 offset:29184
    v_mfma_f32_16x16x32_bf16 v[224:227], v[156:159], v[140:143], v[224:227]
    v_cvt_pk_bf16_f32 v219, v222, v223
    v_add_f32 v239, v239, v223
    ds_read_b128 v[156:159], v243 offset:25088
    v_mfma_f32_16x16x32_bf16 v[228:231], v[172:175], v[140:143], v[228:231]
    ds_read_b128 v[172:175], v243 offset:29184
    v_mfma_f32_16x16x32_bf16 v[4:7], v[176:179], v[216:219], v[4:7]
    s_add_u32 m0, s56, 16384
    s_add_u32 s26, s26, 8192
    s_and_b32 s26, s26, 0x3ffff
    buffer_load_dwordx4 v248, s[12:15], s26 offen nt lds
    v_mfma_f32_16x16x32_bf16 v[16:19], v[180:183], v[216:219], v[16:19]
    v_exp_f32 v224, v224
    v_mfma_f32_16x16x32_bf16 v[28:31], v[184:187], v[216:219], v[28:31]
    v_exp_f32 v225, v225
    buffer_load_dwordx4 v249, s[12:15], s26 offen offset:1024 nt lds
    v_mfma_f32_16x16x32_bf16 v[40:43], v[188:191], v[216:219], v[40:43]
    v_exp_f32 v226, v226
    v_mfma_f32_16x16x32_bf16 v[52:55], v[192:195], v[216:219], v[52:55]
    v_add_f32 v240, v240, v224
    v_add_f32 v241, v241, v225
    s_add_u32 m0, s56, 57344
    s_nop 0
    buffer_load_dwordx4 v248, s[16:19], s26 offen nt lds
    v_mfma_f32_16x16x32_bf16 v[64:67], v[196:199], v[216:219], v[64:67]
    v_exp_f32 v227, v227
    v_mfma_f32_16x16x32_bf16 v[76:79], v[200:203], v[216:219], v[76:79]
    v_cvt_pk_bf16_f32 v224, v224, v225
    v_add_f32 v240, v240, v226
    buffer_load_dwordx4 v249, s[16:19], s26 offen offset:1024 nt lds
    v_mfma_f32_16x16x32_bf16 v[88:91], v[204:207], v[216:219], v[88:91]
    v_exp_f32 v228, v228
    s_waitcnt lgkmcnt(0)
    v_mfma_f32_16x16x32_bf16 v[208:211], v[144:147], v[96:99], v[232:235]
    v_exp_f32 v229, v229
    v_mfma_f32_16x16x32_bf16 v[212:215], v[160:163], v[96:99], v[232:235]
    v_add_f32 v241, v241, v227
    v_cvt_pk_bf16_f32 v225, v226, v227
    v_mfma_f32_16x16x32_bf16 v[208:211], v[148:151], v[100:103], v[208:211]
    v_exp_f32 v230, v230
    v_mfma_f32_16x16x32_bf16 v[212:215], v[164:167], v[100:103], v[212:215]
    v_add_f32 v240, v240, v228
    v_add_f32 v241, v241, v229
    v_mfma_f32_16x16x32_bf16 v[208:211], v[152:155], v[104:107], v[208:211]
    v_exp_f32 v231, v231
    v_mfma_f32_16x16x32_bf16 v[212:215], v[168:171], v[104:107], v[212:215]
    v_cvt_pk_bf16_f32 v226, v228, v229
    v_add_f32 v240, v240, v230
    v_mfma_f32_16x16x32_bf16 v[208:211], v[156:159], v[108:111], v[208:211]
    v_cvt_pk_bf16_f32 v227, v230, v231
    v_add_f32 v241, v241, v231
    v_mfma_f32_16x16x32_bf16 v[212:215], v[172:175], v[108:111], v[212:215]
    v_mfma_f32_16x16x32_bf16 v[8:11], v[176:179], v[224:227], v[8:11]
    ds_read_b64_tr_b16 v[176:177], v244 offset:24576
    v_mfma_f32_16x16x32_bf16 v[20:23], v[180:183], v[224:227], v[20:23]
    s_nop 1
    v_exp_f32 v208, v208
    ds_read_b64_tr_b16 v[178:179], v244 offset:28672
    v_mfma_f32_16x16x32_bf16 v[32:35], v[184:187], v[224:227], v[32:35]
    v_exp_f32 v209, v209
    ds_read_b64_tr_b16 v[180:181], v245 offset:24576
    v_mfma_f32_16x16x32_bf16 v[44:47], v[188:191], v[224:227], v[44:47]
    v_exp_f32 v210, v210
    ds_read_b64_tr_b16 v[182:183], v245 offset:28672
    v_mfma_f32_16x16x32_bf16 v[56:59], v[192:195], v[224:227], v[56:59]
    v_add_f32 v236, v236, v208
    v_add_f32 v237, v237, v209
    ds_read_b64_tr_b16 v[184:185], v246 offset:24576
    v_mfma_f32_16x16x32_bf16 v[68:71], v[196:199], v[224:227], v[68:71]
    v_exp_f32 v211, v211
    ds_read_b64_tr_b16 v[186:187], v246 offset:28672
    v_mfma_f32_16x16x32_bf16 v[80:83], v[200:203], v[224:227], v[80:83]
    v_cvt_pk_bf16_f32 v208, v208, v209
    v_add_f32 v236, v236, v210
    ds_read_b64_tr_b16 v[188:189], v247 offset:24576
    v_mfma_f32_16x16x32_bf16 v[92:95], v[204:207], v[224:227], v[92:95]
    v_exp_f32 v212, v212
    ds_read_b64_tr_b16 v[190:191], v247 offset:28672
    v_mfma_f32_16x16x32_bf16 v[216:219], v[144:147], v[112:115], v[232:235]
    v_exp_f32 v213, v213
    ds_read_b64_tr_b16 v[192:193], v244 offset:25088
    v_mfma_f32_16x16x32_bf16 v[220:223], v[160:163], v[112:115], v[232:235]
    v_add_f32 v237, v237, v211
    v_cvt_pk_bf16_f32 v209, v210, v211
    ds_read_b64_tr_b16 v[194:195], v244 offset:29184
    v_mfma_f32_16x16x32_bf16 v[216:219], v[148:151], v[116:119], v[216:219]
    v_exp_f32 v214, v214
    ds_read_b64_tr_b16 v[196:197], v245 offset:25088
    v_mfma_f32_16x16x32_bf16 v[220:223], v[164:167], v[116:119], v[220:223]
    v_add_f32 v236, v236, v212
    v_add_f32 v237, v237, v213
    ds_read_b64_tr_b16 v[198:199], v245 offset:29184
    v_mfma_f32_16x16x32_bf16 v[216:219], v[152:155], v[120:123], v[216:219]
    v_exp_f32 v215, v215
    ds_read_b64_tr_b16 v[200:201], v246 offset:25088
    v_mfma_f32_16x16x32_bf16 v[220:223], v[168:171], v[120:123], v[220:223]
    v_cvt_pk_bf16_f32 v210, v212, v213
    v_add_f32 v236, v236, v214
    ds_read_b64_tr_b16 v[202:203], v246 offset:29184
    v_mfma_f32_16x16x32_bf16 v[216:219], v[156:159], v[124:127], v[216:219]
    v_cvt_pk_bf16_f32 v211, v214, v215
    v_add_f32 v237, v237, v215
    ds_read_b64_tr_b16 v[204:205], v247 offset:25088
    v_mfma_f32_16x16x32_bf16 v[220:223], v[172:175], v[124:127], v[220:223]
    ds_read_b64_tr_b16 v[206:207], v247 offset:29184
    s_waitcnt lgkmcnt(8)
    v_mfma_f32_16x16x32_bf16 v[0:3], v[176:179], v[208:211], v[0:3]
    v_mfma_f32_16x16x32_bf16 v[12:15], v[180:183], v[208:211], v[12:15]
    v_exp_f32 v216, v216
    v_mfma_f32_16x16x32_bf16 v[24:27], v[184:187], v[208:211], v[24:27]
    v_exp_f32 v217, v217
    v_mfma_f32_16x16x32_bf16 v[36:39], v[188:191], v[208:211], v[36:39]
    v_exp_f32 v218, v218
    s_waitcnt lgkmcnt(4)
    v_mfma_f32_16x16x32_bf16 v[48:51], v[192:195], v[208:211], v[48:51]
    v_add_f32 v238, v238, v216
    v_add_f32 v239, v239, v217
    v_mfma_f32_16x16x32_bf16 v[60:63], v[196:199], v[208:211], v[60:63]
    v_exp_f32 v219, v219
    s_waitcnt lgkmcnt(0)
    v_mfma_f32_16x16x32_bf16 v[72:75], v[200:203], v[208:211], v[72:75]
    v_cvt_pk_bf16_f32 v216, v216, v217
    v_add_f32 v238, v238, v218
    v_mfma_f32_16x16x32_bf16 v[84:87], v[204:207], v[208:211], v[84:87]
    v_exp_f32 v220, v220
    s_waitcnt vmcnt(12)
    s_barrier
    v_mfma_f32_16x16x32_bf16 v[224:227], v[144:147], v[128:131], v[232:235]
    v_exp_f32 v221, v221
    ds_read_b128 v[144:147], v242 offset:32768
    v_mfma_f32_16x16x32_bf16 v[228:231], v[160:163], v[128:131], v[232:235]
    v_add_f32 v239, v239, v219
    v_cvt_pk_bf16_f32 v217, v218, v219
    ds_read_b128 v[160:163], v242 offset:36864
    v_mfma_f32_16x16x32_bf16 v[224:227], v[148:151], v[132:135], v[224:227]
    v_exp_f32 v222, v222
    ds_read_b128 v[148:151], v243 offset:32768
    v_mfma_f32_16x16x32_bf16 v[228:231], v[164:167], v[132:135], v[228:231]
    v_add_f32 v238, v238, v220
    v_add_f32 v239, v239, v221
    ds_read_b128 v[164:167], v243 offset:36864
    v_mfma_f32_16x16x32_bf16 v[224:227], v[152:155], v[136:139], v[224:227]
    v_exp_f32 v223, v223
    ds_read_b128 v[152:155], v242 offset:33280
    v_mfma_f32_16x16x32_bf16 v[228:231], v[168:171], v[136:139], v[228:231]
    v_cvt_pk_bf16_f32 v218, v220, v221
    v_add_f32 v238, v238, v222
    ds_read_b128 v[168:171], v242 offset:37376
    v_mfma_f32_16x16x32_bf16 v[224:227], v[156:159], v[140:143], v[224:227]
    v_cvt_pk_bf16_f32 v219, v222, v223
    v_add_f32 v239, v239, v223
    ds_read_b128 v[156:159], v243 offset:33280
    v_mfma_f32_16x16x32_bf16 v[228:231], v[172:175], v[140:143], v[228:231]
    ds_read_b128 v[172:175], v243 offset:37376
    v_mfma_f32_16x16x32_bf16 v[4:7], v[176:179], v[216:219], v[4:7]
    s_add_u32 m0, s56, 24576
    s_add_u32 s26, s26, 8192
    s_and_b32 s26, s26, 0x3ffff
    buffer_load_dwordx4 v248, s[12:15], s26 offen nt lds
    v_mfma_f32_16x16x32_bf16 v[16:19], v[180:183], v[216:219], v[16:19]
    v_exp_f32 v224, v224
    v_mfma_f32_16x16x32_bf16 v[28:31], v[184:187], v[216:219], v[28:31]
    v_exp_f32 v225, v225
    buffer_load_dwordx4 v249, s[12:15], s26 offen offset:1024 nt lds
    v_mfma_f32_16x16x32_bf16 v[40:43], v[188:191], v[216:219], v[40:43]
    v_exp_f32 v226, v226
    v_mfma_f32_16x16x32_bf16 v[52:55], v[192:195], v[216:219], v[52:55]
    v_add_f32 v240, v240, v224
    v_add_f32 v241, v241, v225
    s_add_u32 m0, s56, 65536
    s_nop 0
    buffer_load_dwordx4 v248, s[16:19], s26 offen nt lds
    v_mfma_f32_16x16x32_bf16 v[64:67], v[196:199], v[216:219], v[64:67]
    v_exp_f32 v227, v227
    v_mfma_f32_16x16x32_bf16 v[76:79], v[200:203], v[216:219], v[76:79]
    v_cvt_pk_bf16_f32 v224, v224, v225
    v_add_f32 v240, v240, v226
    buffer_load_dwordx4 v249, s[16:19], s26 offen offset:1024 nt lds
    v_mfma_f32_16x16x32_bf16 v[88:91], v[204:207], v[216:219], v[88:91]
    v_exp_f32 v228, v228
    s_waitcnt lgkmcnt(0)
    v_mfma_f32_16x16x32_bf16 v[208:211], v[144:147], v[96:99], v[232:235]
    v_exp_f32 v229, v229
    v_mfma_f32_16x16x32_bf16 v[212:215], v[160:163], v[96:99], v[232:235]
    v_add_f32 v241, v241, v227
    v_cvt_pk_bf16_f32 v225, v226, v227
    v_mfma_f32_16x16x32_bf16 v[208:211], v[148:151], v[100:103], v[208:211]
    v_exp_f32 v230, v230
    v_mfma_f32_16x16x32_bf16 v[212:215], v[164:167], v[100:103], v[212:215]
    v_add_f32 v240, v240, v228
    v_add_f32 v241, v241, v229
    v_mfma_f32_16x16x32_bf16 v[208:211], v[152:155], v[104:107], v[208:211]
    v_exp_f32 v231, v231
    v_mfma_f32_16x16x32_bf16 v[212:215], v[168:171], v[104:107], v[212:215]
    v_cvt_pk_bf16_f32 v226, v228, v229
    v_add_f32 v240, v240, v230
    v_mfma_f32_16x16x32_bf16 v[208:211], v[156:159], v[108:111], v[208:211]
    v_cvt_pk_bf16_f32 v227, v230, v231
    v_add_f32 v241, v241, v231
    v_mfma_f32_16x16x32_bf16 v[212:215], v[172:175], v[108:111], v[212:215]
    v_mfma_f32_16x16x32_bf16 v[8:11], v[176:179], v[224:227], v[8:11]
    ds_read_b64_tr_b16 v[176:177], v244 offset:32768
    v_mfma_f32_16x16x32_bf16 v[20:23], v[180:183], v[224:227], v[20:23]
    s_nop 1
    v_exp_f32 v208, v208
    ds_read_b64_tr_b16 v[178:179], v244 offset:36864
    v_mfma_f32_16x16x32_bf16 v[32:35], v[184:187], v[224:227], v[32:35]
    v_exp_f32 v209, v209
    ds_read_b64_tr_b16 v[180:181], v245 offset:32768
    v_mfma_f32_16x16x32_bf16 v[44:47], v[188:191], v[224:227], v[44:47]
    v_exp_f32 v210, v210
    ds_read_b64_tr_b16 v[182:183], v245 offset:36864
    v_mfma_f32_16x16x32_bf16 v[56:59], v[192:195], v[224:227], v[56:59]
    v_add_f32 v236, v236, v208
    v_add_f32 v237, v237, v209
    ds_read_b64_tr_b16 v[184:185], v246 offset:32768
    v_mfma_f32_16x16x32_bf16 v[68:71], v[196:199], v[224:227], v[68:71]
    v_exp_f32 v211, v211
    ds_read_b64_tr_b16 v[186:187], v246 offset:36864
    v_mfma_f32_16x16x32_bf16 v[80:83], v[200:203], v[224:227], v[80:83]
    v_cvt_pk_bf16_f32 v208, v208, v209
    v_add_f32 v236, v236, v210
    ds_read_b64_tr_b16 v[188:189], v247 offset:32768
    v_mfma_f32_16x16x32_bf16 v[92:95], v[204:207], v[224:227], v[92:95]
    v_exp_f32 v212, v212
    ds_read_b64_tr_b16 v[190:191], v247 offset:36864
    v_mfma_f32_16x16x32_bf16 v[216:219], v[144:147], v[112:115], v[232:235]
    v_exp_f32 v213, v213
    ds_read_b64_tr_b16 v[192:193], v244 offset:33280
    v_mfma_f32_16x16x32_bf16 v[220:223], v[160:163], v[112:115], v[232:235]
    v_add_f32 v237, v237, v211
    v_cvt_pk_bf16_f32 v209, v210, v211
    ds_read_b64_tr_b16 v[194:195], v244 offset:37376
    v_mfma_f32_16x16x32_bf16 v[216:219], v[148:151], v[116:119], v[216:219]
    v_exp_f32 v214, v214
    ds_read_b64_tr_b16 v[196:197], v245 offset:33280
    v_mfma_f32_16x16x32_bf16 v[220:223], v[164:167], v[116:119], v[220:223]
    v_add_f32 v236, v236, v212
    v_add_f32 v237, v237, v213
    ds_read_b64_tr_b16 v[198:199], v245 offset:37376
    v_mfma_f32_16x16x32_bf16 v[216:219], v[152:155], v[120:123], v[216:219]
    v_exp_f32 v215, v215
    ds_read_b64_tr_b16 v[200:201], v246 offset:33280
    v_mfma_f32_16x16x32_bf16 v[220:223], v[168:171], v[120:123], v[220:223]
    v_cvt_pk_bf16_f32 v210, v212, v213
    v_add_f32 v236, v236, v214
    ds_read_b64_tr_b16 v[202:203], v246 offset:37376
    v_mfma_f32_16x16x32_bf16 v[216:219], v[156:159], v[124:127], v[216:219]
    v_cvt_pk_bf16_f32 v211, v214, v215
    v_add_f32 v237, v237, v215
    ds_read_b64_tr_b16 v[204:205], v247 offset:33280
    v_mfma_f32_16x16x32_bf16 v[220:223], v[172:175], v[124:127], v[220:223]
    ds_read_b64_tr_b16 v[206:207], v247 offset:37376
    s_waitcnt lgkmcnt(8)
    v_mfma_f32_16x16x32_bf16 v[0:3], v[176:179], v[208:211], v[0:3]
    v_mfma_f32_16x16x32_bf16 v[12:15], v[180:183], v[208:211], v[12:15]
    v_exp_f32 v216, v216
    v_mfma_f32_16x16x32_bf16 v[24:27], v[184:187], v[208:211], v[24:27]
    v_exp_f32 v217, v217
    v_mfma_f32_16x16x32_bf16 v[36:39], v[188:191], v[208:211], v[36:39]
    v_exp_f32 v218, v218
    s_waitcnt lgkmcnt(4)
    v_mfma_f32_16x16x32_bf16 v[48:51], v[192:195], v[208:211], v[48:51]
    v_add_f32 v238, v238, v216
    v_add_f32 v239, v239, v217
    v_mfma_f32_16x16x32_bf16 v[60:63], v[196:199], v[208:211], v[60:63]
    v_exp_f32 v219, v219
    s_waitcnt lgkmcnt(0)
    v_mfma_f32_16x16x32_bf16 v[72:75], v[200:203], v[208:211], v[72:75]
    v_cvt_pk_bf16_f32 v216, v216, v217
    v_add_f32 v238, v238, v218
    v_mfma_f32_16x16x32_bf16 v[84:87], v[204:207], v[208:211], v[84:87]
    v_exp_f32 v220, v220
    s_waitcnt vmcnt(12)
    s_barrier
    v_mfma_f32_16x16x32_bf16 v[224:227], v[144:147], v[128:131], v[232:235]
    v_exp_f32 v221, v221
    ds_read_b128 v[144:147], v242 offset:0
    v_mfma_f32_16x16x32_bf16 v[228:231], v[160:163], v[128:131], v[232:235]
    v_add_f32 v239, v239, v219
    v_cvt_pk_bf16_f32 v217, v218, v219
    ds_read_b128 v[160:163], v242 offset:4096
    v_mfma_f32_16x16x32_bf16 v[224:227], v[148:151], v[132:135], v[224:227]
    v_exp_f32 v222, v222
    ds_read_b128 v[148:151], v243 offset:0
    v_mfma_f32_16x16x32_bf16 v[228:231], v[164:167], v[132:135], v[228:231]
    v_add_f32 v238, v238, v220
    v_add_f32 v239, v239, v221
    ds_read_b128 v[164:167], v243 offset:4096
    v_mfma_f32_16x16x32_bf16 v[224:227], v[152:155], v[136:139], v[224:227]
    v_exp_f32 v223, v223
    ds_read_b128 v[152:155], v242 offset:512
    v_mfma_f32_16x16x32_bf16 v[228:231], v[168:171], v[136:139], v[228:231]
    v_cvt_pk_bf16_f32 v218, v220, v221
    v_add_f32 v238, v238, v222
    ds_read_b128 v[168:171], v242 offset:4608
    v_mfma_f32_16x16x32_bf16 v[224:227], v[156:159], v[140:143], v[224:227]
    v_cvt_pk_bf16_f32 v219, v222, v223
    v_add_f32 v239, v239, v223
    ds_read_b128 v[156:159], v243 offset:512
    v_mfma_f32_16x16x32_bf16 v[228:231], v[172:175], v[140:143], v[228:231]
    ds_read_b128 v[172:175], v243 offset:4608
    v_mfma_f32_16x16x32_bf16 v[4:7], v[176:179], v[216:219], v[4:7]
    s_add_u32 m0, s56, 32768
    s_add_u32 s26, s26, 8192
    s_and_b32 s26, s26, 0x3ffff
    buffer_load_dwordx4 v248, s[12:15], s26 offen nt lds
    v_mfma_f32_16x16x32_bf16 v[16:19], v[180:183], v[216:219], v[16:19]
    v_exp_f32 v224, v224
    v_mfma_f32_16x16x32_bf16 v[28:31], v[184:187], v[216:219], v[28:31]
    v_exp_f32 v225, v225
    buffer_load_dwordx4 v249, s[12:15], s26 offen offset:1024 nt lds
    v_mfma_f32_16x16x32_bf16 v[40:43], v[188:191], v[216:219], v[40:43]
    v_exp_f32 v226, v226
    v_mfma_f32_16x16x32_bf16 v[52:55], v[192:195], v[216:219], v[52:55]
    v_add_f32 v240, v240, v224
    v_add_f32 v241, v241, v225
    s_add_u32 m0, s56, 73728
    s_nop 0
    buffer_load_dwordx4 v248, s[16:19], s26 offen nt lds
    v_mfma_f32_16x16x32_bf16 v[64:67], v[196:199], v[216:219], v[64:67]
    v_exp_f32 v227, v227
    v_mfma_f32_16x16x32_bf16 v[76:79], v[200:203], v[216:219], v[76:79]
    v_cvt_pk_bf16_f32 v224, v224, v225
    v_add_f32 v240, v240, v226
    buffer_load_dwordx4 v249, s[16:19], s26 offen offset:1024 nt lds
    v_mfma_f32_16x16x32_bf16 v[88:91], v[204:207], v[216:219], v[88:91]
    v_exp_f32 v228, v228
    s_waitcnt lgkmcnt(0)
    v_mfma_f32_16x16x32_bf16 v[208:211], v[144:147], v[96:99], v[232:235]
    v_exp_f32 v229, v229
    v_mfma_f32_16x16x32_bf16 v[212:215], v[160:163], v[96:99], v[232:235]
    v_add_f32 v241, v241, v227
    v_cvt_pk_bf16_f32 v225, v226, v227
    v_mfma_f32_16x16x32_bf16 v[208:211], v[148:151], v[100:103], v[208:211]
    v_exp_f32 v230, v230
    v_mfma_f32_16x16x32_bf16 v[212:215], v[164:167], v[100:103], v[212:215]
    v_add_f32 v240, v240, v228
    v_add_f32 v241, v241, v229
    v_mfma_f32_16x16x32_bf16 v[208:211], v[152:155], v[104:107], v[208:211]
    v_exp_f32 v231, v231
    v_mfma_f32_16x16x32_bf16 v[212:215], v[168:171], v[104:107], v[212:215]
    v_cvt_pk_bf16_f32 v226, v228, v229
    v_add_f32 v240, v240, v230
    v_mfma_f32_16x16x32_bf16 v[208:211], v[156:159], v[108:111], v[208:211]
    v_cvt_pk_bf16_f32 v227, v230, v231
    v_add_f32 v241, v241, v231
    v_mfma_f32_16x16x32_bf16 v[212:215], v[172:175], v[108:111], v[212:215]
    v_mfma_f32_16x16x32_bf16 v[8:11], v[176:179], v[224:227], v[8:11]
    ds_read_b64_tr_b16 v[176:177], v244 offset:0
    v_mfma_f32_16x16x32_bf16 v[20:23], v[180:183], v[224:227], v[20:23]
    s_nop 1
    v_exp_f32 v208, v208
    ds_read_b64_tr_b16 v[178:179], v244 offset:4096
    v_mfma_f32_16x16x32_bf16 v[32:35], v[184:187], v[224:227], v[32:35]
    v_exp_f32 v209, v209
    ds_read_b64_tr_b16 v[180:181], v245 offset:0
    v_mfma_f32_16x16x32_bf16 v[44:47], v[188:191], v[224:227], v[44:47]
    v_exp_f32 v210, v210
    ds_read_b64_tr_b16 v[182:183], v245 offset:4096
    v_mfma_f32_16x16x32_bf16 v[56:59], v[192:195], v[224:227], v[56:59]
    v_add_f32 v236, v236, v208
    v_add_f32 v237, v237, v209
    ds_read_b64_tr_b16 v[184:185], v246 offset:0
    v_mfma_f32_16x16x32_bf16 v[68:71], v[196:199], v[224:227], v[68:71]
    v_exp_f32 v211, v211
    ds_read_b64_tr_b16 v[186:187], v246 offset:4096
    v_mfma_f32_16x16x32_bf16 v[80:83], v[200:203], v[224:227], v[80:83]
    v_cvt_pk_bf16_f32 v208, v208, v209
    v_add_f32 v236, v236, v210
    ds_read_b64_tr_b16 v[188:189], v247 offset:0
    v_mfma_f32_16x16x32_bf16 v[92:95], v[204:207], v[224:227], v[92:95]
    v_exp_f32 v212, v212
    ds_read_b64_tr_b16 v[190:191], v247 offset:4096
    v_mfma_f32_16x16x32_bf16 v[216:219], v[144:147], v[112:115], v[232:235]
    v_exp_f32 v213, v213
    ds_read_b64_tr_b16 v[192:193], v244 offset:512
    v_mfma_f32_16x16x32_bf16 v[220:223], v[160:163], v[112:115], v[232:235]
    v_add_f32 v237, v237, v211
    v_cvt_pk_bf16_f32 v209, v210, v211
    ds_read_b64_tr_b16 v[194:195], v244 offset:4608
    v_mfma_f32_16x16x32_bf16 v[216:219], v[148:151], v[116:119], v[216:219]
    v_exp_f32 v214, v214
    ds_read_b64_tr_b16 v[196:197], v245 offset:512
    v_mfma_f32_16x16x32_bf16 v[220:223], v[164:167], v[116:119], v[220:223]
    v_add_f32 v236, v236, v212
    v_add_f32 v237, v237, v213
    ds_read_b64_tr_b16 v[198:199], v245 offset:4608
    v_mfma_f32_16x16x32_bf16 v[216:219], v[152:155], v[120:123], v[216:219]
    v_exp_f32 v215, v215
    ds_read_b64_tr_b16 v[200:201], v246 offset:512
    v_mfma_f32_16x16x32_bf16 v[220:223], v[168:171], v[120:123], v[220:223]
    v_cvt_pk_bf16_f32 v210, v212, v213
    v_add_f32 v236, v236, v214
    ds_read_b64_tr_b16 v[202:203], v246 offset:4608
    v_mfma_f32_16x16x32_bf16 v[216:219], v[156:159], v[124:127], v[216:219]
    v_cvt_pk_bf16_f32 v211, v214, v215
    v_add_f32 v237, v237, v215
    ds_read_b64_tr_b16 v[204:205], v247 offset:512
    v_mfma_f32_16x16x32_bf16 v[220:223], v[172:175], v[124:127], v[220:223]
    ds_read_b64_tr_b16 v[206:207], v247 offset:4608
    s_waitcnt lgkmcnt(8)
    v_mfma_f32_16x16x32_bf16 v[0:3], v[176:179], v[208:211], v[0:3]
    v_mfma_f32_16x16x32_bf16 v[12:15], v[180:183], v[208:211], v[12:15]
    v_exp_f32 v216, v216
    v_mfma_f32_16x16x32_bf16 v[24:27], v[184:187], v[208:211], v[24:27]
    v_exp_f32 v217, v217
    v_mfma_f32_16x16x32_bf16 v[36:39], v[188:191], v[208:211], v[36:39]
    v_exp_f32 v218, v218
    s_waitcnt lgkmcnt(4)
    v_mfma_f32_16x16x32_bf16 v[48:51], v[192:195], v[208:211], v[48:51]
    v_add_f32 v238, v238, v216
    v_add_f32 v239, v239, v217
    v_mfma_f32_16x16x32_bf16 v[60:63], v[196:199], v[208:211], v[60:63]
    v_exp_f32 v219, v219
    s_waitcnt lgkmcnt(0)
    v_mfma_f32_16x16x32_bf16 v[72:75], v[200:203], v[208:211], v[72:75]
    v_cvt_pk_bf16_f32 v216, v216, v217
    v_add_f32 v238, v238, v218
    v_mfma_f32_16x16x32_bf16 v[84:87], v[204:207], v[208:211], v[84:87]
    v_exp_f32 v220, v220
    s_waitcnt vmcnt(12)
    s_barrier
    v_mfma_f32_16x16x32_bf16 v[224:227], v[144:147], v[128:131], v[232:235]
    v_exp_f32 v221, v221
    ds_read_b128 v[144:147], v242 offset:8192
    v_mfma_f32_16x16x32_bf16 v[228:231], v[160:163], v[128:131], v[232:235]
    v_add_f32 v239, v239, v219
    v_cvt_pk_bf16_f32 v217, v218, v219
    ds_read_b128 v[160:163], v242 offset:12288
    v_mfma_f32_16x16x32_bf16 v[224:227], v[148:151], v[132:135], v[224:227]
    v_exp_f32 v222, v222
    ds_read_b128 v[148:151], v243 offset:8192
    v_mfma_f32_16x16x32_bf16 v[228:231], v[164:167], v[132:135], v[228:231]
    v_add_f32 v238, v238, v220
    v_add_f32 v239, v239, v221
    ds_read_b128 v[164:167], v243 offset:12288
    v_mfma_f32_16x16x32_bf16 v[224:227], v[152:155], v[136:139], v[224:227]
    v_exp_f32 v223, v223
    ds_read_b128 v[152:155], v242 offset:8704
    v_mfma_f32_16x16x32_bf16 v[228:231], v[168:171], v[136:139], v[228:231]
    v_cvt_pk_bf16_f32 v218, v220, v221
    v_add_f32 v238, v238, v222
    ds_read_b128 v[168:171], v242 offset:12800
    v_mfma_f32_16x16x32_bf16 v[224:227], v[156:159], v[140:143], v[224:227]
    v_cvt_pk_bf16_f32 v219, v222, v223
    v_add_f32 v239, v239, v223
    ds_read_b128 v[156:159], v243 offset:8704
    v_mfma_f32_16x16x32_bf16 v[228:231], v[172:175], v[140:143], v[228:231]
    ds_read_b128 v[172:175], v243 offset:12800
    v_mfma_f32_16x16x32_bf16 v[4:7], v[176:179], v[216:219], v[4:7]
    s_add_u32 m0, s56, 0
    s_add_u32 s26, s26, 8192
    s_and_b32 s26, s26, 0x3ffff
    buffer_load_dwordx4 v248, s[12:15], s26 offen nt lds
    v_mfma_f32_16x16x32_bf16 v[16:19], v[180:183], v[216:219], v[16:19]
    v_exp_f32 v224, v224
    v_mfma_f32_16x16x32_bf16 v[28:31], v[184:187], v[216:219], v[28:31]
    v_exp_f32 v225, v225
    buffer_load_dwordx4 v249, s[12:15], s26 offen offset:1024 nt lds
    v_mfma_f32_16x16x32_bf16 v[40:43], v[188:191], v[216:219], v[40:43]
    v_exp_f32 v226, v226
    v_mfma_f32_16x16x32_bf16 v[52:55], v[192:195], v[216:219], v[52:55]
    v_add_f32 v240, v240, v224
    v_add_f32 v241, v241, v225
    s_add_u32 m0, s56, 40960
    s_nop 0
    buffer_load_dwordx4 v248, s[16:19], s26 offen nt lds
    v_mfma_f32_16x16x32_bf16 v[64:67], v[196:199], v[216:219], v[64:67]
    v_exp_f32 v227, v227
    v_mfma_f32_16x16x32_bf16 v[76:79], v[200:203], v[216:219], v[76:79]
    v_cvt_pk_bf16_f32 v224, v224, v225
    v_add_f32 v240, v240, v226
    buffer_load_dwordx4 v249, s[16:19], s26 offen offset:1024 nt lds
    v_mfma_f32_16x16x32_bf16 v[88:91], v[204:207], v[216:219], v[88:91]
    v_exp_f32 v228, v228
    s_sub_u32 s25, s25, 1
    s_cmp_lg_u32 s25, 0
    s_cbranch_scc1 K1_loop
    s_waitcnt lgkmcnt(0)
    v_mfma_f32_16x16x32_bf16 v[208:211], v[144:147], v[96:99], v[232:235]
    v_exp_f32 v229, v229
    v_mfma_f32_16x16x32_bf16 v[212:215], v[160:163], v[96:99], v[232:235]
    v_add_f32 v241, v241, v227
    v_cvt_pk_bf16_f32 v225, v226, v227
    v_mfma_f32_16x16x32_bf16 v[208:211], v[148:151], v[100:103], v[208:211]
    v_exp_f32 v230, v230
    v_mfma_f32_16x16x32_bf16 v[212:215], v[164:167], v[100:103], v[212:215]
    v_add_f32 v240, v240, v228
    v_add_f32 v241, v241, v229
    v_mfma_f32_16x16x32_bf16 v[208:211], v[152:155], v[104:107], v[208:211]
    v_exp_f32 v231, v231
    v_mfma_f32_16x16x32_bf16 v[212:215], v[168:171], v[104:107], v[212:215]
    v_cvt_pk_bf16_f32 v226, v228, v229
    v_add_f32 v240, v240, v230
    v_mfma_f32_16x16x32_bf16 v[208:211], v[156:159], v[108:111], v[208:211]
    v_cvt_pk_bf16_f32 v227, v230, v231
    v_add_f32 v241, v241, v231
    v_mfma_f32_16x16x32_bf16 v[212:215], v[172:175], v[108:111], v[212:215]
    v_mfma_f32_16x16x32_bf16 v[8:11], v[176:179], v[224:227], v[8:11]
    ds_read_b64_tr_b16 v[176:177], v244 offset:8192
    v_mfma_f32_16x16x32_bf16 v[20:23], v[180:183], v[224:227], v[20:23]
    s_nop 1
    v_exp_f32 v208, v208
    ds_read_b64_tr_b16 v[178:179], v244 offset:12288
    v_mfma_f32_16x16x32_bf16 v[32:35], v[184:187], v[224:227], v[32:35]
    v_exp_f32 v209, v209
    ds_read_b64_tr_b16 v[180:181], v245 offset:8192
    v_mfma_f32_16x16x32_bf16 v[44:47], v[188:191], v[224:227], v[44:47]
    v_exp_f32 v210, v210
    ds_read_b64_tr_b16 v[182:183], v245 offset:12288
    v_mfma_f32_16x16x32_bf16 v[56:59], v[192:195], v[224:227], v[56:59]
    v_add_f32 v236, v236, v208
    v_add_f32 v237, v237, v209
    ds_read_b64_tr_b16 v[184:185], v246 offset:8192
    v_mfma_f32_16x16x32_bf16 v[68:71], v[196:199], v[224:227], v[68:71]
    v_exp_f32 v211, v211
    ds_read_b64_tr_b16 v[186:187], v246 offset:12288
    v_mfma_f32_16x16x32_bf16 v[80:83], v[200:203], v[224:227], v[80:83]
    v_cvt_pk_bf16_f32 v208, v208, v209
    v_add_f32 v236, v236, v210
    ds_read_b64_tr_b16 v[188:189], v247 offset:8192
    v_mfma_f32_16x16x32_bf16 v[92:95], v[204:207], v[224:227], v[92:95]
    v_exp_f32 v212, v212
    ds_read_b64_tr_b16 v[190:191], v247 offset:12288
    v_mfma_f32_16x16x32_bf16 v[216:219], v[144:147], v[112:115], v[232:235]
    v_exp_f32 v213, v213
    ds_read_b64_tr_b16 v[192:193], v244 offset:8704
    v_mfma_f32_16x16x32_bf16 v[220:223], v[160:163], v[112:115], v[232:235]
    v_add_f32 v237, v237, v211
    v_cvt_pk_bf16_f32 v209, v210, v211
    ds_read_b64_tr_b16 v[194:195], v244 offset:12800
    v_mfma_f32_16x16x32_bf16 v[216:219], v[148:151], v[116:119], v[216:219]
    v_exp_f32 v214, v214
    ds_read_b64_tr_b16 v[196:197], v245 offset:8704
    v_mfma_f32_16x16x32_bf16 v[220:223], v[164:167], v[116:119], v[220:223]
    v_add_f32 v236, v236, v212
    v_add_f32 v237, v237, v213
    ds_read_b64_tr_b16 v[198:199], v245 offset:12800
    v_mfma_f32_16x16x32_bf16 v[216:219], v[152:155], v[120:123], v[216:219]
    v_exp_f32 v215, v215
    ds_read_b64_tr_b16 v[200:201], v246 offset:8704
    v_mfma_f32_16x16x32_bf16 v[220:223], v[168:171], v[120:123], v[220:223]
    v_cvt_pk_bf16_f32 v210, v212, v213
    v_add_f32 v236, v236, v214
    ds_read_b64_tr_b16 v[202:203], v246 offset:12800
    v_mfma_f32_16x16x32_bf16 v[216:219], v[156:159], v[124:127], v[216:219]
    v_cvt_pk_bf16_f32 v211, v214, v215
    v_add_f32 v237, v237, v215
    ds_read_b64_tr_b16 v[204:205], v247 offset:8704
    v_mfma_f32_16x16x32_bf16 v[220:223], v[172:175], v[124:127], v[220:223]
    ds_read_b64_tr_b16 v[206:207], v247 offset:12800
    s_waitcnt lgkmcnt(8)
    v_mfma_f32_16x16x32_bf16 v[0:3], v[176:179], v[208:211], v[0:3]
    v_mfma_f32_16x16x32_bf16 v[12:15], v[180:183], v[208:211], v[12:15]
    v_exp_f32 v216, v216
    v_mfma_f32_16x16x32_bf16 v[24:27], v[184:187], v[208:211], v[24:27]
    v_exp_f32 v217, v217
    v_mfma_f32_16x16x32_bf16 v[36:39], v[188:191], v[208:211], v[36:39]
    v_exp_f32 v218, v218
    s_waitcnt lgkmcnt(4)
    v_mfma_f32_16x16x32_bf16 v[48:51], v[192:195], v[208:211], v[48:51]
    v_add_f32 v238, v238, v216
    v_add_f32 v239, v239, v217
    v_mfma_f32_16x16x32_bf16 v[60:63], v[196:199], v[208:211], v[60:63]
    v_exp_f32 v219, v219
    s_waitcnt lgkmcnt(0)
    v_mfma_f32_16x16x32_bf16 v[72:75], v[200:203], v[208:211], v[72:75]
    v_cvt_pk_bf16_f32 v216, v216, v217
    v_add_f32 v238, v238, v218
    v_mfma_f32_16x16x32_bf16 v[84:87], v[204:207], v[208:211], v[84:87]
    v_exp_f32 v220, v220
    s_waitcnt vmcnt(12)
    s_barrier
    v_mfma_f32_16x16x32_bf16 v[224:227], v[144:147], v[128:131], v[232:235]
    v_exp_f32 v221, v221
    ds_read_b128 v[144:147], v242 offset:16384
    v_mfma_f32_16x16x32_bf16 v[228:231], v[160:163], v[128:131], v[232:235]
    v_add_f32 v239, v239, v219
    v_cvt_pk_bf16_f32 v217, v218, v219
    ds_read_b128 v[160:163], v242 offset:20480
    v_mfma_f32_16x16x32_bf16 v[224:227], v[148:151], v[132:135], v[224:227]
    v_exp_f32 v222, v222
    ds_read_b128 v[148:151], v243 offset:16384
    v_mfma_f32_16x16x32_bf16 v[228:231], v[164:167], v[132:135], v[228:231]
    v_add_f32 v238, v238, v220
    v_add_f32 v239, v239, v221
    ds_read_b128 v[164:167], v243 offset:20480
    v_mfma_f32_16x16x32_bf16 v[224:227], v[152:155], v[136:139], v[224:227]
    v_exp_f32 v223, v223
    ds_read_b128 v[152:155], v242 offset:16896
    v_mfma_f32_16x16x32_bf16 v[228:231], v[168:171], v[136:139], v[228:231]
    v_cvt_pk_bf16_f32 v218, v220, v221
    v_add_f32 v238, v238, v222
    ds_read_b128 v[168:171], v242 offset:20992
    v_mfma_f32_16x16x32_bf16 v[224:227], v[156:159], v[140:143], v[224:227]
    v_cvt_pk_bf16_f32 v219, v222, v223
    v_add_f32 v239, v239, v223
    ds_read_b128 v[156:159], v243 offset:16896
    v_mfma_f32_16x16x32_bf16 v[228:231], v[172:175], v[140:143], v[228:231]
    ds_read_b128 v[172:175], v243 offset:20992
    v_mfma_f32_16x16x32_bf16 v[4:7], v[176:179], v[216:219], v[4:7]
    s_add_u32 m0, s56, 8192
    s_add_u32 s26, s26, 8192
    s_and_b32 s26, s26, 0x3ffff
    buffer_load_dwordx4 v248, s[12:15], s26 offen nt lds
    v_mfma_f32_16x16x32_bf16 v[16:19], v[180:183], v[216:219], v[16:19]
    v_exp_f32 v224, v224
    v_mfma_f32_16x16x32_bf16 v[28:31], v[184:187], v[216:219], v[28:31]
    v_exp_f32 v225, v225
    buffer_load_dwordx4 v249, s[12:15], s26 offen offset:1024 nt lds
    v_mfma_f32_16x16x32_bf16 v[40:43], v[188:191], v[216:219], v[40:43]
    v_exp_f32 v226, v226
    v_mfma_f32_16x16x32_bf16 v[52:55], v[192:195], v[216:219], v[52:55]
    v_add_f32 v240, v240, v224
    v_add_f32 v241, v241, v225
    s_add_u32 m0, s56, 49152
    s_nop 0
    buffer_load_dwordx4 v248, s[16:19], s26 offen nt lds
    v_mfma_f32_16x16x32_bf16 v[64:67], v[196:199], v[216:219], v[64:67]
    v_exp_f32 v227, v227
    v_mfma_f32_16x16x32_bf16 v[76:79], v[200:203], v[216:219], v[76:79]
    v_cvt_pk_bf16_f32 v224, v224, v225
    v_add_f32 v240, v240, v226
    buffer_load_dwordx4 v249, s[16:19], s26 offen offset:1024 nt lds
    v_mfma_f32_16x16x32_bf16 v[88:91], v[204:207], v[216:219], v[88:91]
    v_exp_f32 v228, v228
    s_waitcnt lgkmcnt(0)
    v_mfma_f32_16x16x32_bf16 v[208:211], v[144:147], v[96:99], v[232:235]
    v_exp_f32 v229, v229
    v_mfma_f32_16x16x32_bf16 v[212:215], v[160:163], v[96:99], v[232:235]
    v_add_f32 v241, v241, v227
    v_cvt_pk_bf16_f32 v225, v226, v227
    v_mfma_f32_16x16x32_bf16 v[208:211], v[148:151], v[100:103], v[208:211]
    v_exp_f32 v230, v230
    v_mfma_f32_16x16x32_bf16 v[212:215], v[164:167], v[100:103], v[212:215]
    v_add_f32 v240, v240, v228
    v_add_f32 v241, v241, v229
    v_mfma_f32_16x16x32_bf16 v[208:211], v[152:155], v[104:107], v[208:211]
    v_exp_f32 v231, v231
    v_mfma_f32_16x16x32_bf16 v[212:215], v[168:171], v[104:107], v[212:215]
    v_cvt_pk_bf16_f32 v226, v228, v229
    v_add_f32 v240, v240, v230
    v_mfma_f32_16x16x32_bf16 v[208:211], v[156:159], v[108:111], v[208:211]
    v_cvt_pk_bf16_f32 v227, v230, v231
    v_add_f32 v241, v241, v231
    v_mfma_f32_16x16x32_bf16 v[212:215], v[172:175], v[108:111], v[212:215]
    v_mfma_f32_16x16x32_bf16 v[8:11], v[176:179], v[224:227], v[8:11]
    ds_read_b64_tr_b16 v[176:177], v244 offset:16384
    v_mfma_f32_16x16x32_bf16 v[20:23], v[180:183], v[224:227], v[20:23]
    s_nop 1
    v_exp_f32 v208, v208
    ds_read_b64_tr_b16 v[178:179], v244 offset:20480
    v_mfma_f32_16x16x32_bf16 v[32:35], v[184:187], v[224:227], v[32:35]
    v_exp_f32 v209, v209
    ds_read_b64_tr_b16 v[180:181], v245 offset:16384
    v_mfma_f32_16x16x32_bf16 v[44:47], v[188:191], v[224:227], v[44:47]
    v_exp_f32 v210, v210
    ds_read_b64_tr_b16 v[182:183], v245 offset:20480
    v_mfma_f32_16x16x32_bf16 v[56:59], v[192:195], v[224:227], v[56:59]
    v_add_f32 v236, v236, v208
    v_add_f32 v237, v237, v209
    ds_read_b64_tr_b16 v[184:185], v246 offset:16384
    v_mfma_f32_16x16x32_bf16 v[68:71], v[196:199], v[224:227], v[68:71]
    v_exp_f32 v211, v211
    ds_read_b64_tr_b16 v[186:187], v246 offset:20480
    v_mfma_f32_16x16x32_bf16 v[80:83], v[200:203], v[224:227], v[80:83]
    v_cvt_pk_bf16_f32 v208, v208, v209
    v_add_f32 v236, v236, v210
    ds_read_b64_tr_b16 v[188:189], v247 offset:16384
    v_mfma_f32_16x16x32_bf16 v[92:95], v[204:207], v[224:227], v[92:95]
    v_exp_f32 v212, v212
    ds_read_b64_tr_b16 v[190:191], v247 offset:20480
    v_mfma_f32_16x16x32_bf16 v[216:219], v[144:147], v[112:115], v[232:235]
    v_exp_f32 v213, v213
    ds_read_b64_tr_b16 v[192:193], v244 offset:16896
    v_mfma_f32_16x16x32_bf16 v[220:223], v[160:163], v[112:115], v[232:235]
    v_add_f32 v237, v237, v211
    v_cvt_pk_bf16_f32 v209, v210, v211
    ds_read_b64_tr_b16 v[194:195], v244 offset:20992
    v_mfma_f32_16x16x32_bf16 v[216:219], v[148:151], v[116:119], v[216:219]
    v_exp_f32 v214, v214
    ds_read_b64_tr_b16 v[196:197], v245 offset:16896
    v_mfma_f32_16x16x32_bf16 v[220:223], v[164:167], v[116:119], v[220:223]
    v_add_f32 v236, v236, v212
    v_add_f32 v237, v237, v213
    ds_read_b64_tr_b16 v[198:199], v245 offset:20992
    v_mfma_f32_16x16x32_bf16 v[216:219], v[152:155], v[120:123], v[216:219]
    v_exp_f32 v215, v215
    ds_read_b64_tr_b16 v[200:201], v246 offset:16896
    v_mfma_f32_16x16x32_bf16 v[220:223], v[168:171], v[120:123], v[220:223]
    v_cvt_pk_bf16_f32 v210, v212, v213
    v_add_f32 v236, v236, v214
    ds_read_b64_tr_b16 v[202:203], v246 offset:20992
    v_mfma_f32_16x16x32_bf16 v[216:219], v[156:159], v[124:127], v[216:219]
    v_cvt_pk_bf16_f32 v211, v214, v215
    v_add_f32 v237, v237, v215
    ds_read_b64_tr_b16 v[204:205], v247 offset:16896
    v_mfma_f32_16x16x32_bf16 v[220:223], v[172:175], v[124:127], v[220:223]
    ds_read_b64_tr_b16 v[206:207], v247 offset:20992
    s_waitcnt lgkmcnt(8)
    v_mfma_f32_16x16x32_bf16 v[0:3], v[176:179], v[208:211], v[0:3]
    v_mfma_f32_16x16x32_bf16 v[12:15], v[180:183], v[208:211], v[12:15]
    v_exp_f32 v216, v216
    v_mfma_f32_16x16x32_bf16 v[24:27], v[184:187], v[208:211], v[24:27]
    v_exp_f32 v217, v217
    v_mfma_f32_16x16x32_bf16 v[36:39], v[188:191], v[208:211], v[36:39]
    v_exp_f32 v218, v218
    s_waitcnt lgkmcnt(4)
    v_mfma_f32_16x16x32_bf16 v[48:51], v[192:195], v[208:211], v[48:51]
    v_add_f32 v238, v238, v216
    v_add_f32 v239, v239, v217
    v_mfma_f32_16x16x32_bf16 v[60:63], v[196:199], v[208:211], v[60:63]
    v_exp_f32 v219, v219
    s_waitcnt lgkmcnt(0)
    v_mfma_f32_16x16x32_bf16 v[72:75], v[200:203], v[208:211], v[72:75]
    v_cvt_pk_bf16_f32 v216, v216, v217
    v_add_f32 v238, v238, v218
    v_mfma_f32_16x16x32_bf16 v[84:87], v[204:207], v[208:211], v[84:87]
    v_exp_f32 v220, v220
    s_waitcnt vmcnt(12)
    s_barrier
    v_mfma_f32_16x16x32_bf16 v[224:227], v[144:147], v[128:131], v[232:235]
    v_exp_f32 v221, v221
    ds_read_b128 v[144:147], v242 offset:24576
    v_mfma_f32_16x16x32_bf16 v[228:231], v[160:163], v[128:131], v[232:235]
    v_add_f32 v239, v239, v219
    v_cvt_pk_bf16_f32 v217, v218, v219
    ds_read_b128 v[160:163], v242 offset:28672
    v_mfma_f32_16x16x32_bf16 v[224:227], v[148:151], v[132:135], v[224:227]
    v_exp_f32 v222, v222
    ds_read_b128 v[148:151], v243 offset:24576
    v_mfma_f32_16x16x32_bf16 v[228:231], v[164:167], v[132:135], v[228:231]
    v_add_f32 v238, v238, v220
    v_add_f32 v239, v239, v221
    ds_read_b128 v[164:167], v243 offset:28672
    v_mfma_f32_16x16x32_bf16 v[224:227], v[152:155], v[136:139], v[224:227]
    v_exp_f32 v223, v223
    ds_read_b128 v[152:155], v242 offset:25088
    v_mfma_f32_16x16x32_bf16 v[228:231], v[168:171], v[136:139], v[228:231]
    v_cvt_pk_bf16_f32 v218, v220, v221
    v_add_f32 v238, v238, v222
    ds_read_b128 v[168:171], v242 offset:29184
    v_mfma_f32_16x16x32_bf16 v[224:227], v[156:159], v[140:143], v[224:227]
    v_cvt_pk_bf16_f32 v219, v222, v223
    v_add_f32 v239, v239, v223
    ds_read_b128 v[156:159], v243 offset:25088
    v_mfma_f32_16x16x32_bf16 v[228:231], v[172:175], v[140:143], v[228:231]
    ds_read_b128 v[172:175], v243 offset:29184
    v_mfma_f32_16x16x32_bf16 v[4:7], v[176:179], v[216:219], v[4:7]
    v_mfma_f32_16x16x32_bf16 v[16:19], v[180:183], v[216:219], v[16:19]
    s_nop 0
    v_exp_f32 v224, v224
    v_mfma_f32_16x16x32_bf16 v[28:31], v[184:187], v[216:219], v[28:31]
    v_exp_f32 v225, v225
    v_mfma_f32_16x16x32_bf16 v[40:43], v[188:191], v[216:219], v[40:43]
    v_exp_f32 v226, v226
    v_mfma_f32_16x16x32_bf16 v[52:55], v[192:195], v[216:219], v[52:55]
    v_add_f32 v240, v240, v224
    v_add_f32 v241, v241, v225
    v_mfma_f32_16x16x32_bf16 v[64:67], v[196:199], v[216:219], v[64:67]
    v_exp_f32 v227, v227
    v_mfma_f32_16x16x32_bf16 v[76:79], v[200:203], v[216:219], v[76:79]
    v_cvt_pk_bf16_f32 v224, v224, v225
    v_add_f32 v240, v240, v226
    v_mfma_f32_16x16x32_bf16 v[88:91], v[204:207], v[216:219], v[88:91]
    v_exp_f32 v228, v228
    s_waitcnt lgkmcnt(0)
    v_mfma_f32_16x16x32_bf16 v[208:211], v[144:147], v[96:99], v[232:235]
    v_exp_f32 v229, v229
    v_mfma_f32_16x16x32_bf16 v[212:215], v[160:163], v[96:99], v[232:235]
    v_add_f32 v241, v241, v227
    v_cvt_pk_bf16_f32 v225, v226, v227
    v_mfma_f32_16x16x32_bf16 v[208:211], v[148:151], v[100:103], v[208:211]
    v_exp_f32 v230, v230
    v_mfma_f32_16x16x32_bf16 v[212:215], v[164:167], v[100:103], v[212:215]
    v_add_f32 v240, v240, v228
    v_add_f32 v241, v241, v229
    v_mfma_f32_16x16x32_bf16 v[208:211], v[152:155], v[104:107], v[208:211]
    v_exp_f32 v231, v231
    v_mfma_f32_16x16x32_bf16 v[212:215], v[168:171], v[104:107], v[212:215]
    v_cvt_pk_bf16_f32 v226, v228, v229
    v_add_f32 v240, v240, v230
    v_mfma_f32_16x16x32_bf16 v[208:211], v[156:159], v[108:111], v[208:211]
    v_cvt_pk_bf16_f32 v227, v230, v231
    v_add_f32 v241, v241, v231
    v_mfma_f32_16x16x32_bf16 v[212:215], v[172:175], v[108:111], v[212:215]
    v_mfma_f32_16x16x32_bf16 v[8:11], v[176:179], v[224:227], v[8:11]
    ds_read_b64_tr_b16 v[176:177], v244 offset:24576
    v_mfma_f32_16x16x32_bf16 v[20:23], v[180:183], v[224:227], v[20:23]
    s_nop 1
    v_exp_f32 v208, v208
    ds_read_b64_tr_b16 v[178:179], v244 offset:28672
    v_mfma_f32_16x16x32_bf16 v[32:35], v[184:187], v[224:227], v[32:35]
    v_exp_f32 v209, v209
    ds_read_b64_tr_b16 v[180:181], v245 offset:24576
    v_mfma_f32_16x16x32_bf16 v[44:47], v[188:191], v[224:227], v[44:47]
    v_exp_f32 v210, v210
    ds_read_b64_tr_b16 v[182:183], v245 offset:28672
    v_mfma_f32_16x16x32_bf16 v[56:59], v[192:195], v[224:227], v[56:59]
    v_add_f32 v236, v236, v208
    v_add_f32 v237, v237, v209
    ds_read_b64_tr_b16 v[184:185], v246 offset:24576
    v_mfma_f32_16x16x32_bf16 v[68:71], v[196:199], v[224:227], v[68:71]
    v_exp_f32 v211, v211
    ds_read_b64_tr_b16 v[186:187], v246 offset:28672
    v_mfma_f32_16x16x32_bf16 v[80:83], v[200:203], v[224:227], v[80:83]
    v_cvt_pk_bf16_f32 v208, v208, v209
    v_add_f32 v236, v236, v210
    ds_read_b64_tr_b16 v[188:189], v247 offset:24576
    v_mfma_f32_16x16x32_bf16 v[92:95], v[204:207], v[224:227], v[92:95]
    v_exp_f32 v212, v212
    ds_read_b64_tr_b16 v[190:191], v247 offset:28672
    v_mfma_f32_16x16x32_bf16 v[216:219], v[144:147], v[112:115], v[232:235]
    v_exp_f32 v213, v213
    ds_read_b64_tr_b16 v[192:193], v244 offset:25088
    v_mfma_f32_16x16x32_bf16 v[220:223], v[160:163], v[112:115], v[232:235]
    v_add_f32 v237, v237, v211
    v_cvt_pk_bf16_f32 v209, v210, v211
    ds_read_b64_tr_b16 v[194:195], v244 offset:29184
    v_mfma_f32_16x16x32_bf16 v[216:219], v[148:151], v[116:119], v[216:219]
    v_exp_f32 v214, v214
    ds_read_b64_tr_b16 v[196:197], v245 offset:25088
    v_mfma_f32_16x16x32_bf16 v[220:223], v[164:167], v[116:119], v[220:223]
    v_add_f32 v236, v236, v212
    v_add_f32 v237, v237, v213
    ds_read_b64_tr_b16 v[198:199], v245 offset:29184
    v_mfma_f32_16x16x32_bf16 v[216:219], v[152:155], v[120:123], v[216:219]
    v_exp_f32 v215, v215
    ds_read_b64_tr_b16 v[200:201], v246 offset:25088
    v_mfma_f32_16x16x32_bf16 v[220:223], v[168:171], v[120:123], v[220:223]
    v_cvt_pk_bf16_f32 v210, v212, v213
    v_add_f32 v236, v236, v214
    ds_read_b64_tr_b16 v[202:203], v246 offset:29184
    v_mfma_f32_16x16x32_bf16 v[216:219], v[156:159], v[124:127], v[216:219]
    v_cvt_pk_bf16_f32 v211, v214, v215
    v_add_f32 v237, v237, v215
    ds_read_b64_tr_b16 v[204:205], v247 offset:25088
    v_mfma_f32_16x16x32_bf16 v[220:223], v[172:175], v[124:127], v[220:223]
    ds_read_b64_tr_b16 v[206:207], v247 offset:29184
    s_waitcnt lgkmcnt(8)
    v_mfma_f32_16x16x32_bf16 v[0:3], v[176:179], v[208:211], v[0:3]
    v_mfma_f32_16x16x32_bf16 v[12:15], v[180:183], v[208:211], v[12:15]
    v_exp_f32 v216, v216
    v_mfma_f32_16x16x32_bf16 v[24:27], v[184:187], v[208:211], v[24:27]
    v_exp_f32 v217, v217
    v_mfma_f32_16x16x32_bf16 v[36:39], v[188:191], v[208:211], v[36:39]
    v_exp_f32 v218, v218
    s_waitcnt lgkmcnt(4)
    v_mfma_f32_16x16x32_bf16 v[48:51], v[192:195], v[208:211], v[48:51]
    v_add_f32 v238, v238, v216
    v_add_f32 v239, v239, v217
    v_mfma_f32_16x16x32_bf16 v[60:63], v[196:199], v[208:211], v[60:63]
    v_exp_f32 v219, v219
    s_waitcnt lgkmcnt(0)
    v_mfma_f32_16x16x32_bf16 v[72:75], v[200:203], v[208:211], v[72:75]
    v_cvt_pk_bf16_f32 v216, v216, v217
    v_add_f32 v238, v238, v218
    v_mfma_f32_16x16x32_bf16 v[84:87], v[204:207], v[208:211], v[84:87]
    v_exp_f32 v220, v220
    s_waitcnt vmcnt(8)
    s_barrier
    v_mfma_f32_16x16x32_bf16 v[224:227], v[144:147], v[128:131], v[232:235]
    v_exp_f32 v221, v221
    ds_read_b128 v[144:147], v242 offset:32768
    v_mfma_f32_16x16x32_bf16 v[228:231], v[160:163], v[128:131], v[232:235]
    v_add_f32 v239, v239, v219
    v_cvt_pk_bf16_f32 v217, v218, v219
    ds_read_b128 v[160:163], v242 offset:36864
    v_mfma_f32_16x16x32_bf16 v[224:227], v[148:151], v[132:135], v[224:227]
    v_exp_f32 v222, v222
    ds_read_b128 v[148:151], v243 offset:32768
    v_mfma_f32_16x16x32_bf16 v[228:231], v[164:167], v[132:135], v[228:231]
    v_add_f32 v238, v238, v220
    v_add_f32 v239, v239, v221
    ds_read_b128 v[164:167], v243 offset:36864
    v_mfma_f32_16x16x32_bf16 v[224:227], v[152:155], v[136:139], v[224:227]
    v_exp_f32 v223, v223
    ds_read_b128 v[152:155], v242 offset:33280
    v_mfma_f32_16x16x32_bf16 v[228:231], v[168:171], v[136:139], v[228:231]
    v_cvt_pk_bf16_f32 v218, v220, v221
    v_add_f32 v238, v238, v222
    ds_read_b128 v[168:171], v242 offset:37376
    v_mfma_f32_16x16x32_bf16 v[224:227], v[156:159], v[140:143], v[224:227]
    v_cvt_pk_bf16_f32 v219, v222, v223
    v_add_f32 v239, v239, v223
    ds_read_b128 v[156:159], v243 offset:33280
    v_mfma_f32_16x16x32_bf16 v[228:231], v[172:175], v[140:143], v[228:231]
    ds_read_b128 v[172:175], v243 offset:37376
    v_mfma_f32_16x16x32_bf16 v[4:7], v[176:179], v[216:219], v[4:7]
    v_mfma_f32_16x16x32_bf16 v[16:19], v[180:183], v[216:219], v[16:19]
    s_nop 0
    v_exp_f32 v224, v224
    v_mfma_f32_16x16x32_bf16 v[28:31], v[184:187], v[216:219], v[28:31]
    v_exp_f32 v225, v225
    v_mfma_f32_16x16x32_bf16 v[40:43], v[188:191], v[216:219], v[40:43]
    v_exp_f32 v226, v226
    v_mfma_f32_16x16x32_bf16 v[52:55], v[192:195], v[216:219], v[52:55]
    v_add_f32 v240, v240, v224
    v_add_f32 v241, v241, v225
    v_mfma_f32_16x16x32_bf16 v[64:67], v[196:199], v[216:219], v[64:67]
    v_exp_f32 v227, v227
    v_mfma_f32_16x16x32_bf16 v[76:79], v[200:203], v[216:219], v[76:79]
    v_cvt_pk_bf16_f32 v224, v224, v225
    v_add_f32 v240, v240, v226
    v_mfma_f32_16x16x32_bf16 v[88:91], v[204:207], v[216:219], v[88:91]
    v_exp_f32 v228, v228
    s_waitcnt lgkmcnt(0)
    v_mfma_f32_16x16x32_bf16 v[208:211], v[144:147], v[96:99], v[232:235]
    v_exp_f32 v229, v229
    v_mfma_f32_16x16x32_bf16 v[212:215], v[160:163], v[96:99], v[232:235]
    v_add_f32 v241, v241, v227
    v_cvt_pk_bf16_f32 v225, v226, v227
    v_mfma_f32_16x16x32_bf16 v[208:211], v[148:151], v[100:103], v[208:211]
    v_exp_f32 v230, v230
    v_mfma_f32_16x16x32_bf16 v[212:215], v[164:167], v[100:103], v[212:215]
    v_add_f32 v240, v240, v228
    v_add_f32 v241, v241, v229
    v_mfma_f32_16x16x32_bf16 v[208:211], v[152:155], v[104:107], v[208:211]
    v_exp_f32 v231, v231
    v_mfma_f32_16x16x32_bf16 v[212:215], v[168:171], v[104:107], v[212:215]
    v_cvt_pk_bf16_f32 v226, v228, v229
    v_add_f32 v240, v240, v230
    v_mfma_f32_16x16x32_bf16 v[208:211], v[156:159], v[108:111], v[208:211]
    v_cvt_pk_bf16_f32 v227, v230, v231
    v_add_f32 v241, v241, v231
    v_mfma_f32_16x16x32_bf16 v[212:215], v[172:175], v[108:111], v[212:215]
    v_mfma_f32_16x16x32_bf16 v[8:11], v[176:179], v[224:227], v[8:11]
    ds_read_b64_tr_b16 v[176:177], v244 offset:32768
    v_mfma_f32_16x16x32_bf16 v[20:23], v[180:183], v[224:227], v[20:23]
    s_nop 1
    v_exp_f32 v208, v208
    ds_read_b64_tr_b16 v[178:179], v244 offset:36864
    v_mfma_f32_16x16x32_bf16 v[32:35], v[184:187], v[224:227], v[32:35]
    v_exp_f32 v209, v209
    ds_read_b64_tr_b16 v[180:181], v245 offset:32768
    v_mfma_f32_16x16x32_bf16 v[44:47], v[188:191], v[224:227], v[44:47]
    v_exp_f32 v210, v210
    ds_read_b64_tr_b16 v[182:183], v245 offset:36864
    v_mfma_f32_16x16x32_bf16 v[56:59], v[192:195], v[224:227], v[56:59]
    v_add_f32 v236, v236, v208
    v_add_f32 v237, v237, v209
    ds_read_b64_tr_b16 v[184:185], v246 offset:32768
    v_mfma_f32_16x16x32_bf16 v[68:71], v[196:199], v[224:227], v[68:71]
    v_exp_f32 v211, v211
    ds_read_b64_tr_b16 v[186:187], v246 offset:36864
    v_mfma_f32_16x16x32_bf16 v[80:83], v[200:203], v[224:227], v[80:83]
    v_cvt_pk_bf16_f32 v208, v208, v209
    v_add_f32 v236, v236, v210
    ds_read_b64_tr_b16 v[188:189], v247 offset:32768
    v_mfma_f32_16x16x32_bf16 v[92:95], v[204:207], v[224:227], v[92:95]
    v_exp_f32 v212, v212
    ds_read_b64_tr_b16 v[190:191], v247 offset:36864
    v_mfma_f32_16x16x32_bf16 v[216:219], v[144:147], v[112:115], v[232:235]
    v_exp_f32 v213, v213
    ds_read_b64_tr_b16 v[192:193], v244 offset:33280
    v_mfma_f32_16x16x32_bf16 v[220:223], v[160:163], v[112:115], v[232:235]
    v_add_f32 v237, v237, v211
    v_cvt_pk_bf16_f32 v209, v210, v211
    ds_read_b64_tr_b16 v[194:195], v244 offset:37376
    v_mfma_f32_16x16x32_bf16 v[216:219], v[148:151], v[116:119], v[216:219]
    v_exp_f32 v214, v214
    ds_read_b64_tr_b16 v[196:197], v245 offset:33280
    v_mfma_f32_16x16x32_bf16 v[220:223], v[164:167], v[116:119], v[220:223]
    v_add_f32 v236, v236, v212
    v_add_f32 v237, v237, v213
    ds_read_b64_tr_b16 v[198:199], v245 offset:37376
    v_mfma_f32_16x16x32_bf16 v[216:219], v[152:155], v[120:123], v[216:219]
    v_exp_f32 v215, v215
    ds_read_b64_tr_b16 v[200:201], v246 offset:33280
    v_mfma_f32_16x16x32_bf16 v[220:223], v[168:171], v[120:123], v[220:223]
    v_cvt_pk_bf16_f32 v210, v212, v213
    v_add_f32 v236, v236, v214
    ds_read_b64_tr_b16 v[202:203], v246 offset:37376
    v_mfma_f32_16x16x32_bf16 v[216:219], v[156:159], v[124:127], v[216:219]
    v_cvt_pk_bf16_f32 v211, v214, v215
    v_add_f32 v237, v237, v215
    ds_read_b64_tr_b16 v[204:205], v247 offset:33280
    v_mfma_f32_16x16x32_bf16 v[220:223], v[172:175], v[124:127], v[220:223]
    ds_read_b64_tr_b16 v[206:207], v247 offset:37376
    s_waitcnt lgkmcnt(8)
    v_mfma_f32_16x16x32_bf16 v[0:3], v[176:179], v[208:211], v[0:3]
    v_mfma_f32_16x16x32_bf16 v[12:15], v[180:183], v[208:211], v[12:15]
    v_exp_f32 v216, v216
    v_mfma_f32_16x16x32_bf16 v[24:27], v[184:187], v[208:211], v[24:27]
    v_exp_f32 v217, v217
    v_mfma_f32_16x16x32_bf16 v[36:39], v[188:191], v[208:211], v[36:39]
    v_exp_f32 v218, v218
    s_waitcnt lgkmcnt(4)
    v_mfma_f32_16x16x32_bf16 v[48:51], v[192:195], v[208:211], v[48:51]
    v_add_f32 v238, v238, v216
    v_add_f32 v239, v239, v217
    v_mfma_f32_16x16x32_bf16 v[60:63], v[196:199], v[208:211], v[60:63]
    v_exp_f32 v219, v219
    s_waitcnt lgkmcnt(0)
    v_mfma_f32_16x16x32_bf16 v[72:75], v[200:203], v[208:211], v[72:75]
    v_cvt_pk_bf16_f32 v216, v216, v217
    v_add_f32 v238, v238, v218
    v_mfma_f32_16x16x32_bf16 v[84:87], v[204:207], v[208:211], v[84:87]
    v_exp_f32 v220, v220
    s_waitcnt vmcnt(4)
    s_barrier
    v_mfma_f32_16x16x32_bf16 v[224:227], v[144:147], v[128:131], v[232:235]
    v_exp_f32 v221, v221
    ds_read_b128 v[144:147], v242 offset:0
    v_mfma_f32_16x16x32_bf16 v[228:231], v[160:163], v[128:131], v[232:235]
    v_add_f32 v239, v239, v219
    v_cvt_pk_bf16_f32 v217, v218, v219
    ds_read_b128 v[160:163], v242 offset:4096
    v_mfma_f32_16x16x32_bf16 v[224:227], v[148:151], v[132:135], v[224:227]
    v_exp_f32 v222, v222
    ds_read_b128 v[148:151], v243 offset:0
    v_mfma_f32_16x16x32_bf16 v[228:231], v[164:167], v[132:135], v[228:231]
    v_add_f32 v238, v238, v220
    v_add_f32 v239, v239, v221
    ds_read_b128 v[164:167], v243 offset:4096
    v_mfma_f32_16x16x32_bf16 v[224:227], v[152:155], v[136:139], v[224:227]
    v_exp_f32 v223, v223
    ds_read_b128 v[152:155], v242 offset:512
    v_mfma_f32_16x16x32_bf16 v[228:231], v[168:171], v[136:139], v[228:231]
    v_cvt_pk_bf16_f32 v218, v220, v221
    v_add_f32 v238, v238, v222
    ds_read_b128 v[168:171], v242 offset:4608
    v_mfma_f32_16x16x32_bf16 v[224:227], v[156:159], v[140:143], v[224:227]
    v_cvt_pk_bf16_f32 v219, v222, v223
    v_add_f32 v239, v239, v223
    ds_read_b128 v[156:159], v243 offset:512
    v_mfma_f32_16x16x32_bf16 v[228:231], v[172:175], v[140:143], v[228:231]
    ds_read_b128 v[172:175], v243 offset:4608
    v_mfma_f32_16x16x32_bf16 v[4:7], v[176:179], v[216:219], v[4:7]
    v_mfma_f32_16x16x32_bf16 v[16:19], v[180:183], v[216:219], v[16:19]
    s_nop 0
    v_exp_f32 v224, v224
    v_mfma_f32_16x16x32_bf16 v[28:31], v[184:187], v[216:219], v[28:31]
    v_exp_f32 v225, v225
    v_mfma_f32_16x16x32_bf16 v[40:43], v[188:191], v[216:219], v[40:43]
    v_exp_f32 v226, v226
    v_mfma_f32_16x16x32_bf16 v[52:55], v[192:195], v[216:219], v[52:55]
    v_add_f32 v240, v240, v224
    v_add_f32 v241, v241, v225
    v_mfma_f32_16x16x32_bf16 v[64:67], v[196:199], v[216:219], v[64:67]
    v_exp_f32 v227, v227
    v_mfma_f32_16x16x32_bf16 v[76:79], v[200:203], v[216:219], v[76:79]
    v_cvt_pk_bf16_f32 v224, v224, v225
    v_add_f32 v240, v240, v226
    v_mfma_f32_16x16x32_bf16 v[88:91], v[204:207], v[216:219], v[88:91]
    v_exp_f32 v228, v228
    s_waitcnt lgkmcnt(0)
    v_mfma_f32_16x16x32_bf16 v[208:211], v[144:147], v[96:99], v[232:235]
    v_exp_f32 v229, v229
    v_mfma_f32_16x16x32_bf16 v[212:215], v[160:163], v[96:99], v[232:235]
    v_add_f32 v241, v241, v227
    v_cvt_pk_bf16_f32 v225, v226, v227
    v_mfma_f32_16x16x32_bf16 v[208:211], v[148:151], v[100:103], v[208:211]
    v_exp_f32 v230, v230
    v_mfma_f32_16x16x32_bf16 v[212:215], v[164:167], v[100:103], v[212:215]
    v_add_f32 v240, v240, v228
    v_add_f32 v241, v241, v229
    v_mfma_f32_16x16x32_bf16 v[208:211], v[152:155], v[104:107], v[208:211]
    v_exp_f32 v231, v231
    v_mfma_f32_16x16x32_bf16 v[212:215], v[168:171], v[104:107], v[212:215]
    v_cvt_pk_bf16_f32 v226, v228, v229
    v_add_f32 v240, v240, v230
    v_mfma_f32_16x16x32_bf16 v[208:211], v[156:159], v[108:111], v[208:211]
    v_cvt_pk_bf16_f32 v227, v230, v231
    v_add_f32 v241, v241, v231
    v_mfma_f32_16x16x32_bf16 v[212:215], v[172:175], v[108:111], v[212:215]
    v_mfma_f32_16x16x32_bf16 v[8:11], v[176:179], v[224:227], v[8:11]
    ds_read_b64_tr_b16 v[176:177], v244 offset:0
    v_mfma_f32_16x16x32_bf16 v[20:23], v[180:183], v[224:227], v[20:23]
    s_nop 1
    v_exp_f32 v208, v208
    ds_read_b64_tr_b16 v[178:179], v244 offset:4096
    v_mfma_f32_16x16x32_bf16 v[32:35], v[184:187], v[224:227], v[32:35]
    v_exp_f32 v209, v209
    ds_read_b64_tr_b16 v[180:181], v245 offset:0
    v_mfma_f32_16x16x32_bf16 v[44:47], v[188:191], v[224:227], v[44:47]
    v_exp_f32 v210, v210
    ds_read_b64_tr_b16 v[182:183], v245 offset:4096
    v_mfma_f32_16x16x32_bf16 v[56:59], v[192:195], v[224:227], v[56:59]
    v_add_f32 v236, v236, v208
    v_add_f32 v237, v237, v209
    ds_read_b64_tr_b16 v[184:185], v246 offset:0
    v_mfma_f32_16x16x32_bf16 v[68:71], v[196:199], v[224:227], v[68:71]
    v_exp_f32 v211, v211
    ds_read_b64_tr_b16 v[186:187], v246 offset:4096
    v_mfma_f32_16x16x32_bf16 v[80:83], v[200:203], v[224:227], v[80:83]
    v_cvt_pk_bf16_f32 v208, v208, v209
    v_add_f32 v236, v236, v210
    ds_read_b64_tr_b16 v[188:189], v247 offset:0
    v_mfma_f32_16x16x32_bf16 v[92:95], v[204:207], v[224:227], v[92:95]
    v_exp_f32 v212, v212
    ds_read_b64_tr_b16 v[190:191], v247 offset:4096
    v_mfma_f32_16x16x32_bf16 v[216:219], v[144:147], v[112:115], v[232:235]
    v_exp_f32 v213, v213
    ds_read_b64_tr_b16 v[192:193], v244 offset:512
    v_mfma_f32_16x16x32_bf16 v[220:223], v[160:163], v[112:115], v[232:235]
    v_add_f32 v237, v237, v211
    v_cvt_pk_bf16_f32 v209, v210, v211
    ds_read_b64_tr_b16 v[194:195], v244 offset:4608
    v_mfma_f32_16x16x32_bf16 v[216:219], v[148:151], v[116:119], v[216:219]
    v_exp_f32 v214, v214
    ds_read_b64_tr_b16 v[196:197], v245 offset:512
    v_mfma_f32_16x16x32_bf16 v[220:223], v[164:167], v[116:119], v[220:223]
    v_add_f32 v236, v236, v212
    v_add_f32 v237, v237, v213
    ds_read_b64_tr_b16 v[198:199], v245 offset:4608
    v_mfma_f32_16x16x32_bf16 v[216:219], v[152:155], v[120:123], v[216:219]
    v_exp_f32 v215, v215
    ds_read_b64_tr_b16 v[200:201], v246 offset:512
    v_mfma_f32_16x16x32_bf16 v[220:223], v[168:171], v[120:123], v[220:223]
    v_cvt_pk_bf16_f32 v210, v212, v213
    v_add_f32 v236, v236, v214
    ds_read_b64_tr_b16 v[202:203], v246 offset:4608
    v_mfma_f32_16x16x32_bf16 v[216:219], v[156:159], v[124:127], v[216:219]
    v_cvt_pk_bf16_f32 v211, v214, v215
    v_add_f32 v237, v237, v215
    ds_read_b64_tr_b16 v[204:205], v247 offset:512
    v_mfma_f32_16x16x32_bf16 v[220:223], v[172:175], v[124:127], v[220:223]
    ds_read_b64_tr_b16 v[206:207], v247 offset:4608
    s_waitcnt lgkmcnt(8)
    v_mfma_f32_16x16x32_bf16 v[0:3], v[176:179], v[208:211], v[0:3]
    v_mfma_f32_16x16x32_bf16 v[12:15], v[180:183], v[208:211], v[12:15]
    v_exp_f32 v216, v216
    v_mfma_f32_16x16x32_bf16 v[24:27], v[184:187], v[208:211], v[24:27]
    v_exp_f32 v217, v217
    v_mfma_f32_16x16x32_bf16 v[36:39], v[188:191], v[208:211], v[36:39]
    v_exp_f32 v218, v218
    s_waitcnt lgkmcnt(4)
    v_mfma_f32_16x16x32_bf16 v[48:51], v[192:195], v[208:211], v[48:51]
    v_add_f32 v238, v238, v216
    v_add_f32 v239, v239, v217
    v_mfma_f32_16x16x32_bf16 v[60:63], v[196:199], v[208:211], v[60:63]
    v_exp_f32 v219, v219
    s_waitcnt lgkmcnt(0)
    v_mfma_f32_16x16x32_bf16 v[72:75], v[200:203], v[208:211], v[72:75]
    v_cvt_pk_bf16_f32 v216, v216, v217
    v_add_f32 v238, v238, v218
    v_mfma_f32_16x16x32_bf16 v[84:87], v[204:207], v[208:211], v[84:87]
    v_exp_f32 v220, v220
    s_waitcnt vmcnt(0)
    s_barrier
    v_mfma_f32_16x16x32_bf16 v[224:227], v[144:147], v[128:131], v[232:235]
    v_exp_f32 v221, v221
    ds_read_b128 v[144:147], v242 offset:8192
    v_mfma_f32_16x16x32_bf16 v[228:231], v[160:163], v[128:131], v[232:235]
    v_add_f32 v239, v239, v219
    v_cvt_pk_bf16_f32 v217, v218, v219
    ds_read_b128 v[160:163], v242 offset:12288
    v_mfma_f32_16x16x32_bf16 v[224:227], v[148:151], v[132:135], v[224:227]
    v_exp_f32 v222, v222
    ds_read_b128 v[148:151], v243 offset:8192
    v_mfma_f32_16x16x32_bf16 v[228:231], v[164:167], v[132:135], v[228:231]
    v_add_f32 v238, v238, v220
    v_add_f32 v239, v239, v221
    ds_read_b128 v[164:167], v243 offset:12288
    v_mfma_f32_16x16x32_bf16 v[224:227], v[152:155], v[136:139], v[224:227]
    v_exp_f32 v223, v223
    ds_read_b128 v[152:155], v242 offset:8704
    v_mfma_f32_16x16x32_bf16 v[228:231], v[168:171], v[136:139], v[228:231]
    v_cvt_pk_bf16_f32 v218, v220, v221
    v_add_f32 v238, v238, v222
    ds_read_b128 v[168:171], v242 offset:12800
    v_mfma_f32_16x16x32_bf16 v[224:227], v[156:159], v[140:143], v[224:227]
    v_cvt_pk_bf16_f32 v219, v222, v223
    v_add_f32 v239, v239, v223
    ds_read_b128 v[156:159], v243 offset:8704
    v_mfma_f32_16x16x32_bf16 v[228:231], v[172:175], v[140:143], v[228:231]
    ds_read_b128 v[172:175], v243 offset:12800
    v_mfma_f32_16x16x32_bf16 v[4:7], v[176:179], v[216:219], v[4:7]
    v_mfma_f32_16x16x32_bf16 v[16:19], v[180:183], v[216:219], v[16:19]
    s_nop 0
    v_exp_f32 v224, v224
    v_mfma_f32_16x16x32_bf16 v[28:31], v[184:187], v[216:219], v[28:31]
    v_exp_f32 v225, v225
    v_mfma_f32_16x16x32_bf16 v[40:43], v[188:191], v[216:219], v[40:43]
    v_exp_f32 v226, v226
    v_mfma_f32_16x16x32_bf16 v[52:55], v[192:195], v[216:219], v[52:55]
    v_add_f32 v240, v240, v224
    v_add_f32 v241, v241, v225
    v_mfma_f32_16x16x32_bf16 v[64:67], v[196:199], v[216:219], v[64:67]
    v_exp_f32 v227, v227
    v_mfma_f32_16x16x32_bf16 v[76:79], v[200:203], v[216:219], v[76:79]
    v_cvt_pk_bf16_f32 v224, v224, v225
    v_add_f32 v240, v240, v226
    v_mfma_f32_16x16x32_bf16 v[88:91], v[204:207], v[216:219], v[88:91]
    v_exp_f32 v228, v228
    s_waitcnt lgkmcnt(0)
    v_mfma_f32_16x16x32_bf16 v[208:211], v[144:147], v[96:99], v[232:235]
    v_exp_f32 v229, v229
    v_mfma_f32_16x16x32_bf16 v[212:215], v[160:163], v[96:99], v[232:235]
    v_add_f32 v241, v241, v227
    v_cvt_pk_bf16_f32 v225, v226, v227
    v_mfma_f32_16x16x32_bf16 v[208:211], v[148:151], v[100:103], v[208:211]
    v_exp_f32 v230, v230
    v_mfma_f32_16x16x32_bf16 v[212:215], v[164:167], v[100:103], v[212:215]
    v_add_f32 v240, v240, v228
    v_add_f32 v241, v241, v229
    v_mfma_f32_16x16x32_bf16 v[208:211], v[152:155], v[104:107], v[208:211]
    v_exp_f32 v231, v231
    v_mfma_f32_16x16x32_bf16 v[212:215], v[168:171], v[104:107], v[212:215]
    v_cvt_pk_bf16_f32 v226, v228, v229
    v_add_f32 v240, v240, v230
    v_mfma_f32_16x16x32_bf16 v[208:211], v[156:159], v[108:111], v[208:211]
    v_cvt_pk_bf16_f32 v227, v230, v231
    v_add_f32 v241, v241, v231
    v_mfma_f32_16x16x32_bf16 v[212:215], v[172:175], v[108:111], v[212:215]
    v_mfma_f32_16x16x32_bf16 v[8:11], v[176:179], v[224:227], v[8:11]
    ds_read_b64_tr_b16 v[176:177], v244 offset:8192
    v_mfma_f32_16x16x32_bf16 v[20:23], v[180:183], v[224:227], v[20:23]
    s_nop 1
    v_exp_f32 v208, v208
    ds_read_b64_tr_b16 v[178:179], v244 offset:12288
    v_mfma_f32_16x16x32_bf16 v[32:35], v[184:187], v[224:227], v[32:35]
    v_exp_f32 v209, v209
    ds_read_b64_tr_b16 v[180:181], v245 offset:8192
    v_mfma_f32_16x16x32_bf16 v[44:47], v[188:191], v[224:227], v[44:47]
    v_exp_f32 v210, v210
    ds_read_b64_tr_b16 v[182:183], v245 offset:12288
    v_mfma_f32_16x16x32_bf16 v[56:59], v[192:195], v[224:227], v[56:59]
    v_add_f32 v236, v236, v208
    v_add_f32 v237, v237, v209
    ds_read_b64_tr_b16 v[184:185], v246 offset:8192
    v_mfma_f32_16x16x32_bf16 v[68:71], v[196:199], v[224:227], v[68:71]
    v_exp_f32 v211, v211
    ds_read_b64_tr_b16 v[186:187], v246 offset:12288
    v_mfma_f32_16x16x32_bf16 v[80:83], v[200:203], v[224:227], v[80:83]
    v_cvt_pk_bf16_f32 v208, v208, v209
    v_add_f32 v236, v236, v210
    ds_read_b64_tr_b16 v[188:189], v247 offset:8192
    v_mfma_f32_16x16x32_bf16 v[92:95], v[204:207], v[224:227], v[92:95]
    v_exp_f32 v212, v212
    ds_read_b64_tr_b16 v[190:191], v247 offset:12288
    v_mfma_f32_16x16x32_bf16 v[216:219], v[144:147], v[112:115], v[232:235]
    v_exp_f32 v213, v213
    ds_read_b64_tr_b16 v[192:193], v244 offset:8704
    v_mfma_f32_16x16x32_bf16 v[220:223], v[160:163], v[112:115], v[232:235]
    v_add_f32 v237, v237, v211
    v_cvt_pk_bf16_f32 v209, v210, v211
    ds_read_b64_tr_b16 v[194:195], v244 offset:12800
    v_mfma_f32_16x16x32_bf16 v[216:219], v[148:151], v[116:119], v[216:219]
    v_exp_f32 v214, v214
    ds_read_b64_tr_b16 v[196:197], v245 offset:8704
    v_mfma_f32_16x16x32_bf16 v[220:223], v[164:167], v[116:119], v[220:223]
    v_add_f32 v236, v236, v212
    v_add_f32 v237, v237, v213
    ds_read_b64_tr_b16 v[198:199], v245 offset:12800
    v_mfma_f32_16x16x32_bf16 v[216:219], v[152:155], v[120:123], v[216:219]
    v_exp_f32 v215, v215
    ds_read_b64_tr_b16 v[200:201], v246 offset:8704
    v_mfma_f32_16x16x32_bf16 v[220:223], v[168:171], v[120:123], v[220:223]
    v_cvt_pk_bf16_f32 v210, v212, v213
    v_add_f32 v236, v236, v214
    ds_read_b64_tr_b16 v[202:203], v246 offset:12800
    v_mfma_f32_16x16x32_bf16 v[216:219], v[156:159], v[124:127], v[216:219]
    v_cvt_pk_bf16_f32 v211, v214, v215
    v_add_f32 v237, v237, v215
    ds_read_b64_tr_b16 v[204:205], v247 offset:8704
    v_mfma_f32_16x16x32_bf16 v[220:223], v[172:175], v[124:127], v[220:223]
    ds_read_b64_tr_b16 v[206:207], v247 offset:12800
    s_waitcnt lgkmcnt(8)
    v_mfma_f32_16x16x32_bf16 v[0:3], v[176:179], v[208:211], v[0:3]
    v_mfma_f32_16x16x32_bf16 v[12:15], v[180:183], v[208:211], v[12:15]
    v_exp_f32 v216, v216
    v_mfma_f32_16x16x32_bf16 v[24:27], v[184:187], v[208:211], v[24:27]
    v_exp_f32 v217, v217
    v_mfma_f32_16x16x32_bf16 v[36:39], v[188:191], v[208:211], v[36:39]
    v_exp_f32 v218, v218
    s_waitcnt lgkmcnt(4)
    v_mfma_f32_16x16x32_bf16 v[48:51], v[192:195], v[208:211], v[48:51]
    v_add_f32 v238, v238, v216
    v_add_f32 v239, v239, v217
    v_mfma_f32_16x16x32_bf16 v[60:63], v[196:199], v[208:211], v[60:63]
    v_exp_f32 v219, v219
    s_waitcnt lgkmcnt(0)
    v_mfma_f32_16x16x32_bf16 v[72:75], v[200:203], v[208:211], v[72:75]
    v_cvt_pk_bf16_f32 v216, v216, v217
    v_add_f32 v238, v238, v218
    v_mfma_f32_16x16x32_bf16 v[84:87], v[204:207], v[208:211], v[84:87]
    v_exp_f32 v220, v220
    v_mfma_f32_16x16x32_bf16 v[224:227], v[144:147], v[128:131], v[232:235]
    v_exp_f32 v221, v221
    v_mfma_f32_16x16x32_bf16 v[228:231], v[160:163], v[128:131], v[232:235]
    v_add_f32 v239, v239, v219
    v_cvt_pk_bf16_f32 v217, v218, v219
    v_mfma_f32_16x16x32_bf16 v[224:227], v[148:151], v[132:135], v[224:227]
    v_exp_f32 v222, v222
    v_mfma_f32_16x16x32_bf16 v[228:231], v[164:167], v[132:135], v[228:231]
    v_add_f32 v238, v238, v220
    v_add_f32 v239, v239, v221
    v_mfma_f32_16x16x32_bf16 v[224:227], v[152:155], v[136:139], v[224:227]
    v_exp_f32 v223, v223
    v_mfma_f32_16x16x32_bf16 v[228:231], v[168:171], v[136:139], v[228:231]
    v_cvt_pk_bf16_f32 v218, v220, v221
    v_add_f32 v238, v238, v222
    v_mfma_f32_16x16x32_bf16 v[224:227], v[156:159], v[140:143], v[224:227]
    v_cvt_pk_bf16_f32 v219, v222, v223
    v_add_f32 v239, v239, v223
    v_mfma_f32_16x16x32_bf16 v[228:231], v[172:175], v[140:143], v[228:231]
    v_mfma_f32_16x16x32_bf16 v[4:7], v[176:179], v[216:219], v[4:7]
    v_mfma_f32_16x16x32_bf16 v[16:19], v[180:183], v[216:219], v[16:19]
    s_nop 2
    v_exp_f32 v224, v224
    v_mfma_f32_16x16x32_bf16 v[28:31], v[184:187], v[216:219], v[28:31]
    v_exp_f32 v225, v225
    v_mfma_f32_16x16x32_bf16 v[40:43], v[188:191], v[216:219], v[40:43]
    v_exp_f32 v226, v226
    v_mfma_f32_16x16x32_bf16 v[52:55], v[192:195], v[216:219], v[52:55]
    v_add_f32 v240, v240, v224
    v_add_f32 v241, v241, v225
    v_mfma_f32_16x16x32_bf16 v[64:67], v[196:199], v[216:219], v[64:67]
    v_exp_f32 v227, v227
    v_mfma_f32_16x16x32_bf16 v[76:79], v[200:203], v[216:219], v[76:79]
    v_cvt_pk_bf16_f32 v224, v224, v225
    v_add_f32 v240, v240, v226
    v_mfma_f32_16x16x32_bf16 v[88:91], v[204:207], v[216:219], v[88:91]
    v_exp_f32 v228, v228
    v_exp_f32 v229, v229
    v_add_f32 v241, v241, v227
    v_cvt_pk_bf16_f32 v225, v226, v227
    v_exp_f32 v230, v230
    v_add_f32 v240, v240, v228
    v_add_f32 v241, v241, v229
    v_exp_f32 v231, v231
    v_cvt_pk_bf16_f32 v226, v228, v229
    v_add_f32 v240, v240, v230
    v_cvt_pk_bf16_f32 v227, v230, v231
    v_add_f32 v241, v241, v231
    s_nop 0
    v_mfma_f32_16x16x32_bf16 v[8:11], v[176:179], v[224:227], v[8:11]
    v_mfma_f32_16x16x32_bf16 v[20:23], v[180:183], v[224:227], v[20:23]
    v_mfma_f32_16x16x32_bf16 v[32:35], v[184:187], v[224:227], v[32:35]
    v_mfma_f32_16x16x32_bf16 v[44:47], v[188:191], v[224:227], v[44:47]
    v_mfma_f32_16x16x32_bf16 v[56:59], v[192:195], v[224:227], v[56:59]
    v_mfma_f32_16x16x32_bf16 v[68:71], v[196:199], v[224:227], v[68:71]
    v_mfma_f32_16x16x32_bf16 v[80:83], v[200:203], v[224:227], v[80:83]
    v_mfma_f32_16x16x32_bf16 v[92:95], v[204:207], v[224:227], v[92:95]
    v_add_f32 v236, v236, v237
    v_add_f32 v238, v238, v239
    v_add_f32 v240, v240, v241
    v_mov_b32 v237, v236
    v_mov_b32 v239, v238
    v_mov_b32 v241, v240
    v_permlane32_swap_b32 v237, v236
    v_permlane32_swap_b32 v239, v238
    v_permlane32_swap_b32 v241, v240
    v_add_f32 v236, v236, v237
    v_add_f32 v238, v238, v239
    v_add_f32 v240, v240, v241
    v_mov_b32 v237, v236
    v_mov_b32 v239, v238
    v_mov_b32 v241, v240
    v_permlane16_swap_b32 v237, v236
    v_permlane16_swap_b32 v239, v238
    v_permlane16_swap_b32 v241, v240
    v_add_f32 v236, v236, v237
    v_add_f32 v238, v238, v239
    v_add_f32 v240, v240, v241
    v_max3_f32 v250, v236, v238, v240
    v_min3_f32 v251, v236, v238, v240
    v_add_f32 v252, v236, v238
    v_add_f32 v252, v252, v240
    s_mov_b32 s54, 1317011456
    s_mov_b32 s55, 2071986176
    s_mov_b32 s30, 813694976
    v_cmp_gt_f32 s[32:33], s54, v252
    v_cmp_lt_f32 s[30:31], s30, v251
    v_pk_mul_f32 v[216:217], v[0:1], v[2:3]
    v_pk_fma_f32 v[216:217], v[4:5], v[6:7], v[216:217]
    v_pk_fma_f32 v[216:217], v[8:9], v[10:11], v[216:217]
    v_pk_fma_f32 v[216:217], v[12:13], v[14:15], v[216:217]
    v_pk_fma_f32 v[216:217], v[16:17], v[18:19], v[216:217]
    v_pk_fma_f32 v[216:217], v[20:21], v[22:23], v[216:217]
    v_pk_fma_f32 v[216:217], v[24:25], v[26:27], v[216:217]
    v_pk_fma_f32 v[216:217], v[28:29], v[30:31], v[216:217]
    v_pk_fma_f32 v[216:217], v[32:33], v[34:35], v[216:217]
    v_pk_fma_f32 v[216:217], v[36:37], v[38:39], v[216:217]
    v_pk_fma_f32 v[216:217], v[40:41], v[42:43], v[216:217]
    v_pk_fma_f32 v[216:217], v[44:45], v[46:47], v[216:217]
    v_pk_fma_f32 v[216:217], v[48:49], v[50:51], v[216:217]
    v_pk_fma_f32 v[216:217], v[52:53], v[54:55], v[216:217]
    v_pk_fma_f32 v[216:217], v[56:57], v[58:59], v[216:217]
    v_pk_fma_f32 v[216:217], v[60:61], v[62:63], v[216:217]
    v_pk_fma_f32 v[216:217], v[64:65], v[66:67], v[216:217]
    v_pk_fma_f32 v[216:217], v[68:69], v[70:71], v[216:217]
    v_pk_fma_f32 v[216:217], v[72:73], v[74:75], v[216:217]
    v_pk_fma_f32 v[216:217], v[76:77], v[78:79], v[216:217]
    v_pk_fma_f32 v[216:217], v[80:81], v[82:83], v[216:217]
    v_pk_fma_f32 v[216:217], v[84:85], v[86:87], v[216:217]
    v_pk_fma_f32 v[216:217], v[88:89], v[90:91], v[216:217]
    v_pk_fma_f32 v[216:217], v[92:93], v[94:95], v[216:217]
    v_add_f32 v253, v216, v217
    v_cmp_gt_f32 s[34:35], s55, abs(v253)
    s_nop 3
    s_and_b64 s[32:33], s[32:33], s[34:35]
    s_and_b64 s[32:33], s[32:33], s[30:31]
    s_cmp_eq_u64 s[32:33], -1
    s_cselect_b32 s54, 0, 1
    v_mov_b32 v250, s54
    s_lshl_b32 s55, s24, 2
    v_mov_b32 v251, s55
    ds_write_b32 v251, v250
    s_waitcnt lgkmcnt(0)
    s_barrier
    v_mov_b32 v251, 0
    ds_read_b128 v[208:211], v251
    s_waitcnt lgkmcnt(0)
    v_or3_b32 v250, v208, v209, v210
    v_or_b32 v250, v250, v211
    s_nop 0
    v_readfirstlane_b32 s54, v250
    s_cmp_eq_u32 s54, 0
    s_cbranch_scc1 K1_epi
    v_mov_b32 v0, 0
    v_mov_b32 v1, 0
    v_mov_b32 v2, 0
    v_mov_b32 v3, 0
    v_mov_b32 v4, 0
    v_mov_b32 v5, 0
    v_mov_b32 v6, 0
    v_mov_b32 v7, 0
    v_mov_b32 v8, 0
    v_mov_b32 v9, 0
    v_mov_b32 v10, 0
    v_mov_b32 v11, 0
    v_mov_b32 v12, 0
    v_mov_b32 v13, 0
    v_mov_b32 v14, 0
    v_mov_b32 v15, 0
    v_mov_b32 v16, 0
    v_mov_b32 v17, 0
    v_mov_b32 v18, 0
    v_mov_b32 v19, 0
    v_mov_b32 v20, 0
    v_mov_b32 v21, 0
    v_mov_b32 v22, 0
    v_mov_b32 v23, 0
    v_mov_b32 v24, 0
    v_mov_b32 v25, 0
    v_mov_b32 v26, 0
    v_mov_b32 v27, 0
    v_mov_b32 v28, 0
    v_mov_b32 v29, 0
    v_mov_b32 v30, 0
    v_mov_b32 v31, 0
    v_mov_b32 v32, 0
    v_mov_b32 v33, 0
    v_mov_b32 v34, 0
    v_mov_b32 v35, 0
    v_mov_b32 v36, 0
    v_mov_b32 v37, 0
    v_mov_b32 v38, 0
    v_mov_b32 v39, 0
    v_mov_b32 v40, 0
    v_mov_b32 v41, 0
    v_mov_b32 v42, 0
    v_mov_b32 v43, 0
    v_mov_b32 v44, 0
    v_mov_b32 v45, 0
    v_mov_b32 v46, 0
    v_mov_b32 v47, 0
    v_mov_b32 v48, 0
    v_mov_b32 v49, 0
    v_mov_b32 v50, 0
    v_mov_b32 v51, 0
    v_mov_b32 v52, 0
    v_mov_b32 v53, 0
    v_mov_b32 v54, 0
    v_mov_b32 v55, 0
    v_mov_b32 v56, 0
    v_mov_b32 v57, 0
    v_mov_b32 v58, 0
    v_mov_b32 v59, 0
    v_mov_b32 v60, 0
    v_mov_b32 v61, 0
    v_mov_b32 v62, 0
    v_mov_b32 v63, 0
    v_mov_b32 v64, 0
    v_mov_b32 v65, 0
    v_mov_b32 v66, 0
    v_mov_b32 v67, 0
    v_mov_b32 v68, 0
    v_mov_b32 v69, 0
    v_mov_b32 v70, 0
    v_mov_b32 v71, 0
    v_mov_b32 v72, 0
    v_mov_b32 v73, 0
    v_mov_b32 v74, 0
    v_mov_b32 v75, 0
    v_mov_b32 v76, 0
    v_mov_b32 v77, 0
    v_mov_b32 v78, 0
    v_mov_b32 v79, 0
    v_mov_b32 v80, 0
    v_mov_b32 v81, 0
    v_mov_b32 v82, 0
    v_mov_b32 v83, 0
    v_mov_b32 v84, 0
    v_mov_b32 v85, 0
    v_mov_b32 v86, 0
    v_mov_b32 v87, 0
    v_mov_b32 v88, 0
    v_mov_b32 v89, 0
    v_mov_b32 v90, 0
    v_mov_b32 v91, 0
    v_mov_b32 v92, 0
    v_mov_b32 v93, 0
    v_mov_b32 v94, 0
    v_mov_b32 v95, 0
    v_mov_b32 v236, 0
    v_mov_b32 v237, 0
    v_mov_b32 v232, 0xff800000
    v_mov_b32 v238, 0
    v_mov_b32 v239, 0
    v_mov_b32 v233, 0xff800000
    v_mov_b32 v240, 0
    v_mov_b32 v241, 0
    v_mov_b32 v234, 0xff800000
    s_mov_b32 s26, 0
K1_safe:
    s_barrier
    s_add_u32 m0, s56, 8192
    s_nop 0
    buffer_load_dwordx4 v248, s[12:15], s26 offen nt lds
    buffer_load_dwordx4 v249, s[12:15], s26 offen offset:1024 nt lds
    s_add_u32 m0, s56, 49152
    s_nop 0
    buffer_load_dwordx4 v248, s[16:19], s26 offen nt lds
    buffer_load_dwordx4 v249, s[16:19], s26 offen offset:1024 nt lds
    s_waitcnt vmcnt(0)
    s_barrier
    ds_read_b128 v[144:147], v242 offset:8192
    ds_read_b128 v[160:163], v242 offset:12288
    ds_read_b128 v[148:151], v243 offset:8192
    ds_read_b128 v[164:167], v243 offset:12288
    ds_read_b128 v[152:155], v242 offset:8704
    ds_read_b128 v[168:171], v242 offset:12800
    ds_read_b128 v[156:159], v243 offset:8704
    ds_read_b128 v[172:175], v243 offset:12800
    ds_read_b64_tr_b16 v[176:177], v244 offset:8192
    ds_read_b64_tr_b16 v[178:179], v244 offset:12288
    ds_read_b64_tr_b16 v[180:181], v245 offset:8192
    ds_read_b64_tr_b16 v[182:183], v245 offset:12288
    ds_read_b64_tr_b16 v[184:185], v246 offset:8192
    ds_read_b64_tr_b16 v[186:187], v246 offset:12288
    ds_read_b64_tr_b16 v[188:189], v247 offset:8192
    ds_read_b64_tr_b16 v[190:191], v247 offset:12288
    ds_read_b64_tr_b16 v[192:193], v244 offset:8704
    ds_read_b64_tr_b16 v[194:195], v244 offset:12800
    ds_read_b64_tr_b16 v[196:197], v245 offset:8704
    ds_read_b64_tr_b16 v[198:199], v245 offset:12800
    ds_read_b64_tr_b16 v[200:201], v246 offset:8704
    ds_read_b64_tr_b16 v[202:203], v246 offset:12800
    ds_read_b64_tr_b16 v[204:205], v247 offset:8704
    ds_read_b64_tr_b16 v[206:207], v247 offset:12800
    s_waitcnt lgkmcnt(0)
    v_mfma_f32_16x16x32_bf16 v[208:211], v[144:147], v[96:99], 0
    v_mfma_f32_16x16x32_bf16 v[212:215], v[160:163], v[96:99], 0
    v_mfma_f32_16x16x32_bf16 v[208:211], v[148:151], v[100:103], v[208:211]
    v_mfma_f32_16x16x32_bf16 v[212:215], v[164:167], v[100:103], v[212:215]
    v_mfma_f32_16x16x32_bf16 v[208:211], v[152:155], v[104:107], v[208:211]
    v_mfma_f32_16x16x32_bf16 v[212:215], v[168:171], v[104:107], v[212:215]
    v_mfma_f32_16x16x32_bf16 v[208:211], v[156:159], v[108:111], v[208:211]
    v_mfma_f32_16x16x32_bf16 v[212:215], v[172:175], v[108:111], v[212:215]
    s_nop 6
    v_max3_f32 v250, v208, v209, v210
    v_max3_f32 v250, v250, v211, v212
    v_max3_f32 v250, v250, v213, v214
    v_max_f32 v250, v250, v215
    v_mov_b32 v251, v250
    s_nop 1
    v_permlane32_swap_b32 v251, v250
    v_max_f32 v250, v250, v251
    v_mov_b32 v251, v250
    s_nop 1
    v_permlane16_swap_b32 v251, v250
    v_max_f32 v250, v250, v251
    v_max_f32 v250, v250, v232
    v_sub_f32 v251, v232, v250
    v_exp_f32 v251, v251
    v_mov_b32 v232, v250
    v_mul_f32 v236, v236, v251
    v_mul_f32 v237, v237, v251
    v_mul_f32 v0, v0, v251
    v_mul_f32 v1, v1, v251
    v_mul_f32 v2, v2, v251
    v_mul_f32 v3, v3, v251
    v_mul_f32 v12, v12, v251
    v_mul_f32 v13, v13, v251
    v_mul_f32 v14, v14, v251
    v_mul_f32 v15, v15, v251
    v_mul_f32 v24, v24, v251
    v_mul_f32 v25, v25, v251
    v_mul_f32 v26, v26, v251
    v_mul_f32 v27, v27, v251
    v_mul_f32 v36, v36, v251
    v_mul_f32 v37, v37, v251
    v_mul_f32 v38, v38, v251
    v_mul_f32 v39, v39, v251
    v_mul_f32 v48, v48, v251
    v_mul_f32 v49, v49, v251
    v_mul_f32 v50, v50, v251
    v_mul_f32 v51, v51, v251
    v_mul_f32 v60, v60, v251
    v_mul_f32 v61, v61, v251
    v_mul_f32 v62, v62, v251
    v_mul_f32 v63, v63, v251
    v_mul_f32 v72, v72, v251
    v_mul_f32 v73, v73, v251
    v_mul_f32 v74, v74, v251
    v_mul_f32 v75, v75, v251
    v_mul_f32 v84, v84, v251
    v_mul_f32 v85, v85, v251
    v_mul_f32 v86, v86, v251
    v_mul_f32 v87, v87, v251
    v_sub_f32 v208, v208, v250
    v_sub_f32 v209, v209, v250
    v_sub_f32 v210, v210, v250
    v_sub_f32 v211, v211, v250
    v_sub_f32 v212, v212, v250
    v_sub_f32 v213, v213, v250
    v_sub_f32 v214, v214, v250
    v_sub_f32 v215, v215, v250
    v_exp_f32 v208, v208
    v_exp_f32 v209, v209
    v_exp_f32 v210, v210
    v_add_f32 v236, v236, v208
    v_add_f32 v237, v237, v209
    v_exp_f32 v211, v211
    v_cvt_pk_bf16_f32 v208, v208, v209
    v_add_f32 v236, v236, v210
    v_exp_f32 v212, v212
    v_exp_f32 v213, v213
    v_add_f32 v237, v237, v211
    v_cvt_pk_bf16_f32 v209, v210, v211
    v_exp_f32 v214, v214
    v_add_f32 v236, v236, v212
    v_add_f32 v237, v237, v213
    v_exp_f32 v215, v215
    v_cvt_pk_bf16_f32 v210, v212, v213
    v_add_f32 v236, v236, v214
    v_cvt_pk_bf16_f32 v211, v214, v215
    v_add_f32 v237, v237, v215
    s_nop 0
    v_mfma_f32_16x16x32_bf16 v[0:3], v[176:179], v[208:211], v[0:3]
    v_mfma_f32_16x16x32_bf16 v[12:15], v[180:183], v[208:211], v[12:15]
    v_mfma_f32_16x16x32_bf16 v[24:27], v[184:187], v[208:211], v[24:27]
    v_mfma_f32_16x16x32_bf16 v[36:39], v[188:191], v[208:211], v[36:39]
    v_mfma_f32_16x16x32_bf16 v[48:51], v[192:195], v[208:211], v[48:51]
    v_mfma_f32_16x16x32_bf16 v[60:63], v[196:199], v[208:211], v[60:63]
    v_mfma_f32_16x16x32_bf16 v[72:75], v[200:203], v[208:211], v[72:75]
    v_mfma_f32_16x16x32_bf16 v[84:87], v[204:207], v[208:211], v[84:87]
    v_mfma_f32_16x16x32_bf16 v[216:219], v[144:147], v[112:115], 0
    v_mfma_f32_16x16x32_bf16 v[220:223], v[160:163], v[112:115], 0
    v_mfma_f32_16x16x32_bf16 v[216:219], v[148:151], v[116:119], v[216:219]
    v_mfma_f32_16x16x32_bf16 v[220:223], v[164:167], v[116:119], v[220:223]
    v_mfma_f32_16x16x32_bf16 v[216:219], v[152:155], v[120:123], v[216:219]
    v_mfma_f32_16x16x32_bf16 v[220:223], v[168:171], v[120:123], v[220:223]
    v_mfma_f32_16x16x32_bf16 v[216:219], v[156:159], v[124:127], v[216:219]
    v_mfma_f32_16x16x32_bf16 v[220:223], v[172:175], v[124:127], v[220:223]
    s_nop 6
    v_max3_f32 v250, v216, v217, v218
    v_max3_f32 v250, v250, v219, v220
    v_max3_f32 v250, v250, v221, v222
    v_max_f32 v250, v250, v223
    v_mov_b32 v251, v250
    s_nop 1
    v_permlane32_swap_b32 v251, v250
    v_max_f32 v250, v250, v251
    v_mov_b32 v251, v250
    s_nop 1
    v_permlane16_swap_b32 v251, v250
    v_max_f32 v250, v250, v251
    v_max_f32 v250, v250, v233
    v_sub_f32 v251, v233, v250
    v_exp_f32 v251, v251
    v_mov_b32 v233, v250
    v_mul_f32 v238, v238, v251
    v_mul_f32 v239, v239, v251
    v_mul_f32 v4, v4, v251
    v_mul_f32 v5, v5, v251
    v_mul_f32 v6, v6, v251
    v_mul_f32 v7, v7, v251
    v_mul_f32 v16, v16, v251
    v_mul_f32 v17, v17, v251
    v_mul_f32 v18, v18, v251
    v_mul_f32 v19, v19, v251
    v_mul_f32 v28, v28, v251
    v_mul_f32 v29, v29, v251
    v_mul_f32 v30, v30, v251
    v_mul_f32 v31, v31, v251
    v_mul_f32 v40, v40, v251
    v_mul_f32 v41, v41, v251
    v_mul_f32 v42, v42, v251
    v_mul_f32 v43, v43, v251
    v_mul_f32 v52, v52, v251
    v_mul_f32 v53, v53, v251
    v_mul_f32 v54, v54, v251
    v_mul_f32 v55, v55, v251
    v_mul_f32 v64, v64, v251
    v_mul_f32 v65, v65, v251
    v_mul_f32 v66, v66, v251
    v_mul_f32 v67, v67, v251
    v_mul_f32 v76, v76, v251
    v_mul_f32 v77, v77, v251
    v_mul_f32 v78, v78, v251
    v_mul_f32 v79, v79, v251
    v_mul_f32 v88, v88, v251
    v_mul_f32 v89, v89, v251
    v_mul_f32 v90, v90, v251
    v_mul_f32 v91, v91, v251
    v_sub_f32 v216, v216, v250
    v_sub_f32 v217, v217, v250
    v_sub_f32 v218, v218, v250
    v_sub_f32 v219, v219, v250
    v_sub_f32 v220, v220, v250
    v_sub_f32 v221, v221, v250
    v_sub_f32 v222, v222, v250
    v_sub_f32 v223, v223, v250
    v_exp_f32 v216, v216
    v_exp_f32 v217, v217
    v_exp_f32 v218, v218
    v_add_f32 v238, v238, v216
    v_add_f32 v239, v239, v217
    v_exp_f32 v219, v219
    v_cvt_pk_bf16_f32 v216, v216, v217
    v_add_f32 v238, v238, v218
    v_exp_f32 v220, v220
    v_exp_f32 v221, v221
    v_add_f32 v239, v239, v219
    v_cvt_pk_bf16_f32 v217, v218, v219
    v_exp_f32 v222, v222
    v_add_f32 v238, v238, v220
    v_add_f32 v239, v239, v221
    v_exp_f32 v223, v223
    v_cvt_pk_bf16_f32 v218, v220, v221
    v_add_f32 v238, v238, v222
    v_cvt_pk_bf16_f32 v219, v222, v223
    v_add_f32 v239, v239, v223
    s_nop 0
    v_mfma_f32_16x16x32_bf16 v[4:7], v[176:179], v[216:219], v[4:7]
    v_mfma_f32_16x16x32_bf16 v[16:19], v[180:183], v[216:219], v[16:19]
    v_mfma_f32_16x16x32_bf16 v[28:31], v[184:187], v[216:219], v[28:31]
    v_mfma_f32_16x16x32_bf16 v[40:43], v[188:191], v[216:219], v[40:43]
    v_mfma_f32_16x16x32_bf16 v[52:55], v[192:195], v[216:219], v[52:55]
    v_mfma_f32_16x16x32_bf16 v[64:67], v[196:199], v[216:219], v[64:67]
    v_mfma_f32_16x16x32_bf16 v[76:79], v[200:203], v[216:219], v[76:79]
    v_mfma_f32_16x16x32_bf16 v[88:91], v[204:207], v[216:219], v[88:91]
    v_mfma_f32_16x16x32_bf16 v[224:227], v[144:147], v[128:131], 0
    v_mfma_f32_16x16x32_bf16 v[228:231], v[160:163], v[128:131], 0
    v_mfma_f32_16x16x32_bf16 v[224:227], v[148:151], v[132:135], v[224:227]
    v_mfma_f32_16x16x32_bf16 v[228:231], v[164:167], v[132:135], v[228:231]
    v_mfma_f32_16x16x32_bf16 v[224:227], v[152:155], v[136:139], v[224:227]
    v_mfma_f32_16x16x32_bf16 v[228:231], v[168:171], v[136:139], v[228:231]
    v_mfma_f32_16x16x32_bf16 v[224:227], v[156:159], v[140:143], v[224:227]
    v_mfma_f32_16x16x32_bf16 v[228:231], v[172:175], v[140:143], v[228:231]
    s_nop 6
    v_max3_f32 v250, v224, v225, v226
    v_max3_f32 v250, v250, v227, v228
    v_max3_f32 v250, v250, v229, v230
    v_max_f32 v250, v250, v231
    v_mov_b32 v251, v250
    s_nop 1
    v_permlane32_swap_b32 v251, v250
    v_max_f32 v250, v250, v251
    v_mov_b32 v251, v250
    s_nop 1
    v_permlane16_swap_b32 v251, v250
    v_max_f32 v250, v250, v251
    v_max_f32 v250, v250, v234
    v_sub_f32 v251, v234, v250
    v_exp_f32 v251, v251
    v_mov_b32 v234, v250
    v_mul_f32 v240, v240, v251
    v_mul_f32 v241, v241, v251
    v_mul_f32 v8, v8, v251
    v_mul_f32 v9, v9, v251
    v_mul_f32 v10, v10, v251
    v_mul_f32 v11, v11, v251
    v_mul_f32 v20, v20, v251
    v_mul_f32 v21, v21, v251
    v_mul_f32 v22, v22, v251
    v_mul_f32 v23, v23, v251
    v_mul_f32 v32, v32, v251
    v_mul_f32 v33, v33, v251
    v_mul_f32 v34, v34, v251
    v_mul_f32 v35, v35, v251
    v_mul_f32 v44, v44, v251
    v_mul_f32 v45, v45, v251
    v_mul_f32 v46, v46, v251
    v_mul_f32 v47, v47, v251
    v_mul_f32 v56, v56, v251
    v_mul_f32 v57, v57, v251
    v_mul_f32 v58, v58, v251
    v_mul_f32 v59, v59, v251
    v_mul_f32 v68, v68, v251
    v_mul_f32 v69, v69, v251
    v_mul_f32 v70, v70, v251
    v_mul_f32 v71, v71, v251
    v_mul_f32 v80, v80, v251
    v_mul_f32 v81, v81, v251
    v_mul_f32 v82, v82, v251
    v_mul_f32 v83, v83, v251
    v_mul_f32 v92, v92, v251
    v_mul_f32 v93, v93, v251
    v_mul_f32 v94, v94, v251
    v_mul_f32 v95, v95, v251
    v_sub_f32 v224, v224, v250
    v_sub_f32 v225, v225, v250
    v_sub_f32 v226, v226, v250
    v_sub_f32 v227, v227, v250
    v_sub_f32 v228, v228, v250
    v_sub_f32 v229, v229, v250
    v_sub_f32 v230, v230, v250
    v_sub_f32 v231, v231, v250
    v_exp_f32 v224, v224
    v_exp_f32 v225, v225
    v_exp_f32 v226, v226
    v_add_f32 v240, v240, v224
    v_add_f32 v241, v241, v225
    v_exp_f32 v227, v227
    v_cvt_pk_bf16_f32 v224, v224, v225
    v_add_f32 v240, v240, v226
    v_exp_f32 v228, v228
    v_exp_f32 v229, v229
    v_add_f32 v241, v241, v227
    v_cvt_pk_bf16_f32 v225, v226, v227
    v_exp_f32 v230, v230
    v_add_f32 v240, v240, v228
    v_add_f32 v241, v241, v229
    v_exp_f32 v231, v231
    v_cvt_pk_bf16_f32 v226, v228, v229
    v_add_f32 v240, v240, v230
    v_cvt_pk_bf16_f32 v227, v230, v231
    v_add_f32 v241, v241, v231
    s_nop 0
    v_mfma_f32_16x16x32_bf16 v[8:11], v[176:179], v[224:227], v[8:11]
    v_mfma_f32_16x16x32_bf16 v[20:23], v[180:183], v[224:227], v[20:23]
    v_mfma_f32_16x16x32_bf16 v[32:35], v[184:187], v[224:227], v[32:35]
    v_mfma_f32_16x16x32_bf16 v[44:47], v[188:191], v[224:227], v[44:47]
    v_mfma_f32_16x16x32_bf16 v[56:59], v[192:195], v[224:227], v[56:59]
    v_mfma_f32_16x16x32_bf16 v[68:71], v[196:199], v[224:227], v[68:71]
    v_mfma_f32_16x16x32_bf16 v[80:83], v[200:203], v[224:227], v[80:83]
    v_mfma_f32_16x16x32_bf16 v[92:95], v[204:207], v[224:227], v[92:95]
    s_add_u32 s26, s26, 8192
    s_cmp_lg_u32 s26, 262144
    s_cbranch_scc1 K1_safe
    v_add_f32 v236, v236, v237
    v_add_f32 v238, v238, v239
    v_add_f32 v240, v240, v241
    v_mov_b32 v237, v236
    v_mov_b32 v239, v238
    v_mov_b32 v241, v240
    v_permlane32_swap_b32 v237, v236
    v_permlane32_swap_b32 v239, v238
    v_permlane32_swap_b32 v241, v240
    v_add_f32 v236, v236, v237
    v_add_f32 v238, v238, v239
    v_add_f32 v240, v240, v241
    v_mov_b32 v237, v236
    v_mov_b32 v239, v238
    v_mov_b32 v241, v240
    v_permlane16_swap_b32 v237, v236
    v_permlane16_swap_b32 v239, v238
    v_permlane16_swap_b32 v241, v240
    v_add_f32 v236, v236, v237
    v_add_f32 v238, v238, v239
    v_add_f32 v240, v240, v241
    s_barrier
K1_epi:
    s_nop 7
    s_cmp_ge_u32 s2, 256
    s_cbranch_scc1 K1_wp0
    s_bitcmp0_b32 s2, 7
    s_cselect_b32 s84, s80, s82
    s_cselect_b32 s85, s81, s83
    s_mov_b32 s86, 5242880
    s_mov_b32 s87, 0x20000
    s_and_b32 s92, s2, 127
    s_mul_i32 s93, s92, 40960
    s_mul_i32 s94, s24, 10240
    s_add_u32 s93, s93, s94
    s_add_u32 s94, s94, 40960
    s_add_u32 m0, s94, 0
    s_add_u32 s95, s93, 0
    buffer_load_dwordx4 v255, s[84:87], s95 offen offset:0 lds
    buffer_load_dwordx4 v255, s[84:87], s95 offen offset:1024 lds
    buffer_load_dwordx4 v255, s[84:87], s95 offen offset:2048 lds
    buffer_load_dwordx4 v255, s[84:87], s95 offen offset:3072 lds
    s_add_u32 m0, s94, 4096
    s_add_u32 s95, s93, 4096
    buffer_load_dwordx4 v255, s[84:87], s95 offen offset:0 lds
    buffer_load_dwordx4 v255, s[84:87], s95 offen offset:1024 lds
    buffer_load_dwordx4 v255, s[84:87], s95 offen offset:2048 lds
    buffer_load_dwordx4 v255, s[84:87], s95 offen offset:3072 lds
    s_add_u32 m0, s94, 8192
    s_add_u32 s95, s93, 8192
    buffer_load_dwordx4 v255, s[84:87], s95 offen offset:0 lds
    buffer_load_dwordx4 v255, s[84:87], s95 offen offset:1024 lds
K1_wp0:
    v_rcp_f32 v236, v236
    v_rcp_f32 v238, v238
    v_rcp_f32 v240, v240
    v_mov_b32 v237, v236
    v_mov_b32 v239, v238
    v_mov_b32 v241, v240
    s_mov_b32 s29, 131072
    s_mov_b32 s30, 262144
    v_pk_mul_f32 v[0:1], v[0:1], v[236:237]
    v_pk_mul_f32 v[2:3], v[2:3], v[236:237]
    v_pk_mul_f32 v[12:13], v[12:13], v[236:237]
    v_pk_mul_f32 v[14:15], v[14:15], v[236:237]
    v_cvt_pk_bf16_f32 v96, v0, v1
    v_cvt_pk_bf16_f32 v97, v2, v3
    v_cvt_pk_bf16_f32 v98, v12, v13
    v_cvt_pk_bf16_f32 v99, v14, v15
    buffer_store_dwordx4 v[96:99], v255, s[20:23], 0 offen offset:0 sc0 sc1
    v_pk_mul_f32 v[24:25], v[24:25], v[236:237]
    v_pk_mul_f32 v[26:27], v[26:27], v[236:237]
    v_pk_mul_f32 v[36:37], v[36:37], v[236:237]
    v_pk_mul_f32 v[38:39], v[38:39], v[236:237]
    v_cvt_pk_bf16_f32 v100, v24, v25
    v_cvt_pk_bf16_f32 v101, v26, v27
    v_cvt_pk_bf16_f32 v102, v36, v37
    v_cvt_pk_bf16_f32 v103, v38, v39
    buffer_store_dwordx4 v[100:103], v255, s[20:23], 0 offen offset:1024 sc0 sc1
    v_pk_mul_f32 v[48:49], v[48:49], v[236:237]
    v_pk_mul_f32 v[50:51], v[50:51], v[236:237]
    v_pk_mul_f32 v[60:61], v[60:61], v[236:237]
    v_pk_mul_f32 v[62:63], v[62:63], v[236:237]
    v_cvt_pk_bf16_f32 v104, v48, v49
    v_cvt_pk_bf16_f32 v105, v50, v51
    v_cvt_pk_bf16_f32 v106, v60, v61
    v_cvt_pk_bf16_f32 v107, v62, v63
    buffer_store_dwordx4 v[104:107], v255, s[20:23], 0 offen offset:2048 sc0 sc1
    v_pk_mul_f32 v[72:73], v[72:73], v[236:237]
    v_pk_mul_f32 v[74:75], v[74:75], v[236:237]
    v_pk_mul_f32 v[84:85], v[84:85], v[236:237]
    v_pk_mul_f32 v[86:87], v[86:87], v[236:237]
    v_cvt_pk_bf16_f32 v108, v72, v73
    v_cvt_pk_bf16_f32 v109, v74, v75
    v_cvt_pk_bf16_f32 v110, v84, v85
    v_cvt_pk_bf16_f32 v111, v86, v87
    buffer_store_dwordx4 v[108:111], v255, s[20:23], 0 offen offset:3072 sc0 sc1
    v_pk_mul_f32 v[4:5], v[4:5], v[238:239]
    v_pk_mul_f32 v[6:7], v[6:7], v[238:239]
    v_pk_mul_f32 v[16:17], v[16:17], v[238:239]
    v_pk_mul_f32 v[18:19], v[18:19], v[238:239]
    v_cvt_pk_bf16_f32 v112, v4, v5
    v_cvt_pk_bf16_f32 v113, v6, v7
    v_cvt_pk_bf16_f32 v114, v16, v17
    v_cvt_pk_bf16_f32 v115, v18, v19
    buffer_store_dwordx4 v[112:115], v255, s[20:23], s29 offen offset:0 sc0 sc1
    v_pk_mul_f32 v[28:29], v[28:29], v[238:239]
    v_pk_mul_f32 v[30:31], v[30:31], v[238:239]
    v_pk_mul_f32 v[40:41], v[40:41], v[238:239]
    v_pk_mul_f32 v[42:43], v[42:43], v[238:239]
    v_cvt_pk_bf16_f32 v116, v28, v29
    v_cvt_pk_bf16_f32 v117, v30, v31
    v_cvt_pk_bf16_f32 v118, v40, v41
    v_cvt_pk_bf16_f32 v119, v42, v43
    buffer_store_dwordx4 v[116:119], v255, s[20:23], s29 offen offset:1024 sc0 sc1
    v_pk_mul_f32 v[52:53], v[52:53], v[238:239]
    v_pk_mul_f32 v[54:55], v[54:55], v[238:239]
    v_pk_mul_f32 v[64:65], v[64:65], v[238:239]
    v_pk_mul_f32 v[66:67], v[66:67], v[238:239]
    v_cvt_pk_bf16_f32 v120, v52, v53
    v_cvt_pk_bf16_f32 v121, v54, v55
    v_cvt_pk_bf16_f32 v122, v64, v65
    v_cvt_pk_bf16_f32 v123, v66, v67
    buffer_store_dwordx4 v[120:123], v255, s[20:23], s29 offen offset:2048 sc0 sc1
    v_pk_mul_f32 v[76:77], v[76:77], v[238:239]
    v_pk_mul_f32 v[78:79], v[78:79], v[238:239]
    v_pk_mul_f32 v[88:89], v[88:89], v[238:239]
    v_pk_mul_f32 v[90:91], v[90:91], v[238:239]
    v_cvt_pk_bf16_f32 v124, v76, v77
    v_cvt_pk_bf16_f32 v125, v78, v79
    v_cvt_pk_bf16_f32 v126, v88, v89
    v_cvt_pk_bf16_f32 v127, v90, v91
    buffer_store_dwordx4 v[124:127], v255, s[20:23], s29 offen offset:3072 sc0 sc1
    v_pk_mul_f32 v[8:9], v[8:9], v[240:241]
    v_pk_mul_f32 v[10:11], v[10:11], v[240:241]
    v_pk_mul_f32 v[20:21], v[20:21], v[240:241]
    v_pk_mul_f32 v[22:23], v[22:23], v[240:241]
    v_cvt_pk_bf16_f32 v128, v8, v9
    v_cvt_pk_bf16_f32 v129, v10, v11
    v_cvt_pk_bf16_f32 v130, v20, v21
    v_cvt_pk_bf16_f32 v131, v22, v23
    buffer_store_dwordx4 v[128:131], v255, s[20:23], s30 offen offset:0 sc0 sc1
    v_pk_mul_f32 v[32:33], v[32:33], v[240:241]
    v_pk_mul_f32 v[34:35], v[34:35], v[240:241]
    v_pk_mul_f32 v[44:45], v[44:45], v[240:241]
    v_pk_mul_f32 v[46:47], v[46:47], v[240:241]
    v_cvt_pk_bf16_f32 v132, v32, v33
    v_cvt_pk_bf16_f32 v133, v34, v35
    v_cvt_pk_bf16_f32 v134, v44, v45
    v_cvt_pk_bf16_f32 v135, v46, v47
    buffer_store_dwordx4 v[132:135], v255, s[20:23], s30 offen offset:1024 sc0 sc1
    v_pk_mul_f32 v[56:57], v[56:57], v[240:241]
    v_pk_mul_f32 v[58:59], v[58:59], v[240:241]
    v_pk_mul_f32 v[68:69], v[68:69], v[240:241]
    v_pk_mul_f32 v[70:71], v[70:71], v[240:241]
    v_cvt_pk_bf16_f32 v136, v56, v57
    v_cvt_pk_bf16_f32 v137, v58, v59
    v_cvt_pk_bf16_f32 v138, v68, v69
    v_cvt_pk_bf16_f32 v139, v70, v71
    buffer_store_dwordx4 v[136:139], v255, s[20:23], s30 offen offset:2048 sc0 sc1
    v_pk_mul_f32 v[80:81], v[80:81], v[240:241]
    v_pk_mul_f32 v[82:83], v[82:83], v[240:241]
    v_pk_mul_f32 v[92:93], v[92:93], v[240:241]
    v_pk_mul_f32 v[94:95], v[94:95], v[240:241]
    v_cvt_pk_bf16_f32 v140, v80, v81
    v_cvt_pk_bf16_f32 v141, v82, v83
    v_cvt_pk_bf16_f32 v142, v92, v93
    v_cvt_pk_bf16_f32 v143, v94, v95
    buffer_store_dwordx4 v[140:143], v255, s[20:23], s30 offen offset:3072 sc0 sc1
    s_cmp_ge_u32 s2, 256
    s_cbranch_scc1 K1_wp1
    s_waitcnt vmcnt(12)
    s_barrier
    s_bfe_u32 s93, s2, 0x10007
    s_mul_i32 s93, s93, 40
    s_mul_i32 s94, s24, 10
    s_add_u32 s93, s93, s94
    s_mul_i32 s93, s93, 131072
    s_lshl_b32 s92, s92, 10
    s_add_u32 s93, s93, s92
    s_add_u32 s93, s93, 33554432
    s_add_u32 s88, s52, s93
    s_addc_u32 s89, s53, 0
    s_mov_b32 s90, 1180672
    s_mov_b32 s91, 0x20000
    v_lshrrev_b32 v250, 6, v255
    v_mul_u32_u24 v250, 1280, v250
    v_bfe_u32 v251, v255, 4, 2
    v_lshl_add_u32 v250, v251, 3, v250
    s_mul_i32 s94, s24, 320
    s_add_u32 s94, s94, 40960
    v_add_u32 v250, s94, v250
    ds_read_b64_tr_b16 v[0:1], v250 offset:0
    ds_read_b64_tr_b16 v[2:3], v250 offset:20480
    ds_read_b64_tr_b16 v[4:5], v250 offset:32
    ds_read_b64_tr_b16 v[6:7], v250 offset:20512
    ds_read_b64_tr_b16 v[8:9], v250 offset:64
    ds_read_b64_tr_b16 v[10:11], v250 offset:20544
    ds_read_b64_tr_b16 v[12:13], v250 offset:96
    ds_read_b64_tr_b16 v[14:15], v250 offset:20576
    ds_read_b64_tr_b16 v[16:17], v250 offset:128
    ds_read_b64_tr_b16 v[18:19], v250 offset:20608
    ds_read_b64_tr_b16 v[20:21], v250 offset:160
    ds_read_b64_tr_b16 v[22:23], v250 offset:20640
    ds_read_b64_tr_b16 v[24:25], v250 offset:192
    ds_read_b64_tr_b16 v[26:27], v250 offset:20672
    ds_read_b64_tr_b16 v[28:29], v250 offset:224
    ds_read_b64_tr_b16 v[30:31], v250 offset:20704
    ds_read_b64_tr_b16 v[32:33], v250 offset:256
    ds_read_b64_tr_b16 v[34:35], v250 offset:20736
    ds_read_b64_tr_b16 v[36:37], v250 offset:288
    ds_read_b64_tr_b16 v[38:39], v250 offset:20768
    s_waitcnt lgkmcnt(15)
    s_mov_b32 s94, 0
    buffer_store_dwordx4 v[0:3], v255, s[88:91], s94 offen sc0 sc1
    s_mov_b32 s94, 131072
    buffer_store_dwordx4 v[4:7], v255, s[88:91], s94 offen sc0 sc1
    s_waitcnt lgkmcnt(14)
    s_mov_b32 s94, 262144
    buffer_store_dwordx4 v[8:11], v255, s[88:91], s94 offen sc0 sc1
    s_waitcnt lgkmcnt(12)
    s_mov_b32 s94, 393216
    buffer_store_dwordx4 v[12:15], v255, s[88:91], s94 offen sc0 sc1
    s_waitcnt lgkmcnt(10)
    s_mov_b32 s94, 524288
    buffer_store_dwordx4 v[16:19], v255, s[88:91], s94 offen sc0 sc1
    s_waitcnt lgkmcnt(8)
    s_mov_b32 s94, 655360
    buffer_store_dwordx4 v[20:23], v255, s[88:91], s94 offen sc0 sc1
    s_waitcnt lgkmcnt(6)
    s_mov_b32 s94, 786432
    buffer_store_dwordx4 v[24:27], v255, s[88:91], s94 offen sc0 sc1
    s_waitcnt lgkmcnt(4)
    s_mov_b32 s94, 917504
    buffer_store_dwordx4 v[28:31], v255, s[88:91], s94 offen sc0 sc1
    s_waitcnt lgkmcnt(2)
    s_mov_b32 s94, 1048576
    buffer_store_dwordx4 v[32:35], v255, s[88:91], s94 offen sc0 sc1
    s_waitcnt lgkmcnt(0)
    s_mov_b32 s94, 1179648
    buffer_store_dwordx4 v[36:39], v255, s[88:91], s94 offen sc0 sc1
K1_wp1:
K1_end:
    s_endpgm
.globl oproj_kernel
.p2align 8
.type oproj_kernel,@function
oproj_kernel:
    s_cmp_ge_u32 s2, 256
    s_cbranch_scc1 K2_end
    s_load_dwordx2 s[40:41], s[0:1], 80
    s_load_dwordx2 s[52:53], s[0:1], 96
    v_lshrrev_b32 v1, 6, v0
    v_and_b32 v0, 63, v0
    v_readfirstlane_b32 s24, v1
    s_and_b32 s31, s2, 7
    s_lshr_b32 s32, s2, 3
    s_lshl_b32 s31, s31, 2
    s_lshr_b32 s33, s32, 3
    s_add_u32 s31, s31, s33
    s_and_b32 s32, s32, 7
    s_lshr_b32 s33, s31, 4
    v_lshlrev_b32 v252, 4, v0
    v_lshlrev_b32 v254, 4, v0
    v_and_b32 v1, 15, v0
    v_lshrrev_b32 v2, 4, v0
    v_mul_u32_u24 v3, 2560, v1
    v_lshl_add_u32 v253, v2, 3, v3
    s_mov_b32 s44, 131072
    s_mov_b32 s45, 262144
    s_mov_b32 s46, 393216
    s_mov_b32 s47, 524288
    s_mov_b32 s48, 655360
    s_lshl_b32 s55, s24, 15
    s_lshl_b32 s54, s33, 3
    s_add_u32 s54, s54, s32
    s_mul_i32 s54, s54, 655360
    s_add_u32 s54, s54, s55
    s_add_u32 s56, s54, 33554432
    s_mul_i32 s54, s31, 786432
    s_add_u32 s54, s54, s55
    s_waitcnt lgkmcnt(0)
    s_add_u32 s4, s52, s54
    s_addc_u32 s5, s53, 0
    s_mov_b32 s6, 688128
    s_mov_b32 s7, 0x20000
    s_add_u32 s8, s52, s56
    s_addc_u32 s9, s53, 0
    s_mov_b32 s10, 557056
    s_mov_b32 s11, 0x20000
    buffer_load_dwordx4 v[0:3], v252, s[4:7], 0 offen offset:0
    buffer_load_dwordx4 v[24:27], v252, s[8:11], 0 offen offset:0
    buffer_load_dwordx4 v[4:7], v252, s[4:7], s44 offen offset:0
    buffer_load_dwordx4 v[28:31], v252, s[8:11], s44 offen offset:0
    buffer_load_dwordx4 v[8:11], v252, s[4:7], s45 offen offset:0
    buffer_load_dwordx4 v[32:35], v252, s[8:11], s45 offen offset:0
    buffer_load_dwordx4 v[12:15], v252, s[4:7], s46 offen offset:0
    buffer_load_dwordx4 v[36:39], v252, s[8:11], s46 offen offset:0
    buffer_load_dwordx4 v[16:19], v252, s[4:7], s47 offen offset:0
    buffer_load_dwordx4 v[40:43], v252, s[8:11], s47 offen offset:0
    buffer_load_dwordx4 v[20:23], v252, s[4:7], s48 offen offset:0
    buffer_load_dwordx4 v[44:47], v252, s[4:7], 0 offen offset:1024
    buffer_load_dwordx4 v[68:71], v252, s[8:11], 0 offen offset:1024
    buffer_load_dwordx4 v[48:51], v252, s[4:7], s44 offen offset:1024
    buffer_load_dwordx4 v[72:75], v252, s[8:11], s44 offen offset:1024
    buffer_load_dwordx4 v[52:55], v252, s[4:7], s45 offen offset:1024
    buffer_load_dwordx4 v[76:79], v252, s[8:11], s45 offen offset:1024
    buffer_load_dwordx4 v[56:59], v252, s[4:7], s46 offen offset:1024
    buffer_load_dwordx4 v[80:83], v252, s[8:11], s46 offen offset:1024
    buffer_load_dwordx4 v[60:63], v252, s[4:7], s47 offen offset:1024
    buffer_load_dwordx4 v[84:87], v252, s[8:11], s47 offen offset:1024
    buffer_load_dwordx4 v[64:67], v252, s[4:7], s48 offen offset:1024
    s_and_b32 s54, s31, 15
    s_mul_i32 s54, s54, 245760
    s_mul_i32 s55, s33, 1280
    s_add_u32 s54, s54, s55
    s_mul_i32 s55, s32, 160
    s_add_u32 s54, s54, s55
    s_add_u32 s12, s40, s54
    s_addc_u32 s13, s41, 0
    s_sub_u32 s14, 3932160, s54
    s_mov_b32 s15, 0x20000
    s_mul_i32 s25, s24, 30720
    s_waitcnt vmcnt(11)
    v_mfma_f32_16x16x32_bf16 a[0:3], v[24:27], v[0:3], 0
    buffer_load_dwordx4 v[88:91], v252, s[4:7], 0 offen offset:2048
    v_mfma_f32_16x16x32_bf16 a[20:23], v[24:27], v[4:7], 0
    v_mfma_f32_16x16x32_bf16 a[40:43], v[24:27], v[8:11], 0
    buffer_load_dwordx4 v[112:115], v252, s[8:11], 0 offen offset:2048
    v_mfma_f32_16x16x32_bf16 a[60:63], v[24:27], v[12:15], 0
    v_mfma_f32_16x16x32_bf16 a[80:83], v[24:27], v[16:19], 0
    v_mfma_f32_16x16x32_bf16 a[100:103], v[24:27], v[20:23], 0
    buffer_load_dwordx4 v[92:95], v252, s[4:7], s44 offen offset:2048
    v_mfma_f32_16x16x32_bf16 a[4:7], v[28:31], v[0:3], 0
    v_mfma_f32_16x16x32_bf16 a[24:27], v[28:31], v[4:7], 0
    v_mfma_f32_16x16x32_bf16 a[44:47], v[28:31], v[8:11], 0
    buffer_load_dwordx4 v[116:119], v252, s[8:11], s44 offen offset:2048
    v_mfma_f32_16x16x32_bf16 a[64:67], v[28:31], v[12:15], 0
    v_mfma_f32_16x16x32_bf16 a[84:87], v[28:31], v[16:19], 0
    buffer_load_dwordx4 v[96:99], v252, s[4:7], s45 offen offset:2048
    v_mfma_f32_16x16x32_bf16 a[104:107], v[28:31], v[20:23], 0
    v_mfma_f32_16x16x32_bf16 a[8:11], v[32:35], v[0:3], 0
    v_mfma_f32_16x16x32_bf16 a[28:31], v[32:35], v[4:7], 0
    buffer_load_dwordx4 v[120:123], v252, s[8:11], s45 offen offset:2048
    v_mfma_f32_16x16x32_bf16 a[48:51], v[32:35], v[8:11], 0
    v_mfma_f32_16x16x32_bf16 a[68:71], v[32:35], v[12:15], 0
    v_mfma_f32_16x16x32_bf16 a[88:91], v[32:35], v[16:19], 0
    buffer_load_dwordx4 v[100:103], v252, s[4:7], s46 offen offset:2048
    v_mfma_f32_16x16x32_bf16 a[108:111], v[32:35], v[20:23], 0
    v_mfma_f32_16x16x32_bf16 a[12:15], v[36:39], v[0:3], 0
    v_mfma_f32_16x16x32_bf16 a[32:35], v[36:39], v[4:7], 0
    buffer_load_dwordx4 v[124:127], v252, s[8:11], s46 offen offset:2048
    v_mfma_f32_16x16x32_bf16 a[52:55], v[36:39], v[8:11], 0
    v_mfma_f32_16x16x32_bf16 a[72:75], v[36:39], v[12:15], 0
    buffer_load_dwordx4 v[104:107], v252, s[4:7], s47 offen offset:2048
    v_mfma_f32_16x16x32_bf16 a[92:95], v[36:39], v[16:19], 0
    v_mfma_f32_16x16x32_bf16 a[112:115], v[36:39], v[20:23], 0
    v_mfma_f32_16x16x32_bf16 a[16:19], v[40:43], v[0:3], 0
    buffer_load_dwordx4 v[128:131], v252, s[8:11], s47 offen offset:2048
    v_mfma_f32_16x16x32_bf16 a[36:39], v[40:43], v[4:7], 0
    v_mfma_f32_16x16x32_bf16 a[56:59], v[40:43], v[8:11], 0
    v_mfma_f32_16x16x32_bf16 a[76:79], v[40:43], v[12:15], 0
    buffer_load_dwordx4 v[108:111], v252, s[4:7], s48 offen offset:2048
    v_mfma_f32_16x16x32_bf16 a[96:99], v[40:43], v[16:19], 0
    v_mfma_f32_16x16x32_bf16 a[116:119], v[40:43], v[20:23], 0
    s_waitcnt vmcnt(11)
    v_mfma_f32_16x16x32_bf16 a[0:3], v[68:71], v[44:47], a[0:3]
    buffer_load_dwordx4 v[0:3], v252, s[4:7], 0 offen offset:3072
    v_mfma_f32_16x16x32_bf16 a[20:23], v[68:71], v[48:51], a[20:23]
    v_mfma_f32_16x16x32_bf16 a[40:43], v[68:71], v[52:55], a[40:43]
    buffer_load_dwordx4 v[24:27], v252, s[8:11], 0 offen offset:3072
    v_mfma_f32_16x16x32_bf16 a[60:63], v[68:71], v[56:59], a[60:63]
    v_mfma_f32_16x16x32_bf16 a[80:83], v[68:71], v[60:63], a[80:83]
    v_mfma_f32_16x16x32_bf16 a[100:103], v[68:71], v[64:67], a[100:103]
    buffer_load_dwordx4 v[4:7], v252, s[4:7], s44 offen offset:3072
    v_mfma_f32_16x16x32_bf16 a[4:7], v[72:75], v[44:47], a[4:7]
    v_mfma_f32_16x16x32_bf16 a[24:27], v[72:75], v[48:51], a[24:27]
    v_mfma_f32_16x16x32_bf16 a[44:47], v[72:75], v[52:55], a[44:47]
    buffer_load_dwordx4 v[28:31], v252, s[8:11], s44 offen offset:3072
    v_mfma_f32_16x16x32_bf16 a[64:67], v[72:75], v[56:59], a[64:67]
    v_mfma_f32_16x16x32_bf16 a[84:87], v[72:75], v[60:63], a[84:87]
    buffer_load_dwordx4 v[8:11], v252, s[4:7], s45 offen offset:3072
    v_mfma_f32_16x16x32_bf16 a[104:107], v[72:75], v[64:67], a[104:107]
    v_mfma_f32_16x16x32_bf16 a[8:11], v[76:79], v[44:47], a[8:11]
    v_mfma_f32_16x16x32_bf16 a[28:31], v[76:79], v[48:51], a[28:31]
    buffer_load_dwordx4 v[32:35], v252, s[8:11], s45 offen offset:3072
    v_mfma_f32_16x16x32_bf16 a[48:51], v[76:79], v[52:55], a[48:51]
    v_mfma_f32_16x16x32_bf16 a[68:71], v[76:79], v[56:59], a[68:71]
    v_mfma_f32_16x16x32_bf16 a[88:91], v[76:79], v[60:63], a[88:91]
    buffer_load_dwordx4 v[12:15], v252, s[4:7], s46 offen offset:3072
    v_mfma_f32_16x16x32_bf16 a[108:111], v[76:79], v[64:67], a[108:111]
    v_mfma_f32_16x16x32_bf16 a[12:15], v[80:83], v[44:47], a[12:15]
    v_mfma_f32_16x16x32_bf16 a[32:35], v[80:83], v[48:51], a[32:35]
    buffer_load_dwordx4 v[36:39], v252, s[8:11], s46 offen offset:3072
    v_mfma_f32_16x16x32_bf16 a[52:55], v[80:83], v[52:55], a[52:55]
    v_mfma_f32_16x16x32_bf16 a[72:75], v[80:83], v[56:59], a[72:75]
    buffer_load_dwordx4 v[16:19], v252, s[4:7], s47 offen offset:3072
    v_mfma_f32_16x16x32_bf16 a[92:95], v[80:83], v[60:63], a[92:95]
    v_mfma_f32_16x16x32_bf16 a[112:115], v[80:83], v[64:67], a[112:115]
    v_mfma_f32_16x16x32_bf16 a[16:19], v[84:87], v[44:47], a[16:19]
    buffer_load_dwordx4 v[40:43], v252, s[8:11], s47 offen offset:3072
    v_mfma_f32_16x16x32_bf16 a[36:39], v[84:87], v[48:51], a[36:39]
    v_mfma_f32_16x16x32_bf16 a[56:59], v[84:87], v[52:55], a[56:59]
    v_mfma_f32_16x16x32_bf16 a[76:79], v[84:87], v[56:59], a[76:79]
    buffer_load_dwordx4 v[20:23], v252, s[4:7], s48 offen offset:3072
    v_mfma_f32_16x16x32_bf16 a[96:99], v[84:87], v[60:63], a[96:99]
    v_mfma_f32_16x16x32_bf16 a[116:119], v[84:87], v[64:67], a[116:119]
    s_waitcnt vmcnt(11)
    v_mfma_f32_16x16x32_bf16 a[0:3], v[112:115], v[88:91], a[0:3]
    v_add_u32 v252, 4096, v252
    buffer_load_dwordx4 v[44:47], v252, s[4:7], 0 offen offset:0
    v_mfma_f32_16x16x32_bf16 a[20:23], v[112:115], v[92:95], a[20:23]
    v_mfma_f32_16x16x32_bf16 a[40:43], v[112:115], v[96:99], a[40:43]
    buffer_load_dwordx4 v[68:71], v252, s[8:11], 0 offen offset:0
    v_mfma_f32_16x16x32_bf16 a[60:63], v[112:115], v[100:103], a[60:63]
    v_mfma_f32_16x16x32_bf16 a[80:83], v[112:115], v[104:107], a[80:83]
    v_mfma_f32_16x16x32_bf16 a[100:103], v[112:115], v[108:111], a[100:103]
    buffer_load_dwordx4 v[48:51], v252, s[4:7], s44 offen offset:0
    v_mfma_f32_16x16x32_bf16 a[4:7], v[116:119], v[88:91], a[4:7]
    v_mfma_f32_16x16x32_bf16 a[24:27], v[116:119], v[92:95], a[24:27]
    v_mfma_f32_16x16x32_bf16 a[44:47], v[116:119], v[96:99], a[44:47]
    buffer_load_dwordx4 v[72:75], v252, s[8:11], s44 offen offset:0
    v_mfma_f32_16x16x32_bf16 a[64:67], v[116:119], v[100:103], a[64:67]
    v_mfma_f32_16x16x32_bf16 a[84:87], v[116:119], v[104:107], a[84:87]
    buffer_load_dwordx4 v[52:55], v252, s[4:7], s45 offen offset:0
    v_mfma_f32_16x16x32_bf16 a[104:107], v[116:119], v[108:111], a[104:107]
    v_mfma_f32_16x16x32_bf16 a[8:11], v[120:123], v[88:91], a[8:11]
    v_mfma_f32_16x16x32_bf16 a[28:31], v[120:123], v[92:95], a[28:31]
    buffer_load_dwordx4 v[76:79], v252, s[8:11], s45 offen offset:0
    v_mfma_f32_16x16x32_bf16 a[48:51], v[120:123], v[96:99], a[48:51]
    v_mfma_f32_16x16x32_bf16 a[68:71], v[120:123], v[100:103], a[68:71]
    v_mfma_f32_16x16x32_bf16 a[88:91], v[120:123], v[104:107], a[88:91]
    buffer_load_dwordx4 v[56:59], v252, s[4:7], s46 offen offset:0
    v_mfma_f32_16x16x32_bf16 a[108:111], v[120:123], v[108:111], a[108:111]
    v_mfma_f32_16x16x32_bf16 a[12:15], v[124:127], v[88:91], a[12:15]
    v_mfma_f32_16x16x32_bf16 a[32:35], v[124:127], v[92:95], a[32:35]
    buffer_load_dwordx4 v[80:83], v252, s[8:11], s46 offen offset:0
    v_mfma_f32_16x16x32_bf16 a[52:55], v[124:127], v[96:99], a[52:55]
    v_mfma_f32_16x16x32_bf16 a[72:75], v[124:127], v[100:103], a[72:75]
    buffer_load_dwordx4 v[60:63], v252, s[4:7], s47 offen offset:0
    v_mfma_f32_16x16x32_bf16 a[92:95], v[124:127], v[104:107], a[92:95]
    v_mfma_f32_16x16x32_bf16 a[112:115], v[124:127], v[108:111], a[112:115]
    v_mfma_f32_16x16x32_bf16 a[16:19], v[128:131], v[88:91], a[16:19]
    buffer_load_dwordx4 v[84:87], v252, s[8:11], s47 offen offset:0
    v_mfma_f32_16x16x32_bf16 a[36:39], v[128:131], v[92:95], a[36:39]
    v_mfma_f32_16x16x32_bf16 a[56:59], v[128:131], v[96:99], a[56:59]
    v_mfma_f32_16x16x32_bf16 a[76:79], v[128:131], v[100:103], a[76:79]
    buffer_load_dwordx4 v[64:67], v252, s[4:7], s48 offen offset:0
    v_mfma_f32_16x16x32_bf16 a[96:99], v[128:131], v[104:107], a[96:99]
    v_mfma_f32_16x16x32_bf16 a[116:119], v[128:131], v[108:111], a[116:119]
    s_waitcnt vmcnt(11)
    v_mfma_f32_16x16x32_bf16 a[0:3], v[24:27], v[0:3], a[0:3]
    buffer_load_dwordx4 v[88:91], v252, s[4:7], 0 offen offset:1024
    v_mfma_f32_16x16x32_bf16 a[20:23], v[24:27], v[4:7], a[20:23]
    v_mfma_f32_16x16x32_bf16 a[40:43], v[24:27], v[8:11], a[40:43]
    buffer_load_dwordx4 v[112:115], v252, s[8:11], 0 offen offset:1024
    v_mfma_f32_16x16x32_bf16 a[60:63], v[24:27], v[12:15], a[60:63]
    v_mfma_f32_16x16x32_bf16 a[80:83], v[24:27], v[16:19], a[80:83]
    v_mfma_f32_16x16x32_bf16 a[100:103], v[24:27], v[20:23], a[100:103]
    buffer_load_dwordx4 v[92:95], v252, s[4:7], s44 offen offset:1024
    v_mfma_f32_16x16x32_bf16 a[4:7], v[28:31], v[0:3], a[4:7]
    v_mfma_f32_16x16x32_bf16 a[24:27], v[28:31], v[4:7], a[24:27]
    v_mfma_f32_16x16x32_bf16 a[44:47], v[28:31], v[8:11], a[44:47]
    buffer_load_dwordx4 v[116:119], v252, s[8:11], s44 offen offset:1024
    v_mfma_f32_16x16x32_bf16 a[64:67], v[28:31], v[12:15], a[64:67]
    v_mfma_f32_16x16x32_bf16 a[84:87], v[28:31], v[16:19], a[84:87]
    buffer_load_dwordx4 v[96:99], v252, s[4:7], s45 offen offset:1024
    v_mfma_f32_16x16x32_bf16 a[104:107], v[28:31], v[20:23], a[104:107]
    v_mfma_f32_16x16x32_bf16 a[8:11], v[32:35], v[0:3], a[8:11]
    v_mfma_f32_16x16x32_bf16 a[28:31], v[32:35], v[4:7], a[28:31]
    buffer_load_dwordx4 v[120:123], v252, s[8:11], s45 offen offset:1024
    v_mfma_f32_16x16x32_bf16 a[48:51], v[32:35], v[8:11], a[48:51]
    v_mfma_f32_16x16x32_bf16 a[68:71], v[32:35], v[12:15], a[68:71]
    v_mfma_f32_16x16x32_bf16 a[88:91], v[32:35], v[16:19], a[88:91]
    buffer_load_dwordx4 v[100:103], v252, s[4:7], s46 offen offset:1024
    v_mfma_f32_16x16x32_bf16 a[108:111], v[32:35], v[20:23], a[108:111]
    v_mfma_f32_16x16x32_bf16 a[12:15], v[36:39], v[0:3], a[12:15]
    v_mfma_f32_16x16x32_bf16 a[32:35], v[36:39], v[4:7], a[32:35]
    buffer_load_dwordx4 v[124:127], v252, s[8:11], s46 offen offset:1024
    v_mfma_f32_16x16x32_bf16 a[52:55], v[36:39], v[8:11], a[52:55]
    v_mfma_f32_16x16x32_bf16 a[72:75], v[36:39], v[12:15], a[72:75]
    buffer_load_dwordx4 v[104:107], v252, s[4:7], s47 offen offset:1024
    v_mfma_f32_16x16x32_bf16 a[92:95], v[36:39], v[16:19], a[92:95]
    v_mfma_f32_16x16x32_bf16 a[112:115], v[36:39], v[20:23], a[112:115]
    v_mfma_f32_16x16x32_bf16 a[16:19], v[40:43], v[0:3], a[16:19]
    buffer_load_dwordx4 v[128:131], v252, s[8:11], s47 offen offset:1024
    v_mfma_f32_16x16x32_bf16 a[36:39], v[40:43], v[4:7], a[36:39]
    v_mfma_f32_16x16x32_bf16 a[56:59], v[40:43], v[8:11], a[56:59]
    v_mfma_f32_16x16x32_bf16 a[76:79], v[40:43], v[12:15], a[76:79]
    buffer_load_dwordx4 v[108:111], v252, s[4:7], s48 offen offset:1024
    v_mfma_f32_16x16x32_bf16 a[96:99], v[40:43], v[16:19], a[96:99]
    v_mfma_f32_16x16x32_bf16 a[116:119], v[40:43], v[20:23], a[116:119]
    s_waitcnt vmcnt(11)
    v_mfma_f32_16x16x32_bf16 a[0:3], v[68:71], v[44:47], a[0:3]
    buffer_load_dwordx4 v[0:3], v252, s[4:7], 0 offen offset:2048
    v_mfma_f32_16x16x32_bf16 a[20:23], v[68:71], v[48:51], a[20:23]
    v_mfma_f32_16x16x32_bf16 a[40:43], v[68:71], v[52:55], a[40:43]
    buffer_load_dwordx4 v[24:27], v252, s[8:11], 0 offen offset:2048
    v_mfma_f32_16x16x32_bf16 a[60:63], v[68:71], v[56:59], a[60:63]
    v_mfma_f32_16x16x32_bf16 a[80:83], v[68:71], v[60:63], a[80:83]
    v_mfma_f32_16x16x32_bf16 a[100:103], v[68:71], v[64:67], a[100:103]
    buffer_load_dwordx4 v[4:7], v252, s[4:7], s44 offen offset:2048
    v_mfma_f32_16x16x32_bf16 a[4:7], v[72:75], v[44:47], a[4:7]
    v_mfma_f32_16x16x32_bf16 a[24:27], v[72:75], v[48:51], a[24:27]
    v_mfma_f32_16x16x32_bf16 a[44:47], v[72:75], v[52:55], a[44:47]
    buffer_load_dwordx4 v[28:31], v252, s[8:11], s44 offen offset:2048
    v_mfma_f32_16x16x32_bf16 a[64:67], v[72:75], v[56:59], a[64:67]
    v_mfma_f32_16x16x32_bf16 a[84:87], v[72:75], v[60:63], a[84:87]
    buffer_load_dwordx4 v[8:11], v252, s[4:7], s45 offen offset:2048
    v_mfma_f32_16x16x32_bf16 a[104:107], v[72:75], v[64:67], a[104:107]
    v_mfma_f32_16x16x32_bf16 a[8:11], v[76:79], v[44:47], a[8:11]
    v_mfma_f32_16x16x32_bf16 a[28:31], v[76:79], v[48:51], a[28:31]
    buffer_load_dwordx4 v[32:35], v252, s[8:11], s45 offen offset:2048
    v_mfma_f32_16x16x32_bf16 a[48:51], v[76:79], v[52:55], a[48:51]
    v_mfma_f32_16x16x32_bf16 a[68:71], v[76:79], v[56:59], a[68:71]
    v_mfma_f32_16x16x32_bf16 a[88:91], v[76:79], v[60:63], a[88:91]
    buffer_load_dwordx4 v[12:15], v252, s[4:7], s46 offen offset:2048
    v_mfma_f32_16x16x32_bf16 a[108:111], v[76:79], v[64:67], a[108:111]
    v_mfma_f32_16x16x32_bf16 a[12:15], v[80:83], v[44:47], a[12:15]
    v_mfma_f32_16x16x32_bf16 a[32:35], v[80:83], v[48:51], a[32:35]
    buffer_load_dwordx4 v[36:39], v252, s[8:11], s46 offen offset:2048
    v_mfma_f32_16x16x32_bf16 a[52:55], v[80:83], v[52:55], a[52:55]
    v_mfma_f32_16x16x32_bf16 a[72:75], v[80:83], v[56:59], a[72:75]
    buffer_load_dwordx4 v[16:19], v252, s[4:7], s47 offen offset:2048
    v_mfma_f32_16x16x32_bf16 a[92:95], v[80:83], v[60:63], a[92:95]
    v_mfma_f32_16x16x32_bf16 a[112:115], v[80:83], v[64:67], a[112:115]
    v_mfma_f32_16x16x32_bf16 a[16:19], v[84:87], v[44:47], a[16:19]
    buffer_load_dwordx4 v[40:43], v252, s[8:11], s47 offen offset:2048
    v_mfma_f32_16x16x32_bf16 a[36:39], v[84:87], v[48:51], a[36:39]
    v_mfma_f32_16x16x32_bf16 a[56:59], v[84:87], v[52:55], a[56:59]
    v_mfma_f32_16x16x32_bf16 a[76:79], v[84:87], v[56:59], a[76:79]
    buffer_load_dwordx4 v[20:23], v252, s[4:7], s48 offen offset:2048
    v_mfma_f32_16x16x32_bf16 a[96:99], v[84:87], v[60:63], a[96:99]
    v_mfma_f32_16x16x32_bf16 a[116:119], v[84:87], v[64:67], a[116:119]
    s_waitcnt vmcnt(11)
    v_mfma_f32_16x16x32_bf16 a[0:3], v[112:115], v[88:91], a[0:3]
    buffer_load_dwordx4 v[44:47], v252, s[4:7], 0 offen offset:3072
    v_mfma_f32_16x16x32_bf16 a[20:23], v[112:115], v[92:95], a[20:23]
    v_mfma_f32_16x16x32_bf16 a[40:43], v[112:115], v[96:99], a[40:43]
    buffer_load_dwordx4 v[68:71], v252, s[8:11], 0 offen offset:3072
    v_mfma_f32_16x16x32_bf16 a[60:63], v[112:115], v[100:103], a[60:63]
    v_mfma_f32_16x16x32_bf16 a[80:83], v[112:115], v[104:107], a[80:83]
    v_mfma_f32_16x16x32_bf16 a[100:103], v[112:115], v[108:111], a[100:103]
    buffer_load_dwordx4 v[48:51], v252, s[4:7], s44 offen offset:3072
    v_mfma_f32_16x16x32_bf16 a[4:7], v[116:119], v[88:91], a[4:7]
    v_mfma_f32_16x16x32_bf16 a[24:27], v[116:119], v[92:95], a[24:27]
    v_mfma_f32_16x16x32_bf16 a[44:47], v[116:119], v[96:99], a[44:47]
    buffer_load_dwordx4 v[72:75], v252, s[8:11], s44 offen offset:3072
    v_mfma_f32_16x16x32_bf16 a[64:67], v[116:119], v[100:103], a[64:67]
    v_mfma_f32_16x16x32_bf16 a[84:87], v[116:119], v[104:107], a[84:87]
    buffer_load_dwordx4 v[52:55], v252, s[4:7], s45 offen offset:3072
    v_mfma_f32_16x16x32_bf16 a[104:107], v[116:119], v[108:111], a[104:107]
    v_mfma_f32_16x16x32_bf16 a[8:11], v[120:123], v[88:91], a[8:11]
    v_mfma_f32_16x16x32_bf16 a[28:31], v[120:123], v[92:95], a[28:31]
    buffer_load_dwordx4 v[76:79], v252, s[8:11], s45 offen offset:3072
    v_mfma_f32_16x16x32_bf16 a[48:51], v[120:123], v[96:99], a[48:51]
    v_mfma_f32_16x16x32_bf16 a[68:71], v[120:123], v[100:103], a[68:71]
    v_mfma_f32_16x16x32_bf16 a[88:91], v[120:123], v[104:107], a[88:91]
    buffer_load_dwordx4 v[56:59], v252, s[4:7], s46 offen offset:3072
    v_mfma_f32_16x16x32_bf16 a[108:111], v[120:123], v[108:111], a[108:111]
    v_mfma_f32_16x16x32_bf16 a[12:15], v[124:127], v[88:91], a[12:15]
    v_mfma_f32_16x16x32_bf16 a[32:35], v[124:127], v[92:95], a[32:35]
    buffer_load_dwordx4 v[80:83], v252, s[8:11], s46 offen offset:3072
    v_mfma_f32_16x16x32_bf16 a[52:55], v[124:127], v[96:99], a[52:55]
    v_mfma_f32_16x16x32_bf16 a[72:75], v[124:127], v[100:103], a[72:75]
    buffer_load_dwordx4 v[60:63], v252, s[4:7], s47 offen offset:3072
    v_mfma_f32_16x16x32_bf16 a[92:95], v[124:127], v[104:107], a[92:95]
    v_mfma_f32_16x16x32_bf16 a[112:115], v[124:127], v[108:111], a[112:115]
    v_mfma_f32_16x16x32_bf16 a[16:19], v[128:131], v[88:91], a[16:19]
    buffer_load_dwordx4 v[84:87], v252, s[8:11], s47 offen offset:3072
    v_mfma_f32_16x16x32_bf16 a[36:39], v[128:131], v[92:95], a[36:39]
    v_mfma_f32_16x16x32_bf16 a[56:59], v[128:131], v[96:99], a[56:59]
    v_mfma_f32_16x16x32_bf16 a[76:79], v[128:131], v[100:103], a[76:79]
    buffer_load_dwordx4 v[64:67], v252, s[4:7], s48 offen offset:3072
    v_mfma_f32_16x16x32_bf16 a[96:99], v[128:131], v[104:107], a[96:99]
    v_mfma_f32_16x16x32_bf16 a[116:119], v[128:131], v[108:111], a[116:119]
    s_waitcnt vmcnt(11)
    v_mfma_f32_16x16x32_bf16 a[0:3], v[24:27], v[0:3], a[0:3]
    v_add_u32 v252, 4096, v252
    buffer_load_dwordx4 v[88:91], v252, s[4:7], 0 offen offset:0
    v_mfma_f32_16x16x32_bf16 a[20:23], v[24:27], v[4:7], a[20:23]
    v_mfma_f32_16x16x32_bf16 a[40:43], v[24:27], v[8:11], a[40:43]
    buffer_load_dwordx4 v[112:115], v252, s[8:11], 0 offen offset:0
    v_mfma_f32_16x16x32_bf16 a[60:63], v[24:27], v[12:15], a[60:63]
    v_mfma_f32_16x16x32_bf16 a[80:83], v[24:27], v[16:19], a[80:83]
    v_mfma_f32_16x16x32_bf16 a[100:103], v[24:27], v[20:23], a[100:103]
    buffer_load_dwordx4 v[92:95], v252, s[4:7], s44 offen offset:0
    v_mfma_f32_16x16x32_bf16 a[4:7], v[28:31], v[0:3], a[4:7]
    v_mfma_f32_16x16x32_bf16 a[24:27], v[28:31], v[4:7], a[24:27]
    v_mfma_f32_16x16x32_bf16 a[44:47], v[28:31], v[8:11], a[44:47]
    buffer_load_dwordx4 v[116:119], v252, s[8:11], s44 offen offset:0
    v_mfma_f32_16x16x32_bf16 a[64:67], v[28:31], v[12:15], a[64:67]
    v_mfma_f32_16x16x32_bf16 a[84:87], v[28:31], v[16:19], a[84:87]
    buffer_load_dwordx4 v[96:99], v252, s[4:7], s45 offen offset:0
    v_mfma_f32_16x16x32_bf16 a[104:107], v[28:31], v[20:23], a[104:107]
    v_mfma_f32_16x16x32_bf16 a[8:11], v[32:35], v[0:3], a[8:11]
    v_mfma_f32_16x16x32_bf16 a[28:31], v[32:35], v[4:7], a[28:31]
    buffer_load_dwordx4 v[120:123], v252, s[8:11], s45 offen offset:0
    v_mfma_f32_16x16x32_bf16 a[48:51], v[32:35], v[8:11], a[48:51]
    v_mfma_f32_16x16x32_bf16 a[68:71], v[32:35], v[12:15], a[68:71]
    v_mfma_f32_16x16x32_bf16 a[88:91], v[32:35], v[16:19], a[88:91]
    buffer_load_dwordx4 v[100:103], v252, s[4:7], s46 offen offset:0
    v_mfma_f32_16x16x32_bf16 a[108:111], v[32:35], v[20:23], a[108:111]
    v_mfma_f32_16x16x32_bf16 a[12:15], v[36:39], v[0:3], a[12:15]
    v_mfma_f32_16x16x32_bf16 a[32:35], v[36:39], v[4:7], a[32:35]
    buffer_load_dwordx4 v[124:127], v252, s[8:11], s46 offen offset:0
    v_mfma_f32_16x16x32_bf16 a[52:55], v[36:39], v[8:11], a[52:55]
    v_mfma_f32_16x16x32_bf16 a[72:75], v[36:39], v[12:15], a[72:75]
    buffer_load_dwordx4 v[104:107], v252, s[4:7], s47 offen offset:0
    v_mfma_f32_16x16x32_bf16 a[92:95], v[36:39], v[16:19], a[92:95]
    v_mfma_f32_16x16x32_bf16 a[112:115], v[36:39], v[20:23], a[112:115]
    v_mfma_f32_16x16x32_bf16 a[16:19], v[40:43], v[0:3], a[16:19]
    buffer_load_dwordx4 v[128:131], v252, s[8:11], s47 offen offset:0
    v_mfma_f32_16x16x32_bf16 a[36:39], v[40:43], v[4:7], a[36:39]
    v_mfma_f32_16x16x32_bf16 a[56:59], v[40:43], v[8:11], a[56:59]
    v_mfma_f32_16x16x32_bf16 a[76:79], v[40:43], v[12:15], a[76:79]
    buffer_load_dwordx4 v[108:111], v252, s[4:7], s48 offen offset:0
    v_mfma_f32_16x16x32_bf16 a[96:99], v[40:43], v[16:19], a[96:99]
    v_mfma_f32_16x16x32_bf16 a[116:119], v[40:43], v[20:23], a[116:119]
    s_waitcnt vmcnt(11)
    v_mfma_f32_16x16x32_bf16 a[0:3], v[68:71], v[44:47], a[0:3]
    buffer_load_dwordx4 v[0:3], v252, s[4:7], 0 offen offset:1024
    v_mfma_f32_16x16x32_bf16 a[20:23], v[68:71], v[48:51], a[20:23]
    v_mfma_f32_16x16x32_bf16 a[40:43], v[68:71], v[52:55], a[40:43]
    buffer_load_dwordx4 v[24:27], v252, s[8:11], 0 offen offset:1024
    v_mfma_f32_16x16x32_bf16 a[60:63], v[68:71], v[56:59], a[60:63]
    v_mfma_f32_16x16x32_bf16 a[80:83], v[68:71], v[60:63], a[80:83]
    v_mfma_f32_16x16x32_bf16 a[100:103], v[68:71], v[64:67], a[100:103]
    buffer_load_dwordx4 v[4:7], v252, s[4:7], s44 offen offset:1024
    v_mfma_f32_16x16x32_bf16 a[4:7], v[72:75], v[44:47], a[4:7]
    v_mfma_f32_16x16x32_bf16 a[24:27], v[72:75], v[48:51], a[24:27]
    v_mfma_f32_16x16x32_bf16 a[44:47], v[72:75], v[52:55], a[44:47]
    buffer_load_dwordx4 v[28:31], v252, s[8:11], s44 offen offset:1024
    v_mfma_f32_16x16x32_bf16 a[64:67], v[72:75], v[56:59], a[64:67]
    v_mfma_f32_16x16x32_bf16 a[84:87], v[72:75], v[60:63], a[84:87]
    buffer_load_dwordx4 v[8:11], v252, s[4:7], s45 offen offset:1024
    v_mfma_f32_16x16x32_bf16 a[104:107], v[72:75], v[64:67], a[104:107]
    v_mfma_f32_16x16x32_bf16 a[8:11], v[76:79], v[44:47], a[8:11]
    v_mfma_f32_16x16x32_bf16 a[28:31], v[76:79], v[48:51], a[28:31]
    buffer_load_dwordx4 v[32:35], v252, s[8:11], s45 offen offset:1024
    v_mfma_f32_16x16x32_bf16 a[48:51], v[76:79], v[52:55], a[48:51]
    v_mfma_f32_16x16x32_bf16 a[68:71], v[76:79], v[56:59], a[68:71]
    v_mfma_f32_16x16x32_bf16 a[88:91], v[76:79], v[60:63], a[88:91]
    buffer_load_dwordx4 v[12:15], v252, s[4:7], s46 offen offset:1024
    v_mfma_f32_16x16x32_bf16 a[108:111], v[76:79], v[64:67], a[108:111]
    v_mfma_f32_16x16x32_bf16 a[12:15], v[80:83], v[44:47], a[12:15]
    v_mfma_f32_16x16x32_bf16 a[32:35], v[80:83], v[48:51], a[32:35]
    buffer_load_dwordx4 v[36:39], v252, s[8:11], s46 offen offset:1024
    v_mfma_f32_16x16x32_bf16 a[52:55], v[80:83], v[52:55], a[52:55]
    v_mfma_f32_16x16x32_bf16 a[72:75], v[80:83], v[56:59], a[72:75]
    buffer_load_dwordx4 v[16:19], v252, s[4:7], s47 offen offset:1024
    v_mfma_f32_16x16x32_bf16 a[92:95], v[80:83], v[60:63], a[92:95]
    v_mfma_f32_16x16x32_bf16 a[112:115], v[80:83], v[64:67], a[112:115]
    v_mfma_f32_16x16x32_bf16 a[16:19], v[84:87], v[44:47], a[16:19]
    buffer_load_dwordx4 v[40:43], v252, s[8:11], s47 offen offset:1024
    v_mfma_f32_16x16x32_bf16 a[36:39], v[84:87], v[48:51], a[36:39]
    v_mfma_f32_16x16x32_bf16 a[56:59], v[84:87], v[52:55], a[56:59]
    v_mfma_f32_16x16x32_bf16 a[76:79], v[84:87], v[56:59], a[76:79]
    buffer_load_dwordx4 v[20:23], v252, s[4:7], s48 offen offset:1024
    v_mfma_f32_16x16x32_bf16 a[96:99], v[84:87], v[60:63], a[96:99]
    v_mfma_f32_16x16x32_bf16 a[116:119], v[84:87], v[64:67], a[116:119]
    s_waitcnt vmcnt(11)
    v_mfma_f32_16x16x32_bf16 a[0:3], v[112:115], v[88:91], a[0:3]
    buffer_load_dwordx4 v[44:47], v252, s[4:7], 0 offen offset:2048
    v_mfma_f32_16x16x32_bf16 a[20:23], v[112:115], v[92:95], a[20:23]
    v_mfma_f32_16x16x32_bf16 a[40:43], v[112:115], v[96:99], a[40:43]
    buffer_load_dwordx4 v[68:71], v252, s[8:11], 0 offen offset:2048
    v_mfma_f32_16x16x32_bf16 a[60:63], v[112:115], v[100:103], a[60:63]
    v_mfma_f32_16x16x32_bf16 a[80:83], v[112:115], v[104:107], a[80:83]
    v_mfma_f32_16x16x32_bf16 a[100:103], v[112:115], v[108:111], a[100:103]
    buffer_load_dwordx4 v[48:51], v252, s[4:7], s44 offen offset:2048
    v_mfma_f32_16x16x32_bf16 a[4:7], v[116:119], v[88:91], a[4:7]
    v_mfma_f32_16x16x32_bf16 a[24:27], v[116:119], v[92:95], a[24:27]
    v_mfma_f32_16x16x32_bf16 a[44:47], v[116:119], v[96:99], a[44:47]
    buffer_load_dwordx4 v[72:75], v252, s[8:11], s44 offen offset:2048
    v_mfma_f32_16x16x32_bf16 a[64:67], v[116:119], v[100:103], a[64:67]
    v_mfma_f32_16x16x32_bf16 a[84:87], v[116:119], v[104:107], a[84:87]
    buffer_load_dwordx4 v[52:55], v252, s[4:7], s45 offen offset:2048
    v_mfma_f32_16x16x32_bf16 a[104:107], v[116:119], v[108:111], a[104:107]
    v_mfma_f32_16x16x32_bf16 a[8:11], v[120:123], v[88:91], a[8:11]
    v_mfma_f32_16x16x32_bf16 a[28:31], v[120:123], v[92:95], a[28:31]
    buffer_load_dwordx4 v[76:79], v252, s[8:11], s45 offen offset:2048
    v_mfma_f32_16x16x32_bf16 a[48:51], v[120:123], v[96:99], a[48:51]
    v_mfma_f32_16x16x32_bf16 a[68:71], v[120:123], v[100:103], a[68:71]
    v_mfma_f32_16x16x32_bf16 a[88:91], v[120:123], v[104:107], a[88:91]
    buffer_load_dwordx4 v[56:59], v252, s[4:7], s46 offen offset:2048
    v_mfma_f32_16x16x32_bf16 a[108:111], v[120:123], v[108:111], a[108:111]
    v_mfma_f32_16x16x32_bf16 a[12:15], v[124:127], v[88:91], a[12:15]
    v_mfma_f32_16x16x32_bf16 a[32:35], v[124:127], v[92:95], a[32:35]
    buffer_load_dwordx4 v[80:83], v252, s[8:11], s46 offen offset:2048
    v_mfma_f32_16x16x32_bf16 a[52:55], v[124:127], v[96:99], a[52:55]
    v_mfma_f32_16x16x32_bf16 a[72:75], v[124:127], v[100:103], a[72:75]
    buffer_load_dwordx4 v[60:63], v252, s[4:7], s47 offen offset:2048
    v_mfma_f32_16x16x32_bf16 a[92:95], v[124:127], v[104:107], a[92:95]
    v_mfma_f32_16x16x32_bf16 a[112:115], v[124:127], v[108:111], a[112:115]
    v_mfma_f32_16x16x32_bf16 a[16:19], v[128:131], v[88:91], a[16:19]
    buffer_load_dwordx4 v[84:87], v252, s[8:11], s47 offen offset:2048
    v_mfma_f32_16x16x32_bf16 a[36:39], v[128:131], v[92:95], a[36:39]
    v_mfma_f32_16x16x32_bf16 a[56:59], v[128:131], v[96:99], a[56:59]
    v_mfma_f32_16x16x32_bf16 a[76:79], v[128:131], v[100:103], a[76:79]
    buffer_load_dwordx4 v[64:67], v252, s[4:7], s48 offen offset:2048
    v_mfma_f32_16x16x32_bf16 a[96:99], v[128:131], v[104:107], a[96:99]
    v_mfma_f32_16x16x32_bf16 a[116:119], v[128:131], v[108:111], a[116:119]
    s_waitcnt vmcnt(11)
    v_mfma_f32_16x16x32_bf16 a[0:3], v[24:27], v[0:3], a[0:3]
    buffer_load_dwordx4 v[88:91], v252, s[4:7], 0 offen offset:3072
    v_mfma_f32_16x16x32_bf16 a[20:23], v[24:27], v[4:7], a[20:23]
    v_mfma_f32_16x16x32_bf16 a[40:43], v[24:27], v[8:11], a[40:43]
    buffer_load_dwordx4 v[112:115], v252, s[8:11], 0 offen offset:3072
    v_mfma_f32_16x16x32_bf16 a[60:63], v[24:27], v[12:15], a[60:63]
    v_mfma_f32_16x16x32_bf16 a[80:83], v[24:27], v[16:19], a[80:83]
    v_mfma_f32_16x16x32_bf16 a[100:103], v[24:27], v[20:23], a[100:103]
    buffer_load_dwordx4 v[92:95], v252, s[4:7], s44 offen offset:3072
    v_mfma_f32_16x16x32_bf16 a[4:7], v[28:31], v[0:3], a[4:7]
    v_mfma_f32_16x16x32_bf16 a[24:27], v[28:31], v[4:7], a[24:27]
    v_mfma_f32_16x16x32_bf16 a[44:47], v[28:31], v[8:11], a[44:47]
    buffer_load_dwordx4 v[116:119], v252, s[8:11], s44 offen offset:3072
    v_mfma_f32_16x16x32_bf16 a[64:67], v[28:31], v[12:15], a[64:67]
    v_mfma_f32_16x16x32_bf16 a[84:87], v[28:31], v[16:19], a[84:87]
    buffer_load_dwordx4 v[96:99], v252, s[4:7], s45 offen offset:3072
    v_mfma_f32_16x16x32_bf16 a[104:107], v[28:31], v[20:23], a[104:107]
    v_mfma_f32_16x16x32_bf16 a[8:11], v[32:35], v[0:3], a[8:11]
    v_mfma_f32_16x16x32_bf16 a[28:31], v[32:35], v[4:7], a[28:31]
    buffer_load_dwordx4 v[120:123], v252, s[8:11], s45 offen offset:3072
    v_mfma_f32_16x16x32_bf16 a[48:51], v[32:35], v[8:11], a[48:51]
    v_mfma_f32_16x16x32_bf16 a[68:71], v[32:35], v[12:15], a[68:71]
    v_mfma_f32_16x16x32_bf16 a[88:91], v[32:35], v[16:19], a[88:91]
    buffer_load_dwordx4 v[100:103], v252, s[4:7], s46 offen offset:3072
    v_mfma_f32_16x16x32_bf16 a[108:111], v[32:35], v[20:23], a[108:111]
    v_mfma_f32_16x16x32_bf16 a[12:15], v[36:39], v[0:3], a[12:15]
    v_mfma_f32_16x16x32_bf16 a[32:35], v[36:39], v[4:7], a[32:35]
    buffer_load_dwordx4 v[124:127], v252, s[8:11], s46 offen offset:3072
    v_mfma_f32_16x16x32_bf16 a[52:55], v[36:39], v[8:11], a[52:55]
    v_mfma_f32_16x16x32_bf16 a[72:75], v[36:39], v[12:15], a[72:75]
    buffer_load_dwordx4 v[104:107], v252, s[4:7], s47 offen offset:3072
    v_mfma_f32_16x16x32_bf16 a[92:95], v[36:39], v[16:19], a[92:95]
    v_mfma_f32_16x16x32_bf16 a[112:115], v[36:39], v[20:23], a[112:115]
    v_mfma_f32_16x16x32_bf16 a[16:19], v[40:43], v[0:3], a[16:19]
    buffer_load_dwordx4 v[128:131], v252, s[8:11], s47 offen offset:3072
    v_mfma_f32_16x16x32_bf16 a[36:39], v[40:43], v[4:7], a[36:39]
    v_mfma_f32_16x16x32_bf16 a[56:59], v[40:43], v[8:11], a[56:59]
    v_mfma_f32_16x16x32_bf16 a[76:79], v[40:43], v[12:15], a[76:79]
    buffer_load_dwordx4 v[108:111], v252, s[4:7], s48 offen offset:3072
    v_mfma_f32_16x16x32_bf16 a[96:99], v[40:43], v[16:19], a[96:99]
    v_mfma_f32_16x16x32_bf16 a[116:119], v[40:43], v[20:23], a[116:119]
    s_waitcnt vmcnt(11)
    v_mfma_f32_16x16x32_bf16 a[0:3], v[68:71], v[44:47], a[0:3]
    v_add_u32 v252, 4096, v252
    buffer_load_dwordx4 v[0:3], v252, s[4:7], 0 offen offset:0
    v_mfma_f32_16x16x32_bf16 a[20:23], v[68:71], v[48:51], a[20:23]
    v_mfma_f32_16x16x32_bf16 a[40:43], v[68:71], v[52:55], a[40:43]
    buffer_load_dwordx4 v[24:27], v252, s[8:11], 0 offen offset:0
    v_mfma_f32_16x16x32_bf16 a[60:63], v[68:71], v[56:59], a[60:63]
    v_mfma_f32_16x16x32_bf16 a[80:83], v[68:71], v[60:63], a[80:83]
    v_mfma_f32_16x16x32_bf16 a[100:103], v[68:71], v[64:67], a[100:103]
    buffer_load_dwordx4 v[4:7], v252, s[4:7], s44 offen offset:0
    v_mfma_f32_16x16x32_bf16 a[4:7], v[72:75], v[44:47], a[4:7]
    v_mfma_f32_16x16x32_bf16 a[24:27], v[72:75], v[48:51], a[24:27]
    v_mfma_f32_16x16x32_bf16 a[44:47], v[72:75], v[52:55], a[44:47]
    buffer_load_dwordx4 v[28:31], v252, s[8:11], s44 offen offset:0
    v_mfma_f32_16x16x32_bf16 a[64:67], v[72:75], v[56:59], a[64:67]
    v_mfma_f32_16x16x32_bf16 a[84:87], v[72:75], v[60:63], a[84:87]
    buffer_load_dwordx4 v[8:11], v252, s[4:7], s45 offen offset:0
    v_mfma_f32_16x16x32_bf16 a[104:107], v[72:75], v[64:67], a[104:107]
    v_mfma_f32_16x16x32_bf16 a[8:11], v[76:79], v[44:47], a[8:11]
    v_mfma_f32_16x16x32_bf16 a[28:31], v[76:79], v[48:51], a[28:31]
    buffer_load_dwordx4 v[32:35], v252, s[8:11], s45 offen offset:0
    v_mfma_f32_16x16x32_bf16 a[48:51], v[76:79], v[52:55], a[48:51]
    v_mfma_f32_16x16x32_bf16 a[68:71], v[76:79], v[56:59], a[68:71]
    v_mfma_f32_16x16x32_bf16 a[88:91], v[76:79], v[60:63], a[88:91]
    buffer_load_dwordx4 v[12:15], v252, s[4:7], s46 offen offset:0
    v_mfma_f32_16x16x32_bf16 a[108:111], v[76:79], v[64:67], a[108:111]
    v_mfma_f32_16x16x32_bf16 a[12:15], v[80:83], v[44:47], a[12:15]
    v_mfma_f32_16x16x32_bf16 a[32:35], v[80:83], v[48:51], a[32:35]
    buffer_load_dwordx4 v[36:39], v252, s[8:11], s46 offen offset:0
    v_mfma_f32_16x16x32_bf16 a[52:55], v[80:83], v[52:55], a[52:55]
    v_mfma_f32_16x16x32_bf16 a[72:75], v[80:83], v[56:59], a[72:75]
    buffer_load_dwordx4 v[16:19], v252, s[4:7], s47 offen offset:0
    v_mfma_f32_16x16x32_bf16 a[92:95], v[80:83], v[60:63], a[92:95]
    v_mfma_f32_16x16x32_bf16 a[112:115], v[80:83], v[64:67], a[112:115]
    v_mfma_f32_16x16x32_bf16 a[16:19], v[84:87], v[44:47], a[16:19]
    buffer_load_dwordx4 v[40:43], v252, s[8:11], s47 offen offset:0
    v_mfma_f32_16x16x32_bf16 a[36:39], v[84:87], v[48:51], a[36:39]
    v_mfma_f32_16x16x32_bf16 a[56:59], v[84:87], v[52:55], a[56:59]
    v_mfma_f32_16x16x32_bf16 a[76:79], v[84:87], v[56:59], a[76:79]
    buffer_load_dwordx4 v[20:23], v252, s[4:7], s48 offen offset:0
    v_mfma_f32_16x16x32_bf16 a[96:99], v[84:87], v[60:63], a[96:99]
    v_mfma_f32_16x16x32_bf16 a[116:119], v[84:87], v[64:67], a[116:119]
    s_waitcnt vmcnt(11)
    v_mfma_f32_16x16x32_bf16 a[0:3], v[112:115], v[88:91], a[0:3]
    buffer_load_dwordx4 v[44:47], v252, s[4:7], 0 offen offset:1024
    v_mfma_f32_16x16x32_bf16 a[20:23], v[112:115], v[92:95], a[20:23]
    v_mfma_f32_16x16x32_bf16 a[40:43], v[112:115], v[96:99], a[40:43]
    buffer_load_dwordx4 v[68:71], v252, s[8:11], 0 offen offset:1024
    v_mfma_f32_16x16x32_bf16 a[60:63], v[112:115], v[100:103], a[60:63]
    v_mfma_f32_16x16x32_bf16 a[80:83], v[112:115], v[104:107], a[80:83]
    v_mfma_f32_16x16x32_bf16 a[100:103], v[112:115], v[108:111], a[100:103]
    buffer_load_dwordx4 v[48:51], v252, s[4:7], s44 offen offset:1024
    v_mfma_f32_16x16x32_bf16 a[4:7], v[116:119], v[88:91], a[4:7]
    v_mfma_f32_16x16x32_bf16 a[24:27], v[116:119], v[92:95], a[24:27]
    v_mfma_f32_16x16x32_bf16 a[44:47], v[116:119], v[96:99], a[44:47]
    buffer_load_dwordx4 v[72:75], v252, s[8:11], s44 offen offset:1024
    v_mfma_f32_16x16x32_bf16 a[64:67], v[116:119], v[100:103], a[64:67]
    v_mfma_f32_16x16x32_bf16 a[84:87], v[116:119], v[104:107], a[84:87]
    buffer_load_dwordx4 v[52:55], v252, s[4:7], s45 offen offset:1024
    v_mfma_f32_16x16x32_bf16 a[104:107], v[116:119], v[108:111], a[104:107]
    v_mfma_f32_16x16x32_bf16 a[8:11], v[120:123], v[88:91], a[8:11]
    v_mfma_f32_16x16x32_bf16 a[28:31], v[120:123], v[92:95], a[28:31]
    buffer_load_dwordx4 v[76:79], v252, s[8:11], s45 offen offset:1024
    v_mfma_f32_16x16x32_bf16 a[48:51], v[120:123], v[96:99], a[48:51]
    v_mfma_f32_16x16x32_bf16 a[68:71], v[120:123], v[100:103], a[68:71]
    v_mfma_f32_16x16x32_bf16 a[88:91], v[120:123], v[104:107], a[88:91]
    buffer_load_dwordx4 v[56:59], v252, s[4:7], s46 offen offset:1024
    v_mfma_f32_16x16x32_bf16 a[108:111], v[120:123], v[108:111], a[108:111]
    v_mfma_f32_16x16x32_bf16 a[12:15], v[124:127], v[88:91], a[12:15]
    v_mfma_f32_16x16x32_bf16 a[32:35], v[124:127], v[92:95], a[32:35]
    buffer_load_dwordx4 v[80:83], v252, s[8:11], s46 offen offset:1024
    v_mfma_f32_16x16x32_bf16 a[52:55], v[124:127], v[96:99], a[52:55]
    v_mfma_f32_16x16x32_bf16 a[72:75], v[124:127], v[100:103], a[72:75]
    buffer_load_dwordx4 v[60:63], v252, s[4:7], s47 offen offset:1024
    v_mfma_f32_16x16x32_bf16 a[92:95], v[124:127], v[104:107], a[92:95]
    v_mfma_f32_16x16x32_bf16 a[112:115], v[124:127], v[108:111], a[112:115]
    v_mfma_f32_16x16x32_bf16 a[16:19], v[128:131], v[88:91], a[16:19]
    buffer_load_dwordx4 v[84:87], v252, s[8:11], s47 offen offset:1024
    v_mfma_f32_16x16x32_bf16 a[36:39], v[128:131], v[92:95], a[36:39]
    v_mfma_f32_16x16x32_bf16 a[56:59], v[128:131], v[96:99], a[56:59]
    v_mfma_f32_16x16x32_bf16 a[76:79], v[128:131], v[100:103], a[76:79]
    buffer_load_dwordx4 v[64:67], v252, s[4:7], s48 offen offset:1024
    v_mfma_f32_16x16x32_bf16 a[96:99], v[128:131], v[104:107], a[96:99]
    v_mfma_f32_16x16x32_bf16 a[116:119], v[128:131], v[108:111], a[116:119]
    s_waitcnt vmcnt(11)
    v_mfma_f32_16x16x32_bf16 a[0:3], v[24:27], v[0:3], a[0:3]
    buffer_load_dwordx4 v[88:91], v252, s[4:7], 0 offen offset:2048
    v_mfma_f32_16x16x32_bf16 a[20:23], v[24:27], v[4:7], a[20:23]
    v_mfma_f32_16x16x32_bf16 a[40:43], v[24:27], v[8:11], a[40:43]
    buffer_load_dwordx4 v[112:115], v252, s[8:11], 0 offen offset:2048
    v_mfma_f32_16x16x32_bf16 a[60:63], v[24:27], v[12:15], a[60:63]
    v_mfma_f32_16x16x32_bf16 a[80:83], v[24:27], v[16:19], a[80:83]
    v_mfma_f32_16x16x32_bf16 a[100:103], v[24:27], v[20:23], a[100:103]
    buffer_load_dwordx4 v[92:95], v252, s[4:7], s44 offen offset:2048
    v_mfma_f32_16x16x32_bf16 a[4:7], v[28:31], v[0:3], a[4:7]
    v_mfma_f32_16x16x32_bf16 a[24:27], v[28:31], v[4:7], a[24:27]
    v_mfma_f32_16x16x32_bf16 a[44:47], v[28:31], v[8:11], a[44:47]
    buffer_load_dwordx4 v[116:119], v252, s[8:11], s44 offen offset:2048
    v_mfma_f32_16x16x32_bf16 a[64:67], v[28:31], v[12:15], a[64:67]
    v_mfma_f32_16x16x32_bf16 a[84:87], v[28:31], v[16:19], a[84:87]
    buffer_load_dwordx4 v[96:99], v252, s[4:7], s45 offen offset:2048
    v_mfma_f32_16x16x32_bf16 a[104:107], v[28:31], v[20:23], a[104:107]
    v_mfma_f32_16x16x32_bf16 a[8:11], v[32:35], v[0:3], a[8:11]
    v_mfma_f32_16x16x32_bf16 a[28:31], v[32:35], v[4:7], a[28:31]
    buffer_load_dwordx4 v[120:123], v252, s[8:11], s45 offen offset:2048
    v_mfma_f32_16x16x32_bf16 a[48:51], v[32:35], v[8:11], a[48:51]
    v_mfma_f32_16x16x32_bf16 a[68:71], v[32:35], v[12:15], a[68:71]
    v_mfma_f32_16x16x32_bf16 a[88:91], v[32:35], v[16:19], a[88:91]
    buffer_load_dwordx4 v[100:103], v252, s[4:7], s46 offen offset:2048
    v_mfma_f32_16x16x32_bf16 a[108:111], v[32:35], v[20:23], a[108:111]
    v_mfma_f32_16x16x32_bf16 a[12:15], v[36:39], v[0:3], a[12:15]
    v_mfma_f32_16x16x32_bf16 a[32:35], v[36:39], v[4:7], a[32:35]
    buffer_load_dwordx4 v[124:127], v252, s[8:11], s46 offen offset:2048
    v_mfma_f32_16x16x32_bf16 a[52:55], v[36:39], v[8:11], a[52:55]
    v_mfma_f32_16x16x32_bf16 a[72:75], v[36:39], v[12:15], a[72:75]
    buffer_load_dwordx4 v[104:107], v252, s[4:7], s47 offen offset:2048
    v_mfma_f32_16x16x32_bf16 a[92:95], v[36:39], v[16:19], a[92:95]
    v_mfma_f32_16x16x32_bf16 a[112:115], v[36:39], v[20:23], a[112:115]
    v_mfma_f32_16x16x32_bf16 a[16:19], v[40:43], v[0:3], a[16:19]
    buffer_load_dwordx4 v[128:131], v252, s[8:11], s47 offen offset:2048
    v_mfma_f32_16x16x32_bf16 a[36:39], v[40:43], v[4:7], a[36:39]
    v_mfma_f32_16x16x32_bf16 a[56:59], v[40:43], v[8:11], a[56:59]
    v_mfma_f32_16x16x32_bf16 a[76:79], v[40:43], v[12:15], a[76:79]
    buffer_load_dwordx4 v[108:111], v252, s[4:7], s48 offen offset:2048
    v_mfma_f32_16x16x32_bf16 a[96:99], v[40:43], v[16:19], a[96:99]
    v_mfma_f32_16x16x32_bf16 a[116:119], v[40:43], v[20:23], a[116:119]
    s_waitcnt vmcnt(11)
    v_mfma_f32_16x16x32_bf16 a[0:3], v[68:71], v[44:47], a[0:3]
    buffer_load_dwordx4 v[0:3], v252, s[4:7], 0 offen offset:3072
    v_mfma_f32_16x16x32_bf16 a[20:23], v[68:71], v[48:51], a[20:23]
    v_mfma_f32_16x16x32_bf16 a[40:43], v[68:71], v[52:55], a[40:43]
    buffer_load_dwordx4 v[24:27], v252, s[8:11], 0 offen offset:3072
    v_mfma_f32_16x16x32_bf16 a[60:63], v[68:71], v[56:59], a[60:63]
    v_mfma_f32_16x16x32_bf16 a[80:83], v[68:71], v[60:63], a[80:83]
    v_mfma_f32_16x16x32_bf16 a[100:103], v[68:71], v[64:67], a[100:103]
    buffer_load_dwordx4 v[4:7], v252, s[4:7], s44 offen offset:3072
    v_mfma_f32_16x16x32_bf16 a[4:7], v[72:75], v[44:47], a[4:7]
    v_mfma_f32_16x16x32_bf16 a[24:27], v[72:75], v[48:51], a[24:27]
    v_mfma_f32_16x16x32_bf16 a[44:47], v[72:75], v[52:55], a[44:47]
    buffer_load_dwordx4 v[28:31], v252, s[8:11], s44 offen offset:3072
    v_mfma_f32_16x16x32_bf16 a[64:67], v[72:75], v[56:59], a[64:67]
    v_mfma_f32_16x16x32_bf16 a[84:87], v[72:75], v[60:63], a[84:87]
    buffer_load_dwordx4 v[8:11], v252, s[4:7], s45 offen offset:3072
    v_mfma_f32_16x16x32_bf16 a[104:107], v[72:75], v[64:67], a[104:107]
    v_mfma_f32_16x16x32_bf16 a[8:11], v[76:79], v[44:47], a[8:11]
    v_mfma_f32_16x16x32_bf16 a[28:31], v[76:79], v[48:51], a[28:31]
    buffer_load_dwordx4 v[32:35], v252, s[8:11], s45 offen offset:3072
    v_mfma_f32_16x16x32_bf16 a[48:51], v[76:79], v[52:55], a[48:51]
    v_mfma_f32_16x16x32_bf16 a[68:71], v[76:79], v[56:59], a[68:71]
    v_mfma_f32_16x16x32_bf16 a[88:91], v[76:79], v[60:63], a[88:91]
    buffer_load_dwordx4 v[12:15], v252, s[4:7], s46 offen offset:3072
    v_mfma_f32_16x16x32_bf16 a[108:111], v[76:79], v[64:67], a[108:111]
    v_mfma_f32_16x16x32_bf16 a[12:15], v[80:83], v[44:47], a[12:15]
    v_mfma_f32_16x16x32_bf16 a[32:35], v[80:83], v[48:51], a[32:35]
    buffer_load_dwordx4 v[36:39], v252, s[8:11], s46 offen offset:3072
    v_mfma_f32_16x16x32_bf16 a[52:55], v[80:83], v[52:55], a[52:55]
    v_mfma_f32_16x16x32_bf16 a[72:75], v[80:83], v[56:59], a[72:75]
    buffer_load_dwordx4 v[16:19], v252, s[4:7], s47 offen offset:3072
    v_mfma_f32_16x16x32_bf16 a[92:95], v[80:83], v[60:63], a[92:95]
    v_mfma_f32_16x16x32_bf16 a[112:115], v[80:83], v[64:67], a[112:115]
    v_mfma_f32_16x16x32_bf16 a[16:19], v[84:87], v[44:47], a[16:19]
    buffer_load_dwordx4 v[40:43], v252, s[8:11], s47 offen offset:3072
    v_mfma_f32_16x16x32_bf16 a[36:39], v[84:87], v[48:51], a[36:39]
    v_mfma_f32_16x16x32_bf16 a[56:59], v[84:87], v[52:55], a[56:59]
    v_mfma_f32_16x16x32_bf16 a[76:79], v[84:87], v[56:59], a[76:79]
    buffer_load_dwordx4 v[20:23], v252, s[4:7], s48 offen offset:3072
    v_mfma_f32_16x16x32_bf16 a[96:99], v[84:87], v[60:63], a[96:99]
    v_mfma_f32_16x16x32_bf16 a[116:119], v[84:87], v[64:67], a[116:119]
    s_waitcnt vmcnt(11)
    v_mfma_f32_16x16x32_bf16 a[0:3], v[112:115], v[88:91], a[0:3]
    v_add_u32 v252, 4096, v252
    buffer_load_dwordx4 v[44:47], v252, s[4:7], 0 offen offset:0
    v_mfma_f32_16x16x32_bf16 a[20:23], v[112:115], v[92:95], a[20:23]
    v_mfma_f32_16x16x32_bf16 a[40:43], v[112:115], v[96:99], a[40:43]
    buffer_load_dwordx4 v[68:71], v252, s[8:11], 0 offen offset:0
    v_mfma_f32_16x16x32_bf16 a[60:63], v[112:115], v[100:103], a[60:63]
    v_mfma_f32_16x16x32_bf16 a[80:83], v[112:115], v[104:107], a[80:83]
    v_mfma_f32_16x16x32_bf16 a[100:103], v[112:115], v[108:111], a[100:103]
    buffer_load_dwordx4 v[48:51], v252, s[4:7], s44 offen offset:0
    v_mfma_f32_16x16x32_bf16 a[4:7], v[116:119], v[88:91], a[4:7]
    v_mfma_f32_16x16x32_bf16 a[24:27], v[116:119], v[92:95], a[24:27]
    v_mfma_f32_16x16x32_bf16 a[44:47], v[116:119], v[96:99], a[44:47]
    buffer_load_dwordx4 v[72:75], v252, s[8:11], s44 offen offset:0
    v_mfma_f32_16x16x32_bf16 a[64:67], v[116:119], v[100:103], a[64:67]
    v_mfma_f32_16x16x32_bf16 a[84:87], v[116:119], v[104:107], a[84:87]
    buffer_load_dwordx4 v[52:55], v252, s[4:7], s45 offen offset:0
    v_mfma_f32_16x16x32_bf16 a[104:107], v[116:119], v[108:111], a[104:107]
    v_mfma_f32_16x16x32_bf16 a[8:11], v[120:123], v[88:91], a[8:11]
    v_mfma_f32_16x16x32_bf16 a[28:31], v[120:123], v[92:95], a[28:31]
    buffer_load_dwordx4 v[76:79], v252, s[8:11], s45 offen offset:0
    v_mfma_f32_16x16x32_bf16 a[48:51], v[120:123], v[96:99], a[48:51]
    v_mfma_f32_16x16x32_bf16 a[68:71], v[120:123], v[100:103], a[68:71]
    v_mfma_f32_16x16x32_bf16 a[88:91], v[120:123], v[104:107], a[88:91]
    buffer_load_dwordx4 v[56:59], v252, s[4:7], s46 offen offset:0
    v_mfma_f32_16x16x32_bf16 a[108:111], v[120:123], v[108:111], a[108:111]
    v_mfma_f32_16x16x32_bf16 a[12:15], v[124:127], v[88:91], a[12:15]
    v_mfma_f32_16x16x32_bf16 a[32:35], v[124:127], v[92:95], a[32:35]
    buffer_load_dwordx4 v[80:83], v252, s[8:11], s46 offen offset:0
    v_mfma_f32_16x16x32_bf16 a[52:55], v[124:127], v[96:99], a[52:55]
    v_mfma_f32_16x16x32_bf16 a[72:75], v[124:127], v[100:103], a[72:75]
    buffer_load_dwordx4 v[60:63], v252, s[4:7], s47 offen offset:0
    v_mfma_f32_16x16x32_bf16 a[92:95], v[124:127], v[104:107], a[92:95]
    v_mfma_f32_16x16x32_bf16 a[112:115], v[124:127], v[108:111], a[112:115]
    v_mfma_f32_16x16x32_bf16 a[16:19], v[128:131], v[88:91], a[16:19]
    buffer_load_dwordx4 v[84:87], v252, s[8:11], s47 offen offset:0
    v_mfma_f32_16x16x32_bf16 a[36:39], v[128:131], v[92:95], a[36:39]
    v_mfma_f32_16x16x32_bf16 a[56:59], v[128:131], v[96:99], a[56:59]
    v_mfma_f32_16x16x32_bf16 a[76:79], v[128:131], v[100:103], a[76:79]
    buffer_load_dwordx4 v[64:67], v252, s[4:7], s48 offen offset:0
    v_mfma_f32_16x16x32_bf16 a[96:99], v[128:131], v[104:107], a[96:99]
    v_mfma_f32_16x16x32_bf16 a[116:119], v[128:131], v[108:111], a[116:119]
    s_waitcnt vmcnt(11)
    v_mfma_f32_16x16x32_bf16 a[0:3], v[24:27], v[0:3], a[0:3]
    buffer_load_dwordx4 v[88:91], v252, s[4:7], 0 offen offset:1024
    v_mfma_f32_16x16x32_bf16 a[20:23], v[24:27], v[4:7], a[20:23]
    v_mfma_f32_16x16x32_bf16 a[40:43], v[24:27], v[8:11], a[40:43]
    buffer_load_dwordx4 v[112:115], v252, s[8:11], 0 offen offset:1024
    v_mfma_f32_16x16x32_bf16 a[60:63], v[24:27], v[12:15], a[60:63]
    v_mfma_f32_16x16x32_bf16 a[80:83], v[24:27], v[16:19], a[80:83]
    v_mfma_f32_16x16x32_bf16 a[100:103], v[24:27], v[20:23], a[100:103]
    buffer_load_dwordx4 v[92:95], v252, s[4:7], s44 offen offset:1024
    v_mfma_f32_16x16x32_bf16 a[4:7], v[28:31], v[0:3], a[4:7]
    v_mfma_f32_16x16x32_bf16 a[24:27], v[28:31], v[4:7], a[24:27]
    v_mfma_f32_16x16x32_bf16 a[44:47], v[28:31], v[8:11], a[44:47]
    buffer_load_dwordx4 v[116:119], v252, s[8:11], s44 offen offset:1024
    v_mfma_f32_16x16x32_bf16 a[64:67], v[28:31], v[12:15], a[64:67]
    v_mfma_f32_16x16x32_bf16 a[84:87], v[28:31], v[16:19], a[84:87]
    buffer_load_dwordx4 v[96:99], v252, s[4:7], s45 offen offset:1024
    v_mfma_f32_16x16x32_bf16 a[104:107], v[28:31], v[20:23], a[104:107]
    v_mfma_f32_16x16x32_bf16 a[8:11], v[32:35], v[0:3], a[8:11]
    v_mfma_f32_16x16x32_bf16 a[28:31], v[32:35], v[4:7], a[28:31]
    buffer_load_dwordx4 v[120:123], v252, s[8:11], s45 offen offset:1024
    v_mfma_f32_16x16x32_bf16 a[48:51], v[32:35], v[8:11], a[48:51]
    v_mfma_f32_16x16x32_bf16 a[68:71], v[32:35], v[12:15], a[68:71]
    v_mfma_f32_16x16x32_bf16 a[88:91], v[32:35], v[16:19], a[88:91]
    buffer_load_dwordx4 v[100:103], v252, s[4:7], s46 offen offset:1024
    v_mfma_f32_16x16x32_bf16 a[108:111], v[32:35], v[20:23], a[108:111]
    v_mfma_f32_16x16x32_bf16 a[12:15], v[36:39], v[0:3], a[12:15]
    v_mfma_f32_16x16x32_bf16 a[32:35], v[36:39], v[4:7], a[32:35]
    buffer_load_dwordx4 v[124:127], v252, s[8:11], s46 offen offset:1024
    v_mfma_f32_16x16x32_bf16 a[52:55], v[36:39], v[8:11], a[52:55]
    v_mfma_f32_16x16x32_bf16 a[72:75], v[36:39], v[12:15], a[72:75]
    buffer_load_dwordx4 v[104:107], v252, s[4:7], s47 offen offset:1024
    v_mfma_f32_16x16x32_bf16 a[92:95], v[36:39], v[16:19], a[92:95]
    v_mfma_f32_16x16x32_bf16 a[112:115], v[36:39], v[20:23], a[112:115]
    v_mfma_f32_16x16x32_bf16 a[16:19], v[40:43], v[0:3], a[16:19]
    buffer_load_dwordx4 v[128:131], v252, s[8:11], s47 offen offset:1024
    v_mfma_f32_16x16x32_bf16 a[36:39], v[40:43], v[4:7], a[36:39]
    v_mfma_f32_16x16x32_bf16 a[56:59], v[40:43], v[8:11], a[56:59]
    v_mfma_f32_16x16x32_bf16 a[76:79], v[40:43], v[12:15], a[76:79]
    buffer_load_dwordx4 v[108:111], v252, s[4:7], s48 offen offset:1024
    v_mfma_f32_16x16x32_bf16 a[96:99], v[40:43], v[16:19], a[96:99]
    v_mfma_f32_16x16x32_bf16 a[116:119], v[40:43], v[20:23], a[116:119]
    s_waitcnt vmcnt(11)
    v_mfma_f32_16x16x32_bf16 a[0:3], v[68:71], v[44:47], a[0:3]
    buffer_load_dwordx4 v[0:3], v252, s[4:7], 0 offen offset:2048
    v_mfma_f32_16x16x32_bf16 a[20:23], v[68:71], v[48:51], a[20:23]
    v_mfma_f32_16x16x32_bf16 a[40:43], v[68:71], v[52:55], a[40:43]
    buffer_load_dwordx4 v[24:27], v252, s[8:11], 0 offen offset:2048
    v_mfma_f32_16x16x32_bf16 a[60:63], v[68:71], v[56:59], a[60:63]
    v_mfma_f32_16x16x32_bf16 a[80:83], v[68:71], v[60:63], a[80:83]
    v_mfma_f32_16x16x32_bf16 a[100:103], v[68:71], v[64:67], a[100:103]
    buffer_load_dwordx4 v[4:7], v252, s[4:7], s44 offen offset:2048
    v_mfma_f32_16x16x32_bf16 a[4:7], v[72:75], v[44:47], a[4:7]
    v_mfma_f32_16x16x32_bf16 a[24:27], v[72:75], v[48:51], a[24:27]
    v_mfma_f32_16x16x32_bf16 a[44:47], v[72:75], v[52:55], a[44:47]
    buffer_load_dwordx4 v[28:31], v252, s[8:11], s44 offen offset:2048
    v_mfma_f32_16x16x32_bf16 a[64:67], v[72:75], v[56:59], a[64:67]
    v_mfma_f32_16x16x32_bf16 a[84:87], v[72:75], v[60:63], a[84:87]
    buffer_load_dwordx4 v[8:11], v252, s[4:7], s45 offen offset:2048
    v_mfma_f32_16x16x32_bf16 a[104:107], v[72:75], v[64:67], a[104:107]
    v_mfma_f32_16x16x32_bf16 a[8:11], v[76:79], v[44:47], a[8:11]
    v_mfma_f32_16x16x32_bf16 a[28:31], v[76:79], v[48:51], a[28:31]
    buffer_load_dwordx4 v[32:35], v252, s[8:11], s45 offen offset:2048
    v_mfma_f32_16x16x32_bf16 a[48:51], v[76:79], v[52:55], a[48:51]
    v_mfma_f32_16x16x32_bf16 a[68:71], v[76:79], v[56:59], a[68:71]
    v_mfma_f32_16x16x32_bf16 a[88:91], v[76:79], v[60:63], a[88:91]
    buffer_load_dwordx4 v[12:15], v252, s[4:7], s46 offen offset:2048
    v_mfma_f32_16x16x32_bf16 a[108:111], v[76:79], v[64:67], a[108:111]
    v_mfma_f32_16x16x32_bf16 a[12:15], v[80:83], v[44:47], a[12:15]
    v_mfma_f32_16x16x32_bf16 a[32:35], v[80:83], v[48:51], a[32:35]
    buffer_load_dwordx4 v[36:39], v252, s[8:11], s46 offen offset:2048
    v_mfma_f32_16x16x32_bf16 a[52:55], v[80:83], v[52:55], a[52:55]
    v_mfma_f32_16x16x32_bf16 a[72:75], v[80:83], v[56:59], a[72:75]
    buffer_load_dwordx4 v[16:19], v252, s[4:7], s47 offen offset:2048
    v_mfma_f32_16x16x32_bf16 a[92:95], v[80:83], v[60:63], a[92:95]
    v_mfma_f32_16x16x32_bf16 a[112:115], v[80:83], v[64:67], a[112:115]
    v_mfma_f32_16x16x32_bf16 a[16:19], v[84:87], v[44:47], a[16:19]
    buffer_load_dwordx4 v[40:43], v252, s[8:11], s47 offen offset:2048
    v_mfma_f32_16x16x32_bf16 a[36:39], v[84:87], v[48:51], a[36:39]
    v_mfma_f32_16x16x32_bf16 a[56:59], v[84:87], v[52:55], a[56:59]
    v_mfma_f32_16x16x32_bf16 a[76:79], v[84:87], v[56:59], a[76:79]
    buffer_load_dwordx4 v[20:23], v252, s[4:7], s48 offen offset:2048
    v_mfma_f32_16x16x32_bf16 a[96:99], v[84:87], v[60:63], a[96:99]
    v_mfma_f32_16x16x32_bf16 a[116:119], v[84:87], v[64:67], a[116:119]
    s_waitcnt vmcnt(11)
    v_mfma_f32_16x16x32_bf16 a[0:3], v[112:115], v[88:91], a[0:3]
    buffer_load_dwordx4 v[44:47], v252, s[4:7], 0 offen offset:3072
    v_mfma_f32_16x16x32_bf16 a[20:23], v[112:115], v[92:95], a[20:23]
    v_mfma_f32_16x16x32_bf16 a[40:43], v[112:115], v[96:99], a[40:43]
    buffer_load_dwordx4 v[68:71], v252, s[8:11], 0 offen offset:3072
    v_mfma_f32_16x16x32_bf16 a[60:63], v[112:115], v[100:103], a[60:63]
    v_mfma_f32_16x16x32_bf16 a[80:83], v[112:115], v[104:107], a[80:83]
    v_mfma_f32_16x16x32_bf16 a[100:103], v[112:115], v[108:111], a[100:103]
    buffer_load_dwordx4 v[48:51], v252, s[4:7], s44 offen offset:3072
    v_mfma_f32_16x16x32_bf16 a[4:7], v[116:119], v[88:91], a[4:7]
    v_mfma_f32_16x16x32_bf16 a[24:27], v[116:119], v[92:95], a[24:27]
    v_mfma_f32_16x16x32_bf16 a[44:47], v[116:119], v[96:99], a[44:47]
    buffer_load_dwordx4 v[72:75], v252, s[8:11], s44 offen offset:3072
    v_mfma_f32_16x16x32_bf16 a[64:67], v[116:119], v[100:103], a[64:67]
    v_mfma_f32_16x16x32_bf16 a[84:87], v[116:119], v[104:107], a[84:87]
    buffer_load_dwordx4 v[52:55], v252, s[4:7], s45 offen offset:3072
    v_mfma_f32_16x16x32_bf16 a[104:107], v[116:119], v[108:111], a[104:107]
    v_mfma_f32_16x16x32_bf16 a[8:11], v[120:123], v[88:91], a[8:11]
    v_mfma_f32_16x16x32_bf16 a[28:31], v[120:123], v[92:95], a[28:31]
    buffer_load_dwordx4 v[76:79], v252, s[8:11], s45 offen offset:3072
    v_mfma_f32_16x16x32_bf16 a[48:51], v[120:123], v[96:99], a[48:51]
    v_mfma_f32_16x16x32_bf16 a[68:71], v[120:123], v[100:103], a[68:71]
    v_mfma_f32_16x16x32_bf16 a[88:91], v[120:123], v[104:107], a[88:91]
    buffer_load_dwordx4 v[56:59], v252, s[4:7], s46 offen offset:3072
    v_mfma_f32_16x16x32_bf16 a[108:111], v[120:123], v[108:111], a[108:111]
    v_mfma_f32_16x16x32_bf16 a[12:15], v[124:127], v[88:91], a[12:15]
    v_mfma_f32_16x16x32_bf16 a[32:35], v[124:127], v[92:95], a[32:35]
    buffer_load_dwordx4 v[80:83], v252, s[8:11], s46 offen offset:3072
    v_mfma_f32_16x16x32_bf16 a[52:55], v[124:127], v[96:99], a[52:55]
    v_mfma_f32_16x16x32_bf16 a[72:75], v[124:127], v[100:103], a[72:75]
    buffer_load_dwordx4 v[60:63], v252, s[4:7], s47 offen offset:3072
    v_mfma_f32_16x16x32_bf16 a[92:95], v[124:127], v[104:107], a[92:95]
    v_mfma_f32_16x16x32_bf16 a[112:115], v[124:127], v[108:111], a[112:115]
    v_mfma_f32_16x16x32_bf16 a[16:19], v[128:131], v[88:91], a[16:19]
    buffer_load_dwordx4 v[84:87], v252, s[8:11], s47 offen offset:3072
    v_mfma_f32_16x16x32_bf16 a[36:39], v[128:131], v[92:95], a[36:39]
    v_mfma_f32_16x16x32_bf16 a[56:59], v[128:131], v[96:99], a[56:59]
    v_mfma_f32_16x16x32_bf16 a[76:79], v[128:131], v[100:103], a[76:79]
    buffer_load_dwordx4 v[64:67], v252, s[4:7], s48 offen offset:3072
    v_mfma_f32_16x16x32_bf16 a[96:99], v[128:131], v[104:107], a[96:99]
    v_mfma_f32_16x16x32_bf16 a[116:119], v[128:131], v[108:111], a[116:119]
    s_waitcnt vmcnt(11)
    v_mfma_f32_16x16x32_bf16 a[0:3], v[24:27], v[0:3], a[0:3]
    v_add_u32 v252, 4096, v252
    buffer_load_dwordx4 v[88:91], v252, s[4:7], 0 offen offset:0
    v_mfma_f32_16x16x32_bf16 a[20:23], v[24:27], v[4:7], a[20:23]
    v_mfma_f32_16x16x32_bf16 a[40:43], v[24:27], v[8:11], a[40:43]
    buffer_load_dwordx4 v[112:115], v252, s[8:11], 0 offen offset:0
    v_mfma_f32_16x16x32_bf16 a[60:63], v[24:27], v[12:15], a[60:63]
    v_mfma_f32_16x16x32_bf16 a[80:83], v[24:27], v[16:19], a[80:83]
    v_mfma_f32_16x16x32_bf16 a[100:103], v[24:27], v[20:23], a[100:103]
    buffer_load_dwordx4 v[92:95], v252, s[4:7], s44 offen offset:0
    v_mfma_f32_16x16x32_bf16 a[4:7], v[28:31], v[0:3], a[4:7]
    v_mfma_f32_16x16x32_bf16 a[24:27], v[28:31], v[4:7], a[24:27]
    v_mfma_f32_16x16x32_bf16 a[44:47], v[28:31], v[8:11], a[44:47]
    buffer_load_dwordx4 v[116:119], v252, s[8:11], s44 offen offset:0
    v_mfma_f32_16x16x32_bf16 a[64:67], v[28:31], v[12:15], a[64:67]
    v_mfma_f32_16x16x32_bf16 a[84:87], v[28:31], v[16:19], a[84:87]
    buffer_load_dwordx4 v[96:99], v252, s[4:7], s45 offen offset:0
    v_mfma_f32_16x16x32_bf16 a[104:107], v[28:31], v[20:23], a[104:107]
    v_mfma_f32_16x16x32_bf16 a[8:11], v[32:35], v[0:3], a[8:11]
    v_mfma_f32_16x16x32_bf16 a[28:31], v[32:35], v[4:7], a[28:31]
    buffer_load_dwordx4 v[120:123], v252, s[8:11], s45 offen offset:0
    v_mfma_f32_16x16x32_bf16 a[48:51], v[32:35], v[8:11], a[48:51]
    v_mfma_f32_16x16x32_bf16 a[68:71], v[32:35], v[12:15], a[68:71]
    v_mfma_f32_16x16x32_bf16 a[88:91], v[32:35], v[16:19], a[88:91]
    buffer_load_dwordx4 v[100:103], v252, s[4:7], s46 offen offset:0
    v_mfma_f32_16x16x32_bf16 a[108:111], v[32:35], v[20:23], a[108:111]
    v_mfma_f32_16x16x32_bf16 a[12:15], v[36:39], v[0:3], a[12:15]
    v_mfma_f32_16x16x32_bf16 a[32:35], v[36:39], v[4:7], a[32:35]
    buffer_load_dwordx4 v[124:127], v252, s[8:11], s46 offen offset:0
    v_mfma_f32_16x16x32_bf16 a[52:55], v[36:39], v[8:11], a[52:55]
    v_mfma_f32_16x16x32_bf16 a[72:75], v[36:39], v[12:15], a[72:75]
    buffer_load_dwordx4 v[104:107], v252, s[4:7], s47 offen offset:0
    v_mfma_f32_16x16x32_bf16 a[92:95], v[36:39], v[16:19], a[92:95]
    v_mfma_f32_16x16x32_bf16 a[112:115], v[36:39], v[20:23], a[112:115]
    v_mfma_f32_16x16x32_bf16 a[16:19], v[40:43], v[0:3], a[16:19]
    buffer_load_dwordx4 v[128:131], v252, s[8:11], s47 offen offset:0
    v_mfma_f32_16x16x32_bf16 a[36:39], v[40:43], v[4:7], a[36:39]
    v_mfma_f32_16x16x32_bf16 a[56:59], v[40:43], v[8:11], a[56:59]
    v_mfma_f32_16x16x32_bf16 a[76:79], v[40:43], v[12:15], a[76:79]
    buffer_load_dwordx4 v[108:111], v252, s[4:7], s48 offen offset:0
    v_mfma_f32_16x16x32_bf16 a[96:99], v[40:43], v[16:19], a[96:99]
    v_mfma_f32_16x16x32_bf16 a[116:119], v[40:43], v[20:23], a[116:119]
    s_waitcnt vmcnt(11)
    v_mfma_f32_16x16x32_bf16 a[0:3], v[68:71], v[44:47], a[0:3]
    buffer_load_dwordx4 v[0:3], v252, s[4:7], 0 offen offset:1024
    v_mfma_f32_16x16x32_bf16 a[20:23], v[68:71], v[48:51], a[20:23]
    v_mfma_f32_16x16x32_bf16 a[40:43], v[68:71], v[52:55], a[40:43]
    buffer_load_dwordx4 v[24:27], v252, s[8:11], 0 offen offset:1024
    v_mfma_f32_16x16x32_bf16 a[60:63], v[68:71], v[56:59], a[60:63]
    v_mfma_f32_16x16x32_bf16 a[80:83], v[68:71], v[60:63], a[80:83]
    v_mfma_f32_16x16x32_bf16 a[100:103], v[68:71], v[64:67], a[100:103]
    buffer_load_dwordx4 v[4:7], v252, s[4:7], s44 offen offset:1024
    v_mfma_f32_16x16x32_bf16 a[4:7], v[72:75], v[44:47], a[4:7]
    v_mfma_f32_16x16x32_bf16 a[24:27], v[72:75], v[48:51], a[24:27]
    v_mfma_f32_16x16x32_bf16 a[44:47], v[72:75], v[52:55], a[44:47]
    buffer_load_dwordx4 v[28:31], v252, s[8:11], s44 offen offset:1024
    v_mfma_f32_16x16x32_bf16 a[64:67], v[72:75], v[56:59], a[64:67]
    v_mfma_f32_16x16x32_bf16 a[84:87], v[72:75], v[60:63], a[84:87]
    buffer_load_dwordx4 v[8:11], v252, s[4:7], s45 offen offset:1024
    v_mfma_f32_16x16x32_bf16 a[104:107], v[72:75], v[64:67], a[104:107]
    v_mfma_f32_16x16x32_bf16 a[8:11], v[76:79], v[44:47], a[8:11]
    v_mfma_f32_16x16x32_bf16 a[28:31], v[76:79], v[48:51], a[28:31]
    buffer_load_dwordx4 v[32:35], v252, s[8:11], s45 offen offset:1024
    v_mfma_f32_16x16x32_bf16 a[48:51], v[76:79], v[52:55], a[48:51]
    v_mfma_f32_16x16x32_bf16 a[68:71], v[76:79], v[56:59], a[68:71]
    v_mfma_f32_16x16x32_bf16 a[88:91], v[76:79], v[60:63], a[88:91]
    buffer_load_dwordx4 v[12:15], v252, s[4:7], s46 offen offset:1024
    v_mfma_f32_16x16x32_bf16 a[108:111], v[76:79], v[64:67], a[108:111]
    v_mfma_f32_16x16x32_bf16 a[12:15], v[80:83], v[44:47], a[12:15]
    v_mfma_f32_16x16x32_bf16 a[32:35], v[80:83], v[48:51], a[32:35]
    buffer_load_dwordx4 v[36:39], v252, s[8:11], s46 offen offset:1024
    v_mfma_f32_16x16x32_bf16 a[52:55], v[80:83], v[52:55], a[52:55]
    v_mfma_f32_16x16x32_bf16 a[72:75], v[80:83], v[56:59], a[72:75]
    buffer_load_dwordx4 v[16:19], v252, s[4:7], s47 offen offset:1024
    v_mfma_f32_16x16x32_bf16 a[92:95], v[80:83], v[60:63], a[92:95]
    v_mfma_f32_16x16x32_bf16 a[112:115], v[80:83], v[64:67], a[112:115]
    v_mfma_f32_16x16x32_bf16 a[16:19], v[84:87], v[44:47], a[16:19]
    buffer_load_dwordx4 v[40:43], v252, s[8:11], s47 offen offset:1024
    v_mfma_f32_16x16x32_bf16 a[36:39], v[84:87], v[48:51], a[36:39]
    v_mfma_f32_16x16x32_bf16 a[56:59], v[84:87], v[52:55], a[56:59]
    v_mfma_f32_16x16x32_bf16 a[76:79], v[84:87], v[56:59], a[76:79]
    buffer_load_dwordx4 v[20:23], v252, s[4:7], s48 offen offset:1024
    v_mfma_f32_16x16x32_bf16 a[96:99], v[84:87], v[60:63], a[96:99]
    v_mfma_f32_16x16x32_bf16 a[116:119], v[84:87], v[64:67], a[116:119]
    s_waitcnt vmcnt(11)
    v_mfma_f32_16x16x32_bf16 a[0:3], v[112:115], v[88:91], a[0:3]
    buffer_load_dwordx4 v[44:47], v252, s[4:7], 0 offen offset:2048
    v_mfma_f32_16x16x32_bf16 a[20:23], v[112:115], v[92:95], a[20:23]
    v_mfma_f32_16x16x32_bf16 a[40:43], v[112:115], v[96:99], a[40:43]
    buffer_load_dwordx4 v[68:71], v252, s[8:11], 0 offen offset:2048
    v_mfma_f32_16x16x32_bf16 a[60:63], v[112:115], v[100:103], a[60:63]
    v_mfma_f32_16x16x32_bf16 a[80:83], v[112:115], v[104:107], a[80:83]
    v_mfma_f32_16x16x32_bf16 a[100:103], v[112:115], v[108:111], a[100:103]
    buffer_load_dwordx4 v[48:51], v252, s[4:7], s44 offen offset:2048
    v_mfma_f32_16x16x32_bf16 a[4:7], v[116:119], v[88:91], a[4:7]
    v_mfma_f32_16x16x32_bf16 a[24:27], v[116:119], v[92:95], a[24:27]
    v_mfma_f32_16x16x32_bf16 a[44:47], v[116:119], v[96:99], a[44:47]
    buffer_load_dwordx4 v[72:75], v252, s[8:11], s44 offen offset:2048
    v_mfma_f32_16x16x32_bf16 a[64:67], v[116:119], v[100:103], a[64:67]
    v_mfma_f32_16x16x32_bf16 a[84:87], v[116:119], v[104:107], a[84:87]
    buffer_load_dwordx4 v[52:55], v252, s[4:7], s45 offen offset:2048
    v_mfma_f32_16x16x32_bf16 a[104:107], v[116:119], v[108:111], a[104:107]
    v_mfma_f32_16x16x32_bf16 a[8:11], v[120:123], v[88:91], a[8:11]
    v_mfma_f32_16x16x32_bf16 a[28:31], v[120:123], v[92:95], a[28:31]
    buffer_load_dwordx4 v[76:79], v252, s[8:11], s45 offen offset:2048
    v_mfma_f32_16x16x32_bf16 a[48:51], v[120:123], v[96:99], a[48:51]
    v_mfma_f32_16x16x32_bf16 a[68:71], v[120:123], v[100:103], a[68:71]
    v_mfma_f32_16x16x32_bf16 a[88:91], v[120:123], v[104:107], a[88:91]
    buffer_load_dwordx4 v[56:59], v252, s[4:7], s46 offen offset:2048
    v_mfma_f32_16x16x32_bf16 a[108:111], v[120:123], v[108:111], a[108:111]
    v_mfma_f32_16x16x32_bf16 a[12:15], v[124:127], v[88:91], a[12:15]
    v_mfma_f32_16x16x32_bf16 a[32:35], v[124:127], v[92:95], a[32:35]
    buffer_load_dwordx4 v[80:83], v252, s[8:11], s46 offen offset:2048
    v_mfma_f32_16x16x32_bf16 a[52:55], v[124:127], v[96:99], a[52:55]
    v_mfma_f32_16x16x32_bf16 a[72:75], v[124:127], v[100:103], a[72:75]
    buffer_load_dwordx4 v[60:63], v252, s[4:7], s47 offen offset:2048
    v_mfma_f32_16x16x32_bf16 a[92:95], v[124:127], v[104:107], a[92:95]
    v_mfma_f32_16x16x32_bf16 a[112:115], v[124:127], v[108:111], a[112:115]
    v_mfma_f32_16x16x32_bf16 a[16:19], v[128:131], v[88:91], a[16:19]
    buffer_load_dwordx4 v[84:87], v252, s[8:11], s47 offen offset:2048
    v_mfma_f32_16x16x32_bf16 a[36:39], v[128:131], v[92:95], a[36:39]
    v_mfma_f32_16x16x32_bf16 a[56:59], v[128:131], v[96:99], a[56:59]
    v_mfma_f32_16x16x32_bf16 a[76:79], v[128:131], v[100:103], a[76:79]
    buffer_load_dwordx4 v[64:67], v252, s[4:7], s48 offen offset:2048
    v_mfma_f32_16x16x32_bf16 a[96:99], v[128:131], v[104:107], a[96:99]
    v_mfma_f32_16x16x32_bf16 a[116:119], v[128:131], v[108:111], a[116:119]
    s_waitcnt vmcnt(11)
    v_mfma_f32_16x16x32_bf16 a[0:3], v[24:27], v[0:3], a[0:3]
    buffer_load_dwordx4 v[88:91], v252, s[4:7], 0 offen offset:3072
    v_mfma_f32_16x16x32_bf16 a[20:23], v[24:27], v[4:7], a[20:23]
    v_mfma_f32_16x16x32_bf16 a[40:43], v[24:27], v[8:11], a[40:43]
    buffer_load_dwordx4 v[112:115], v252, s[8:11], 0 offen offset:3072
    v_mfma_f32_16x16x32_bf16 a[60:63], v[24:27], v[12:15], a[60:63]
    v_mfma_f32_16x16x32_bf16 a[80:83], v[24:27], v[16:19], a[80:83]
    v_mfma_f32_16x16x32_bf16 a[100:103], v[24:27], v[20:23], a[100:103]
    buffer_load_dwordx4 v[92:95], v252, s[4:7], s44 offen offset:3072
    v_mfma_f32_16x16x32_bf16 a[4:7], v[28:31], v[0:3], a[4:7]
    v_mfma_f32_16x16x32_bf16 a[24:27], v[28:31], v[4:7], a[24:27]
    v_mfma_f32_16x16x32_bf16 a[44:47], v[28:31], v[8:11], a[44:47]
    buffer_load_dwordx4 v[116:119], v252, s[8:11], s44 offen offset:3072
    v_mfma_f32_16x16x32_bf16 a[64:67], v[28:31], v[12:15], a[64:67]
    v_mfma_f32_16x16x32_bf16 a[84:87], v[28:31], v[16:19], a[84:87]
    buffer_load_dwordx4 v[96:99], v252, s[4:7], s45 offen offset:3072
    v_mfma_f32_16x16x32_bf16 a[104:107], v[28:31], v[20:23], a[104:107]
    v_mfma_f32_16x16x32_bf16 a[8:11], v[32:35], v[0:3], a[8:11]
    v_mfma_f32_16x16x32_bf16 a[28:31], v[32:35], v[4:7], a[28:31]
    buffer_load_dwordx4 v[120:123], v252, s[8:11], s45 offen offset:3072
    v_mfma_f32_16x16x32_bf16 a[48:51], v[32:35], v[8:11], a[48:51]
    v_mfma_f32_16x16x32_bf16 a[68:71], v[32:35], v[12:15], a[68:71]
    v_mfma_f32_16x16x32_bf16 a[88:91], v[32:35], v[16:19], a[88:91]
    buffer_load_dwordx4 v[100:103], v252, s[4:7], s46 offen offset:3072
    v_mfma_f32_16x16x32_bf16 a[108:111], v[32:35], v[20:23], a[108:111]
    v_mfma_f32_16x16x32_bf16 a[12:15], v[36:39], v[0:3], a[12:15]
    v_mfma_f32_16x16x32_bf16 a[32:35], v[36:39], v[4:7], a[32:35]
    buffer_load_dwordx4 v[124:127], v252, s[8:11], s46 offen offset:3072
    v_mfma_f32_16x16x32_bf16 a[52:55], v[36:39], v[8:11], a[52:55]
    v_mfma_f32_16x16x32_bf16 a[72:75], v[36:39], v[12:15], a[72:75]
    buffer_load_dwordx4 v[104:107], v252, s[4:7], s47 offen offset:3072
    v_mfma_f32_16x16x32_bf16 a[92:95], v[36:39], v[16:19], a[92:95]
    v_mfma_f32_16x16x32_bf16 a[112:115], v[36:39], v[20:23], a[112:115]
    v_mfma_f32_16x16x32_bf16 a[16:19], v[40:43], v[0:3], a[16:19]
    buffer_load_dwordx4 v[128:131], v252, s[8:11], s47 offen offset:3072
    v_mfma_f32_16x16x32_bf16 a[36:39], v[40:43], v[4:7], a[36:39]
    v_mfma_f32_16x16x32_bf16 a[56:59], v[40:43], v[8:11], a[56:59]
    v_mfma_f32_16x16x32_bf16 a[76:79], v[40:43], v[12:15], a[76:79]
    buffer_load_dwordx4 v[108:111], v252, s[4:7], s48 offen offset:3072
    v_mfma_f32_16x16x32_bf16 a[96:99], v[40:43], v[16:19], a[96:99]
    v_mfma_f32_16x16x32_bf16 a[116:119], v[40:43], v[20:23], a[116:119]
    s_waitcnt vmcnt(11)
    v_mfma_f32_16x16x32_bf16 a[0:3], v[68:71], v[44:47], a[0:3]
    v_add_u32 v252, 4096, v252
    buffer_load_dwordx4 v[0:3], v252, s[4:7], 0 offen offset:0
    v_mfma_f32_16x16x32_bf16 a[20:23], v[68:71], v[48:51], a[20:23]
    v_mfma_f32_16x16x32_bf16 a[40:43], v[68:71], v[52:55], a[40:43]
    buffer_load_dwordx4 v[24:27], v252, s[8:11], 0 offen offset:0
    v_mfma_f32_16x16x32_bf16 a[60:63], v[68:71], v[56:59], a[60:63]
    v_mfma_f32_16x16x32_bf16 a[80:83], v[68:71], v[60:63], a[80:83]
    v_mfma_f32_16x16x32_bf16 a[100:103], v[68:71], v[64:67], a[100:103]
    buffer_load_dwordx4 v[4:7], v252, s[4:7], s44 offen offset:0
    v_mfma_f32_16x16x32_bf16 a[4:7], v[72:75], v[44:47], a[4:7]
    v_mfma_f32_16x16x32_bf16 a[24:27], v[72:75], v[48:51], a[24:27]
    v_mfma_f32_16x16x32_bf16 a[44:47], v[72:75], v[52:55], a[44:47]
    buffer_load_dwordx4 v[28:31], v252, s[8:11], s44 offen offset:0
    v_mfma_f32_16x16x32_bf16 a[64:67], v[72:75], v[56:59], a[64:67]
    v_mfma_f32_16x16x32_bf16 a[84:87], v[72:75], v[60:63], a[84:87]
    buffer_load_dwordx4 v[8:11], v252, s[4:7], s45 offen offset:0
    v_mfma_f32_16x16x32_bf16 a[104:107], v[72:75], v[64:67], a[104:107]
    v_mfma_f32_16x16x32_bf16 a[8:11], v[76:79], v[44:47], a[8:11]
    v_mfma_f32_16x16x32_bf16 a[28:31], v[76:79], v[48:51], a[28:31]
    buffer_load_dwordx4 v[32:35], v252, s[8:11], s45 offen offset:0
    v_mfma_f32_16x16x32_bf16 a[48:51], v[76:79], v[52:55], a[48:51]
    v_mfma_f32_16x16x32_bf16 a[68:71], v[76:79], v[56:59], a[68:71]
    v_mfma_f32_16x16x32_bf16 a[88:91], v[76:79], v[60:63], a[88:91]
    buffer_load_dwordx4 v[12:15], v252, s[4:7], s46 offen offset:0
    v_mfma_f32_16x16x32_bf16 a[108:111], v[76:79], v[64:67], a[108:111]
    v_mfma_f32_16x16x32_bf16 a[12:15], v[80:83], v[44:47], a[12:15]
    v_mfma_f32_16x16x32_bf16 a[32:35], v[80:83], v[48:51], a[32:35]
    buffer_load_dwordx4 v[36:39], v252, s[8:11], s46 offen offset:0
    v_mfma_f32_16x16x32_bf16 a[52:55], v[80:83], v[52:55], a[52:55]
    v_mfma_f32_16x16x32_bf16 a[72:75], v[80:83], v[56:59], a[72:75]
    buffer_load_dwordx4 v[16:19], v252, s[4:7], s47 offen offset:0
    v_mfma_f32_16x16x32_bf16 a[92:95], v[80:83], v[60:63], a[92:95]
    v_mfma_f32_16x16x32_bf16 a[112:115], v[80:83], v[64:67], a[112:115]
    v_mfma_f32_16x16x32_bf16 a[16:19], v[84:87], v[44:47], a[16:19]
    buffer_load_dwordx4 v[40:43], v252, s[8:11], s47 offen offset:0
    v_mfma_f32_16x16x32_bf16 a[36:39], v[84:87], v[48:51], a[36:39]
    v_mfma_f32_16x16x32_bf16 a[56:59], v[84:87], v[52:55], a[56:59]
    v_mfma_f32_16x16x32_bf16 a[76:79], v[84:87], v[56:59], a[76:79]
    buffer_load_dwordx4 v[20:23], v252, s[4:7], s48 offen offset:0
    v_mfma_f32_16x16x32_bf16 a[96:99], v[84:87], v[60:63], a[96:99]
    v_mfma_f32_16x16x32_bf16 a[116:119], v[84:87], v[64:67], a[116:119]
    s_waitcnt vmcnt(11)
    v_mfma_f32_16x16x32_bf16 a[0:3], v[112:115], v[88:91], a[0:3]
    buffer_load_dwordx4 v[44:47], v252, s[4:7], 0 offen offset:1024
    v_mfma_f32_16x16x32_bf16 a[20:23], v[112:115], v[92:95], a[20:23]
    v_mfma_f32_16x16x32_bf16 a[40:43], v[112:115], v[96:99], a[40:43]
    buffer_load_dwordx4 v[68:71], v252, s[8:11], 0 offen offset:1024
    v_mfma_f32_16x16x32_bf16 a[60:63], v[112:115], v[100:103], a[60:63]
    v_mfma_f32_16x16x32_bf16 a[80:83], v[112:115], v[104:107], a[80:83]
    v_mfma_f32_16x16x32_bf16 a[100:103], v[112:115], v[108:111], a[100:103]
    buffer_load_dwordx4 v[48:51], v252, s[4:7], s44 offen offset:1024
    v_mfma_f32_16x16x32_bf16 a[4:7], v[116:119], v[88:91], a[4:7]
    v_mfma_f32_16x16x32_bf16 a[24:27], v[116:119], v[92:95], a[24:27]
    v_mfma_f32_16x16x32_bf16 a[44:47], v[116:119], v[96:99], a[44:47]
    buffer_load_dwordx4 v[72:75], v252, s[8:11], s44 offen offset:1024
    v_mfma_f32_16x16x32_bf16 a[64:67], v[116:119], v[100:103], a[64:67]
    v_mfma_f32_16x16x32_bf16 a[84:87], v[116:119], v[104:107], a[84:87]
    buffer_load_dwordx4 v[52:55], v252, s[4:7], s45 offen offset:1024
    v_mfma_f32_16x16x32_bf16 a[104:107], v[116:119], v[108:111], a[104:107]
    v_mfma_f32_16x16x32_bf16 a[8:11], v[120:123], v[88:91], a[8:11]
    v_mfma_f32_16x16x32_bf16 a[28:31], v[120:123], v[92:95], a[28:31]
    buffer_load_dwordx4 v[76:79], v252, s[8:11], s45 offen offset:1024
    v_mfma_f32_16x16x32_bf16 a[48:51], v[120:123], v[96:99], a[48:51]
    v_mfma_f32_16x16x32_bf16 a[68:71], v[120:123], v[100:103], a[68:71]
    v_mfma_f32_16x16x32_bf16 a[88:91], v[120:123], v[104:107], a[88:91]
    buffer_load_dwordx4 v[56:59], v252, s[4:7], s46 offen offset:1024
    v_mfma_f32_16x16x32_bf16 a[108:111], v[120:123], v[108:111], a[108:111]
    v_mfma_f32_16x16x32_bf16 a[12:15], v[124:127], v[88:91], a[12:15]
    v_mfma_f32_16x16x32_bf16 a[32:35], v[124:127], v[92:95], a[32:35]
    buffer_load_dwordx4 v[80:83], v252, s[8:11], s46 offen offset:1024
    v_mfma_f32_16x16x32_bf16 a[52:55], v[124:127], v[96:99], a[52:55]
    v_mfma_f32_16x16x32_bf16 a[72:75], v[124:127], v[100:103], a[72:75]
    buffer_load_dwordx4 v[60:63], v252, s[4:7], s47 offen offset:1024
    v_mfma_f32_16x16x32_bf16 a[92:95], v[124:127], v[104:107], a[92:95]
    v_mfma_f32_16x16x32_bf16 a[112:115], v[124:127], v[108:111], a[112:115]
    v_mfma_f32_16x16x32_bf16 a[16:19], v[128:131], v[88:91], a[16:19]
    buffer_load_dwordx4 v[84:87], v252, s[8:11], s47 offen offset:1024
    v_mfma_f32_16x16x32_bf16 a[36:39], v[128:131], v[92:95], a[36:39]
    v_mfma_f32_16x16x32_bf16 a[56:59], v[128:131], v[96:99], a[56:59]
    v_mfma_f32_16x16x32_bf16 a[76:79], v[128:131], v[100:103], a[76:79]
    buffer_load_dwordx4 v[64:67], v252, s[4:7], s48 offen offset:1024
    v_mfma_f32_16x16x32_bf16 a[96:99], v[128:131], v[104:107], a[96:99]
    v_mfma_f32_16x16x32_bf16 a[116:119], v[128:131], v[108:111], a[116:119]
    s_waitcnt vmcnt(11)
    v_mfma_f32_16x16x32_bf16 a[0:3], v[24:27], v[0:3], a[0:3]
    buffer_load_dwordx4 v[88:91], v252, s[4:7], 0 offen offset:2048
    v_mfma_f32_16x16x32_bf16 a[20:23], v[24:27], v[4:7], a[20:23]
    v_mfma_f32_16x16x32_bf16 a[40:43], v[24:27], v[8:11], a[40:43]
    buffer_load_dwordx4 v[112:115], v252, s[8:11], 0 offen offset:2048
    v_mfma_f32_16x16x32_bf16 a[60:63], v[24:27], v[12:15], a[60:63]
    v_mfma_f32_16x16x32_bf16 a[80:83], v[24:27], v[16:19], a[80:83]
    v_mfma_f32_16x16x32_bf16 a[100:103], v[24:27], v[20:23], a[100:103]
    buffer_load_dwordx4 v[92:95], v252, s[4:7], s44 offen offset:2048
    v_mfma_f32_16x16x32_bf16 a[4:7], v[28:31], v[0:3], a[4:7]
    v_mfma_f32_16x16x32_bf16 a[24:27], v[28:31], v[4:7], a[24:27]
    v_mfma_f32_16x16x32_bf16 a[44:47], v[28:31], v[8:11], a[44:47]
    buffer_load_dwordx4 v[116:119], v252, s[8:11], s44 offen offset:2048
    v_mfma_f32_16x16x32_bf16 a[64:67], v[28:31], v[12:15], a[64:67]
    v_mfma_f32_16x16x32_bf16 a[84:87], v[28:31], v[16:19], a[84:87]
    buffer_load_dwordx4 v[96:99], v252, s[4:7], s45 offen offset:2048
    v_mfma_f32_16x16x32_bf16 a[104:107], v[28:31], v[20:23], a[104:107]
    v_mfma_f32_16x16x32_bf16 a[8:11], v[32:35], v[0:3], a[8:11]
    v_mfma_f32_16x16x32_bf16 a[28:31], v[32:35], v[4:7], a[28:31]
    buffer_load_dwordx4 v[120:123], v252, s[8:11], s45 offen offset:2048
    v_mfma_f32_16x16x32_bf16 a[48:51], v[32:35], v[8:11], a[48:51]
    v_mfma_f32_16x16x32_bf16 a[68:71], v[32:35], v[12:15], a[68:71]
    v_mfma_f32_16x16x32_bf16 a[88:91], v[32:35], v[16:19], a[88:91]
    buffer_load_dwordx4 v[100:103], v252, s[4:7], s46 offen offset:2048
    v_mfma_f32_16x16x32_bf16 a[108:111], v[32:35], v[20:23], a[108:111]
    v_mfma_f32_16x16x32_bf16 a[12:15], v[36:39], v[0:3], a[12:15]
    v_mfma_f32_16x16x32_bf16 a[32:35], v[36:39], v[4:7], a[32:35]
    buffer_load_dwordx4 v[124:127], v252, s[8:11], s46 offen offset:2048
    v_mfma_f32_16x16x32_bf16 a[52:55], v[36:39], v[8:11], a[52:55]
    v_mfma_f32_16x16x32_bf16 a[72:75], v[36:39], v[12:15], a[72:75]
    buffer_load_dwordx4 v[104:107], v252, s[4:7], s47 offen offset:2048
    v_mfma_f32_16x16x32_bf16 a[92:95], v[36:39], v[16:19], a[92:95]
    v_mfma_f32_16x16x32_bf16 a[112:115], v[36:39], v[20:23], a[112:115]
    v_mfma_f32_16x16x32_bf16 a[16:19], v[40:43], v[0:3], a[16:19]
    buffer_load_dwordx4 v[128:131], v252, s[8:11], s47 offen offset:2048
    v_mfma_f32_16x16x32_bf16 a[36:39], v[40:43], v[4:7], a[36:39]
    v_mfma_f32_16x16x32_bf16 a[56:59], v[40:43], v[8:11], a[56:59]
    v_mfma_f32_16x16x32_bf16 a[76:79], v[40:43], v[12:15], a[76:79]
    buffer_load_dwordx4 v[108:111], v252, s[4:7], s48 offen offset:2048
    v_mfma_f32_16x16x32_bf16 a[96:99], v[40:43], v[16:19], a[96:99]
    v_mfma_f32_16x16x32_bf16 a[116:119], v[40:43], v[20:23], a[116:119]
    s_waitcnt vmcnt(11)
    v_mfma_f32_16x16x32_bf16 a[0:3], v[68:71], v[44:47], a[0:3]
    buffer_load_dwordx4 v[0:3], v252, s[4:7], 0 offen offset:3072
    v_mfma_f32_16x16x32_bf16 a[20:23], v[68:71], v[48:51], a[20:23]
    v_mfma_f32_16x16x32_bf16 a[40:43], v[68:71], v[52:55], a[40:43]
    buffer_load_dwordx4 v[24:27], v252, s[8:11], 0 offen offset:3072
    v_mfma_f32_16x16x32_bf16 a[60:63], v[68:71], v[56:59], a[60:63]
    v_mfma_f32_16x16x32_bf16 a[80:83], v[68:71], v[60:63], a[80:83]
    v_mfma_f32_16x16x32_bf16 a[100:103], v[68:71], v[64:67], a[100:103]
    buffer_load_dwordx4 v[4:7], v252, s[4:7], s44 offen offset:3072
    v_mfma_f32_16x16x32_bf16 a[4:7], v[72:75], v[44:47], a[4:7]
    v_mfma_f32_16x16x32_bf16 a[24:27], v[72:75], v[48:51], a[24:27]
    v_mfma_f32_16x16x32_bf16 a[44:47], v[72:75], v[52:55], a[44:47]
    buffer_load_dwordx4 v[28:31], v252, s[8:11], s44 offen offset:3072
    v_mfma_f32_16x16x32_bf16 a[64:67], v[72:75], v[56:59], a[64:67]
    v_mfma_f32_16x16x32_bf16 a[84:87], v[72:75], v[60:63], a[84:87]
    buffer_load_dwordx4 v[8:11], v252, s[4:7], s45 offen offset:3072
    v_mfma_f32_16x16x32_bf16 a[104:107], v[72:75], v[64:67], a[104:107]
    v_mfma_f32_16x16x32_bf16 a[8:11], v[76:79], v[44:47], a[8:11]
    v_mfma_f32_16x16x32_bf16 a[28:31], v[76:79], v[48:51], a[28:31]
    buffer_load_dwordx4 v[32:35], v252, s[8:11], s45 offen offset:3072
    v_mfma_f32_16x16x32_bf16 a[48:51], v[76:79], v[52:55], a[48:51]
    v_mfma_f32_16x16x32_bf16 a[68:71], v[76:79], v[56:59], a[68:71]
    v_mfma_f32_16x16x32_bf16 a[88:91], v[76:79], v[60:63], a[88:91]
    buffer_load_dwordx4 v[12:15], v252, s[4:7], s46 offen offset:3072
    v_mfma_f32_16x16x32_bf16 a[108:111], v[76:79], v[64:67], a[108:111]
    v_mfma_f32_16x16x32_bf16 a[12:15], v[80:83], v[44:47], a[12:15]
    v_mfma_f32_16x16x32_bf16 a[32:35], v[80:83], v[48:51], a[32:35]
    buffer_load_dwordx4 v[36:39], v252, s[8:11], s46 offen offset:3072
    v_mfma_f32_16x16x32_bf16 a[52:55], v[80:83], v[52:55], a[52:55]
    v_mfma_f32_16x16x32_bf16 a[72:75], v[80:83], v[56:59], a[72:75]
    buffer_load_dwordx4 v[16:19], v252, s[4:7], s47 offen offset:3072
    v_mfma_f32_16x16x32_bf16 a[92:95], v[80:83], v[60:63], a[92:95]
    v_mfma_f32_16x16x32_bf16 a[112:115], v[80:83], v[64:67], a[112:115]
    v_mfma_f32_16x16x32_bf16 a[16:19], v[84:87], v[44:47], a[16:19]
    buffer_load_dwordx4 v[40:43], v252, s[8:11], s47 offen offset:3072
    v_mfma_f32_16x16x32_bf16 a[36:39], v[84:87], v[48:51], a[36:39]
    v_mfma_f32_16x16x32_bf16 a[56:59], v[84:87], v[52:55], a[56:59]
    v_mfma_f32_16x16x32_bf16 a[76:79], v[84:87], v[56:59], a[76:79]
    buffer_load_dwordx4 v[20:23], v252, s[4:7], s48 offen offset:3072
    v_mfma_f32_16x16x32_bf16 a[96:99], v[84:87], v[60:63], a[96:99]
    v_mfma_f32_16x16x32_bf16 a[116:119], v[84:87], v[64:67], a[116:119]
    s_waitcnt vmcnt(11)
    v_mfma_f32_16x16x32_bf16 a[0:3], v[112:115], v[88:91], a[0:3]
    v_add_u32 v252, 4096, v252
    buffer_load_dwordx4 v[44:47], v252, s[4:7], 0 offen offset:0
    v_mfma_f32_16x16x32_bf16 a[20:23], v[112:115], v[92:95], a[20:23]
    v_mfma_f32_16x16x32_bf16 a[40:43], v[112:115], v[96:99], a[40:43]
    buffer_load_dwordx4 v[68:71], v252, s[8:11], 0 offen offset:0
    v_mfma_f32_16x16x32_bf16 a[60:63], v[112:115], v[100:103], a[60:63]
    v_mfma_f32_16x16x32_bf16 a[80:83], v[112:115], v[104:107], a[80:83]
    v_mfma_f32_16x16x32_bf16 a[100:103], v[112:115], v[108:111], a[100:103]
    buffer_load_dwordx4 v[48:51], v252, s[4:7], s44 offen offset:0
    v_mfma_f32_16x16x32_bf16 a[4:7], v[116:119], v[88:91], a[4:7]
    v_mfma_f32_16x16x32_bf16 a[24:27], v[116:119], v[92:95], a[24:27]
    v_mfma_f32_16x16x32_bf16 a[44:47], v[116:119], v[96:99], a[44:47]
    buffer_load_dwordx4 v[72:75], v252, s[8:11], s44 offen offset:0
    v_mfma_f32_16x16x32_bf16 a[64:67], v[116:119], v[100:103], a[64:67]
    v_mfma_f32_16x16x32_bf16 a[84:87], v[116:119], v[104:107], a[84:87]
    buffer_load_dwordx4 v[52:55], v252, s[4:7], s45 offen offset:0
    v_mfma_f32_16x16x32_bf16 a[104:107], v[116:119], v[108:111], a[104:107]
    v_mfma_f32_16x16x32_bf16 a[8:11], v[120:123], v[88:91], a[8:11]
    v_mfma_f32_16x16x32_bf16 a[28:31], v[120:123], v[92:95], a[28:31]
    buffer_load_dwordx4 v[76:79], v252, s[8:11], s45 offen offset:0
    v_mfma_f32_16x16x32_bf16 a[48:51], v[120:123], v[96:99], a[48:51]
    v_mfma_f32_16x16x32_bf16 a[68:71], v[120:123], v[100:103], a[68:71]
    v_mfma_f32_16x16x32_bf16 a[88:91], v[120:123], v[104:107], a[88:91]
    buffer_load_dwordx4 v[56:59], v252, s[4:7], s46 offen offset:0
    v_mfma_f32_16x16x32_bf16 a[108:111], v[120:123], v[108:111], a[108:111]
    v_mfma_f32_16x16x32_bf16 a[12:15], v[124:127], v[88:91], a[12:15]
    v_mfma_f32_16x16x32_bf16 a[32:35], v[124:127], v[92:95], a[32:35]
    buffer_load_dwordx4 v[80:83], v252, s[8:11], s46 offen offset:0
    v_mfma_f32_16x16x32_bf16 a[52:55], v[124:127], v[96:99], a[52:55]
    v_mfma_f32_16x16x32_bf16 a[72:75], v[124:127], v[100:103], a[72:75]
    buffer_load_dwordx4 v[60:63], v252, s[4:7], s47 offen offset:0
    v_mfma_f32_16x16x32_bf16 a[92:95], v[124:127], v[104:107], a[92:95]
    v_mfma_f32_16x16x32_bf16 a[112:115], v[124:127], v[108:111], a[112:115]
    v_mfma_f32_16x16x32_bf16 a[16:19], v[128:131], v[88:91], a[16:19]
    buffer_load_dwordx4 v[84:87], v252, s[8:11], s47 offen offset:0
    v_mfma_f32_16x16x32_bf16 a[36:39], v[128:131], v[92:95], a[36:39]
    v_mfma_f32_16x16x32_bf16 a[56:59], v[128:131], v[96:99], a[56:59]
    v_mfma_f32_16x16x32_bf16 a[76:79], v[128:131], v[100:103], a[76:79]
    buffer_load_dwordx4 v[64:67], v252, s[4:7], s48 offen offset:0
    v_mfma_f32_16x16x32_bf16 a[96:99], v[128:131], v[104:107], a[96:99]
    v_mfma_f32_16x16x32_bf16 a[116:119], v[128:131], v[108:111], a[116:119]
    s_waitcnt vmcnt(11)
    v_mfma_f32_16x16x32_bf16 a[0:3], v[24:27], v[0:3], a[0:3]
    buffer_load_dwordx4 v[88:91], v252, s[4:7], 0 offen offset:1024
    v_mfma_f32_16x16x32_bf16 a[20:23], v[24:27], v[4:7], a[20:23]
    v_mfma_f32_16x16x32_bf16 a[40:43], v[24:27], v[8:11], a[40:43]
    buffer_load_dwordx4 v[112:115], v252, s[8:11], 0 offen offset:1024
    v_mfma_f32_16x16x32_bf16 a[60:63], v[24:27], v[12:15], a[60:63]
    v_mfma_f32_16x16x32_bf16 a[80:83], v[24:27], v[16:19], a[80:83]
    v_mfma_f32_16x16x32_bf16 a[100:103], v[24:27], v[20:23], a[100:103]
    buffer_load_dwordx4 v[92:95], v252, s[4:7], s44 offen offset:1024
    v_mfma_f32_16x16x32_bf16 a[4:7], v[28:31], v[0:3], a[4:7]
    v_mfma_f32_16x16x32_bf16 a[24:27], v[28:31], v[4:7], a[24:27]
    v_mfma_f32_16x16x32_bf16 a[44:47], v[28:31], v[8:11], a[44:47]
    buffer_load_dwordx4 v[116:119], v252, s[8:11], s44 offen offset:1024
    v_mfma_f32_16x16x32_bf16 a[64:67], v[28:31], v[12:15], a[64:67]
    v_mfma_f32_16x16x32_bf16 a[84:87], v[28:31], v[16:19], a[84:87]
    buffer_load_dwordx4 v[96:99], v252, s[4:7], s45 offen offset:1024
    v_mfma_f32_16x16x32_bf16 a[104:107], v[28:31], v[20:23], a[104:107]
    v_mfma_f32_16x16x32_bf16 a[8:11], v[32:35], v[0:3], a[8:11]
    v_mfma_f32_16x16x32_bf16 a[28:31], v[32:35], v[4:7], a[28:31]
    buffer_load_dwordx4 v[120:123], v252, s[8:11], s45 offen offset:1024
    v_mfma_f32_16x16x32_bf16 a[48:51], v[32:35], v[8:11], a[48:51]
    v_mfma_f32_16x16x32_bf16 a[68:71], v[32:35], v[12:15], a[68:71]
    v_mfma_f32_16x16x32_bf16 a[88:91], v[32:35], v[16:19], a[88:91]
    buffer_load_dwordx4 v[100:103], v252, s[4:7], s46 offen offset:1024
    v_mfma_f32_16x16x32_bf16 a[108:111], v[32:35], v[20:23], a[108:111]
    v_mfma_f32_16x16x32_bf16 a[12:15], v[36:39], v[0:3], a[12:15]
    v_mfma_f32_16x16x32_bf16 a[32:35], v[36:39], v[4:7], a[32:35]
    buffer_load_dwordx4 v[124:127], v252, s[8:11], s46 offen offset:1024
    v_mfma_f32_16x16x32_bf16 a[52:55], v[36:39], v[8:11], a[52:55]
    v_mfma_f32_16x16x32_bf16 a[72:75], v[36:39], v[12:15], a[72:75]
    buffer_load_dwordx4 v[104:107], v252, s[4:7], s47 offen offset:1024
    v_mfma_f32_16x16x32_bf16 a[92:95], v[36:39], v[16:19], a[92:95]
    v_mfma_f32_16x16x32_bf16 a[112:115], v[36:39], v[20:23], a[112:115]
    v_mfma_f32_16x16x32_bf16 a[16:19], v[40:43], v[0:3], a[16:19]
    buffer_load_dwordx4 v[128:131], v252, s[8:11], s47 offen offset:1024
    v_mfma_f32_16x16x32_bf16 a[36:39], v[40:43], v[4:7], a[36:39]
    v_mfma_f32_16x16x32_bf16 a[56:59], v[40:43], v[8:11], a[56:59]
    v_mfma_f32_16x16x32_bf16 a[76:79], v[40:43], v[12:15], a[76:79]
    buffer_load_dwordx4 v[108:111], v252, s[4:7], s48 offen offset:1024
    v_mfma_f32_16x16x32_bf16 a[96:99], v[40:43], v[16:19], a[96:99]
    v_mfma_f32_16x16x32_bf16 a[116:119], v[40:43], v[20:23], a[116:119]
    s_waitcnt vmcnt(11)
    v_mfma_f32_16x16x32_bf16 a[0:3], v[68:71], v[44:47], a[0:3]
    buffer_load_dwordx4 v[0:3], v252, s[4:7], 0 offen offset:2048
    v_mfma_f32_16x16x32_bf16 a[20:23], v[68:71], v[48:51], a[20:23]
    v_mfma_f32_16x16x32_bf16 a[40:43], v[68:71], v[52:55], a[40:43]
    buffer_load_dwordx4 v[24:27], v252, s[8:11], 0 offen offset:2048
    v_mfma_f32_16x16x32_bf16 a[60:63], v[68:71], v[56:59], a[60:63]
    v_mfma_f32_16x16x32_bf16 a[80:83], v[68:71], v[60:63], a[80:83]
    v_mfma_f32_16x16x32_bf16 a[100:103], v[68:71], v[64:67], a[100:103]
    buffer_load_dwordx4 v[4:7], v252, s[4:7], s44 offen offset:2048
    v_mfma_f32_16x16x32_bf16 a[4:7], v[72:75], v[44:47], a[4:7]
    v_mfma_f32_16x16x32_bf16 a[24:27], v[72:75], v[48:51], a[24:27]
    v_mfma_f32_16x16x32_bf16 a[44:47], v[72:75], v[52:55], a[44:47]
    buffer_load_dwordx4 v[28:31], v252, s[8:11], s44 offen offset:2048
    v_mfma_f32_16x16x32_bf16 a[64:67], v[72:75], v[56:59], a[64:67]
    v_mfma_f32_16x16x32_bf16 a[84:87], v[72:75], v[60:63], a[84:87]
    buffer_load_dwordx4 v[8:11], v252, s[4:7], s45 offen offset:2048
    v_mfma_f32_16x16x32_bf16 a[104:107], v[72:75], v[64:67], a[104:107]
    v_mfma_f32_16x16x32_bf16 a[8:11], v[76:79], v[44:47], a[8:11]
    v_mfma_f32_16x16x32_bf16 a[28:31], v[76:79], v[48:51], a[28:31]
    buffer_load_dwordx4 v[32:35], v252, s[8:11], s45 offen offset:2048
    v_mfma_f32_16x16x32_bf16 a[48:51], v[76:79], v[52:55], a[48:51]
    v_mfma_f32_16x16x32_bf16 a[68:71], v[76:79], v[56:59], a[68:71]
    v_mfma_f32_16x16x32_bf16 a[88:91], v[76:79], v[60:63], a[88:91]
    buffer_load_dwordx4 v[12:15], v252, s[4:7], s46 offen offset:2048
    v_mfma_f32_16x16x32_bf16 a[108:111], v[76:79], v[64:67], a[108:111]
    v_mfma_f32_16x16x32_bf16 a[12:15], v[80:83], v[44:47], a[12:15]
    v_mfma_f32_16x16x32_bf16 a[32:35], v[80:83], v[48:51], a[32:35]
    buffer_load_dwordx4 v[36:39], v252, s[8:11], s46 offen offset:2048
    v_mfma_f32_16x16x32_bf16 a[52:55], v[80:83], v[52:55], a[52:55]
    v_mfma_f32_16x16x32_bf16 a[72:75], v[80:83], v[56:59], a[72:75]
    buffer_load_dwordx4 v[16:19], v252, s[4:7], s47 offen offset:2048
    v_mfma_f32_16x16x32_bf16 a[92:95], v[80:83], v[60:63], a[92:95]
    v_mfma_f32_16x16x32_bf16 a[112:115], v[80:83], v[64:67], a[112:115]
    v_mfma_f32_16x16x32_bf16 a[16:19], v[84:87], v[44:47], a[16:19]
    buffer_load_dwordx4 v[40:43], v252, s[8:11], s47 offen offset:2048
    v_mfma_f32_16x16x32_bf16 a[36:39], v[84:87], v[48:51], a[36:39]
    v_mfma_f32_16x16x32_bf16 a[56:59], v[84:87], v[52:55], a[56:59]
    v_mfma_f32_16x16x32_bf16 a[76:79], v[84:87], v[56:59], a[76:79]
    buffer_load_dwordx4 v[20:23], v252, s[4:7], s48 offen offset:2048
    v_mfma_f32_16x16x32_bf16 a[96:99], v[84:87], v[60:63], a[96:99]
    v_mfma_f32_16x16x32_bf16 a[116:119], v[84:87], v[64:67], a[116:119]
    s_waitcnt vmcnt(11)
    v_mfma_f32_16x16x32_bf16 a[0:3], v[112:115], v[88:91], a[0:3]
    buffer_load_dwordx4 v[44:47], v252, s[4:7], 0 offen offset:3072
    v_mfma_f32_16x16x32_bf16 a[20:23], v[112:115], v[92:95], a[20:23]
    v_mfma_f32_16x16x32_bf16 a[40:43], v[112:115], v[96:99], a[40:43]
    buffer_load_dwordx4 v[68:71], v252, s[8:11], 0 offen offset:3072
    v_mfma_f32_16x16x32_bf16 a[60:63], v[112:115], v[100:103], a[60:63]
    v_mfma_f32_16x16x32_bf16 a[80:83], v[112:115], v[104:107], a[80:83]
    v_mfma_f32_16x16x32_bf16 a[100:103], v[112:115], v[108:111], a[100:103]
    buffer_load_dwordx4 v[48:51], v252, s[4:7], s44 offen offset:3072
    v_mfma_f32_16x16x32_bf16 a[4:7], v[116:119], v[88:91], a[4:7]
    v_mfma_f32_16x16x32_bf16 a[24:27], v[116:119], v[92:95], a[24:27]
    v_mfma_f32_16x16x32_bf16 a[44:47], v[116:119], v[96:99], a[44:47]
    buffer_load_dwordx4 v[72:75], v252, s[8:11], s44 offen offset:3072
    v_mfma_f32_16x16x32_bf16 a[64:67], v[116:119], v[100:103], a[64:67]
    v_mfma_f32_16x16x32_bf16 a[84:87], v[116:119], v[104:107], a[84:87]
    buffer_load_dwordx4 v[52:55], v252, s[4:7], s45 offen offset:3072
    v_mfma_f32_16x16x32_bf16 a[104:107], v[116:119], v[108:111], a[104:107]
    v_mfma_f32_16x16x32_bf16 a[8:11], v[120:123], v[88:91], a[8:11]
    v_mfma_f32_16x16x32_bf16 a[28:31], v[120:123], v[92:95], a[28:31]
    buffer_load_dwordx4 v[76:79], v252, s[8:11], s45 offen offset:3072
    v_mfma_f32_16x16x32_bf16 a[48:51], v[120:123], v[96:99], a[48:51]
    v_mfma_f32_16x16x32_bf16 a[68:71], v[120:123], v[100:103], a[68:71]
    v_mfma_f32_16x16x32_bf16 a[88:91], v[120:123], v[104:107], a[88:91]
    buffer_load_dwordx4 v[56:59], v252, s[4:7], s46 offen offset:3072
    v_mfma_f32_16x16x32_bf16 a[108:111], v[120:123], v[108:111], a[108:111]
    v_mfma_f32_16x16x32_bf16 a[12:15], v[124:127], v[88:91], a[12:15]
    v_mfma_f32_16x16x32_bf16 a[32:35], v[124:127], v[92:95], a[32:35]
    buffer_load_dwordx4 v[80:83], v252, s[8:11], s46 offen offset:3072
    v_mfma_f32_16x16x32_bf16 a[52:55], v[124:127], v[96:99], a[52:55]
    v_mfma_f32_16x16x32_bf16 a[72:75], v[124:127], v[100:103], a[72:75]
    buffer_load_dwordx4 v[60:63], v252, s[4:7], s47 offen offset:3072
    v_mfma_f32_16x16x32_bf16 a[92:95], v[124:127], v[104:107], a[92:95]
    v_mfma_f32_16x16x32_bf16 a[112:115], v[124:127], v[108:111], a[112:115]
    v_mfma_f32_16x16x32_bf16 a[16:19], v[128:131], v[88:91], a[16:19]
    buffer_load_dwordx4 v[84:87], v252, s[8:11], s47 offen offset:3072
    v_mfma_f32_16x16x32_bf16 a[36:39], v[128:131], v[92:95], a[36:39]
    v_mfma_f32_16x16x32_bf16 a[56:59], v[128:131], v[96:99], a[56:59]
    v_mfma_f32_16x16x32_bf16 a[76:79], v[128:131], v[100:103], a[76:79]
    buffer_load_dwordx4 v[64:67], v252, s[4:7], s48 offen offset:3072
    v_mfma_f32_16x16x32_bf16 a[96:99], v[128:131], v[104:107], a[96:99]
    v_mfma_f32_16x16x32_bf16 a[116:119], v[128:131], v[108:111], a[116:119]
    s_waitcnt vmcnt(11)
    v_mfma_f32_16x16x32_bf16 a[0:3], v[24:27], v[0:3], a[0:3]
    v_mfma_f32_16x16x32_bf16 a[20:23], v[24:27], v[4:7], a[20:23]
    v_mfma_f32_16x16x32_bf16 a[40:43], v[24:27], v[8:11], a[40:43]
    v_mfma_f32_16x16x32_bf16 a[60:63], v[24:27], v[12:15], a[60:63]
    v_mfma_f32_16x16x32_bf16 a[80:83], v[24:27], v[16:19], a[80:83]
    v_mfma_f32_16x16x32_bf16 a[100:103], v[24:27], v[20:23], a[100:103]
    v_mfma_f32_16x16x32_bf16 a[4:7], v[28:31], v[0:3], a[4:7]
    v_mfma_f32_16x16x32_bf16 a[24:27], v[28:31], v[4:7], a[24:27]
    v_mfma_f32_16x16x32_bf16 a[44:47], v[28:31], v[8:11], a[44:47]
    v_mfma_f32_16x16x32_bf16 a[64:67], v[28:31], v[12:15], a[64:67]
    v_mfma_f32_16x16x32_bf16 a[84:87], v[28:31], v[16:19], a[84:87]
    v_mfma_f32_16x16x32_bf16 a[104:107], v[28:31], v[20:23], a[104:107]
    v_mfma_f32_16x16x32_bf16 a[8:11], v[32:35], v[0:3], a[8:11]
    v_mfma_f32_16x16x32_bf16 a[28:31], v[32:35], v[4:7], a[28:31]
    v_mfma_f32_16x16x32_bf16 a[48:51], v[32:35], v[8:11], a[48:51]
    v_mfma_f32_16x16x32_bf16 a[68:71], v[32:35], v[12:15], a[68:71]
    v_mfma_f32_16x16x32_bf16 a[88:91], v[32:35], v[16:19], a[88:91]
    v_mfma_f32_16x16x32_bf16 a[108:111], v[32:35], v[20:23], a[108:111]
    v_mfma_f32_16x16x32_bf16 a[12:15], v[36:39], v[0:3], a[12:15]
    v_mfma_f32_16x16x32_bf16 a[32:35], v[36:39], v[4:7], a[32:35]
    v_mfma_f32_16x16x32_bf16 a[52:55], v[36:39], v[8:11], a[52:55]
    v_mfma_f32_16x16x32_bf16 a[72:75], v[36:39], v[12:15], a[72:75]
    v_mfma_f32_16x16x32_bf16 a[92:95], v[36:39], v[16:19], a[92:95]
    v_mfma_f32_16x16x32_bf16 a[112:115], v[36:39], v[20:23], a[112:115]
    v_mfma_f32_16x16x32_bf16 a[16:19], v[40:43], v[0:3], a[16:19]
    v_mfma_f32_16x16x32_bf16 a[36:39], v[40:43], v[4:7], a[36:39]
    v_mfma_f32_16x16x32_bf16 a[56:59], v[40:43], v[8:11], a[56:59]
    v_mfma_f32_16x16x32_bf16 a[76:79], v[40:43], v[12:15], a[76:79]
    v_mfma_f32_16x16x32_bf16 a[96:99], v[40:43], v[16:19], a[96:99]
    v_mfma_f32_16x16x32_bf16 a[116:119], v[40:43], v[20:23], a[116:119]
    s_waitcnt vmcnt(0)
    v_mfma_f32_16x16x32_bf16 a[0:3], v[68:71], v[44:47], a[0:3]
    v_mfma_f32_16x16x32_bf16 a[20:23], v[68:71], v[48:51], a[20:23]
    v_mfma_f32_16x16x32_bf16 a[40:43], v[68:71], v[52:55], a[40:43]
    v_mfma_f32_16x16x32_bf16 a[60:63], v[68:71], v[56:59], a[60:63]
    v_mfma_f32_16x16x32_bf16 a[80:83], v[68:71], v[60:63], a[80:83]
    v_mfma_f32_16x16x32_bf16 a[100:103], v[68:71], v[64:67], a[100:103]
    v_mfma_f32_16x16x32_bf16 a[4:7], v[72:75], v[44:47], a[4:7]
    v_mfma_f32_16x16x32_bf16 a[24:27], v[72:75], v[48:51], a[24:27]
    v_mfma_f32_16x16x32_bf16 a[44:47], v[72:75], v[52:55], a[44:47]
    v_mfma_f32_16x16x32_bf16 a[64:67], v[72:75], v[56:59], a[64:67]
    v_mfma_f32_16x16x32_bf16 a[84:87], v[72:75], v[60:63], a[84:87]
    v_mfma_f32_16x16x32_bf16 a[104:107], v[72:75], v[64:67], a[104:107]
    v_mfma_f32_16x16x32_bf16 a[8:11], v[76:79], v[44:47], a[8:11]
    v_mfma_f32_16x16x32_bf16 a[28:31], v[76:79], v[48:51], a[28:31]
    v_mfma_f32_16x16x32_bf16 a[48:51], v[76:79], v[52:55], a[48:51]
    v_mfma_f32_16x16x32_bf16 a[68:71], v[76:79], v[56:59], a[68:71]
    v_mfma_f32_16x16x32_bf16 a[88:91], v[76:79], v[60:63], a[88:91]
    v_mfma_f32_16x16x32_bf16 a[108:111], v[76:79], v[64:67], a[108:111]
    v_mfma_f32_16x16x32_bf16 a[12:15], v[80:83], v[44:47], a[12:15]
    v_mfma_f32_16x16x32_bf16 a[32:35], v[80:83], v[48:51], a[32:35]
    v_mfma_f32_16x16x32_bf16 a[52:55], v[80:83], v[52:55], a[52:55]
    v_mfma_f32_16x16x32_bf16 a[72:75], v[80:83], v[56:59], a[72:75]
    v_mfma_f32_16x16x32_bf16 a[92:95], v[80:83], v[60:63], a[92:95]
    v_mfma_f32_16x16x32_bf16 a[112:115], v[80:83], v[64:67], a[112:115]
    v_mfma_f32_16x16x32_bf16 a[16:19], v[84:87], v[44:47], a[16:19]
    v_mfma_f32_16x16x32_bf16 a[36:39], v[84:87], v[48:51], a[36:39]
    v_mfma_f32_16x16x32_bf16 a[56:59], v[84:87], v[52:55], a[56:59]
    v_mfma_f32_16x16x32_bf16 a[76:79], v[84:87], v[56:59], a[76:79]
    v_mfma_f32_16x16x32_bf16 a[96:99], v[84:87], v[60:63], a[96:99]
    v_mfma_f32_16x16x32_bf16 a[116:119], v[84:87], v[64:67], a[116:119]
    v_add_u32 v4, s25, v254
    s_lshl_b32 s54, s24, 10
    v_add_u32 v5, s54, v254
    ds_write_b128 v4, a[0:3] offset:0
    ds_write_b128 v4, a[4:7] offset:1024
    ds_write_b128 v4, a[8:11] offset:2048
    ds_write_b128 v4, a[12:15] offset:3072
    ds_write_b128 v4, a[16:19] offset:4096
    ds_write_b128 v4, a[20:23] offset:5120
    ds_write_b128 v4, a[24:27] offset:6144
    ds_write_b128 v4, a[28:31] offset:7168
    ds_write_b128 v4, a[32:35] offset:8192
    ds_write_b128 v4, a[36:39] offset:9216
    ds_write_b128 v4, a[40:43] offset:10240
    ds_write_b128 v4, a[44:47] offset:11264
    ds_write_b128 v4, a[48:51] offset:12288
    ds_write_b128 v4, a[52:55] offset:13312
    ds_write_b128 v4, a[56:59] offset:14336
    ds_write_b128 v4, a[60:63] offset:15360
    ds_write_b128 v4, a[64:67] offset:16384
    ds_write_b128 v4, a[68:71] offset:17408
    ds_write_b128 v4, a[72:75] offset:18432
    ds_write_b128 v4, a[76:79] offset:19456
    ds_write_b128 v4, a[80:83] offset:20480
    ds_write_b128 v4, a[84:87] offset:21504
    ds_write_b128 v4, a[88:91] offset:22528
    ds_write_b128 v4, a[92:95] offset:23552
    ds_write_b128 v4, a[96:99] offset:24576
    ds_write_b128 v4, a[100:103] offset:25600
    ds_write_b128 v4, a[104:107] offset:26624
    ds_write_b128 v4, a[108:111] offset:27648
    ds_write_b128 v4, a[112:115] offset:28672
    ds_write_b128 v4, a[116:119] offset:29696
    s_waitcnt lgkmcnt(0)
    s_barrier
    v_add_u32 v6, 61440, v5
    ds_read_b128 v[16:19], v5 offset:0
    ds_read_b128 v[20:23], v5 offset:30720
    ds_read_b128 v[24:27], v6 offset:0
    ds_read_b128 v[28:31], v6 offset:30720
    ds_read_b128 v[32:35], v5 offset:4096
    ds_read_b128 v[36:39], v5 offset:34816
    ds_read_b128 v[40:43], v6 offset:4096
    ds_read_b128 v[44:47], v6 offset:34816
    ds_read_b128 v[48:51], v5 offset:8192
    ds_read_b128 v[52:55], v5 offset:38912
    ds_read_b128 v[56:59], v6 offset:8192
    ds_read_b128 v[60:63], v6 offset:38912
    ds_read_b128 v[64:67], v5 offset:12288
    ds_read_b128 v[68:71], v5 offset:43008
    ds_read_b128 v[72:75], v6 offset:12288
    ds_read_b128 v[76:79], v6 offset:43008
    ds_read_b128 v[80:83], v5 offset:16384
    ds_read_b128 v[84:87], v5 offset:47104
    ds_read_b128 v[88:91], v6 offset:16384
    ds_read_b128 v[92:95], v6 offset:47104
    ds_read_b128 v[96:99], v5 offset:20480
    ds_read_b128 v[100:103], v5 offset:51200
    ds_read_b128 v[104:107], v6 offset:20480
    ds_read_b128 v[108:111], v6 offset:51200
    ds_read_b128 v[112:115], v5 offset:24576
    ds_read_b128 v[116:119], v5 offset:55296
    ds_read_b128 v[120:123], v6 offset:24576
    ds_read_b128 v[124:127], v6 offset:55296
    s_waitcnt lgkmcnt(15)
    v_add_f32 v16, v16, v20
    v_add_f32 v24, v24, v28
    v_add_f32 v17, v17, v21
    v_add_f32 v25, v25, v29
    v_add_f32 v18, v18, v22
    v_add_f32 v26, v26, v30
    v_add_f32 v19, v19, v23
    v_add_f32 v27, v27, v31
    v_add_f32 v16, v16, v24
    v_add_f32 v17, v17, v25
    v_add_f32 v18, v18, v26
    v_add_f32 v19, v19, v27
    v_cvt_pk_bf16_f32 v16, v16, v17
    v_cvt_pk_bf16_f32 v17, v18, v19
    s_add_u32 s54, s24, 0
    s_mul_i32 s55, s54, 52
    s_lshr_b32 s55, s55, 8
    s_mul_i32 s56, s55, 5
    s_sub_u32 s54, s54, s56
    s_lshl_b32 s54, s54, 5
    s_mul_i32 s55, s55, 40960
    s_add_u32 s54, s54, s55
    buffer_store_dwordx2 v[16:17], v253, s[12:15], s54 offen
    v_add_f32 v32, v32, v36
    v_add_f32 v40, v40, v44
    v_add_f32 v33, v33, v37
    v_add_f32 v41, v41, v45
    v_add_f32 v34, v34, v38
    v_add_f32 v42, v42, v46
    v_add_f32 v35, v35, v39
    v_add_f32 v43, v43, v47
    v_add_f32 v32, v32, v40
    v_add_f32 v33, v33, v41
    v_add_f32 v34, v34, v42
    v_add_f32 v35, v35, v43
    v_cvt_pk_bf16_f32 v32, v32, v33
    v_cvt_pk_bf16_f32 v33, v34, v35
    s_add_u32 s54, s24, 4
    s_mul_i32 s55, s54, 52
    s_lshr_b32 s55, s55, 8
    s_mul_i32 s56, s55, 5
    s_sub_u32 s54, s54, s56
    s_lshl_b32 s54, s54, 5
    s_mul_i32 s55, s55, 40960
    s_add_u32 s54, s54, s55
    buffer_store_dwordx2 v[32:33], v253, s[12:15], s54 offen
    v_add_f32 v48, v48, v52
    v_add_f32 v56, v56, v60
    v_add_f32 v49, v49, v53
    v_add_f32 v57, v57, v61
    v_add_f32 v50, v50, v54
    v_add_f32 v58, v58, v62
    v_add_f32 v51, v51, v55
    v_add_f32 v59, v59, v63
    v_add_f32 v48, v48, v56
    v_add_f32 v49, v49, v57
    v_add_f32 v50, v50, v58
    v_add_f32 v51, v51, v59
    v_cvt_pk_bf16_f32 v48, v48, v49
    v_cvt_pk_bf16_f32 v49, v50, v51
    s_add_u32 s54, s24, 8
    s_mul_i32 s55, s54, 52
    s_lshr_b32 s55, s55, 8
    s_mul_i32 s56, s55, 5
    s_sub_u32 s54, s54, s56
    s_lshl_b32 s54, s54, 5
    s_mul_i32 s55, s55, 40960
    s_add_u32 s54, s54, s55
    buffer_store_dwordx2 v[48:49], v253, s[12:15], s54 offen
    s_waitcnt lgkmcnt(12)
    v_add_f32 v64, v64, v68
    v_add_f32 v72, v72, v76
    v_add_f32 v65, v65, v69
    v_add_f32 v73, v73, v77
    v_add_f32 v66, v66, v70
    v_add_f32 v74, v74, v78
    v_add_f32 v67, v67, v71
    v_add_f32 v75, v75, v79
    v_add_f32 v64, v64, v72
    v_add_f32 v65, v65, v73
    v_add_f32 v66, v66, v74
    v_add_f32 v67, v67, v75
    v_cvt_pk_bf16_f32 v64, v64, v65
    v_cvt_pk_bf16_f32 v65, v66, v67
    s_add_u32 s54, s24, 12
    s_mul_i32 s55, s54, 52
    s_lshr_b32 s55, s55, 8
    s_mul_i32 s56, s55, 5
    s_sub_u32 s54, s54, s56
    s_lshl_b32 s54, s54, 5
    s_mul_i32 s55, s55, 40960
    s_add_u32 s54, s54, s55
    buffer_store_dwordx2 v[64:65], v253, s[12:15], s54 offen
    s_waitcnt lgkmcnt(8)
    v_add_f32 v80, v80, v84
    v_add_f32 v88, v88, v92
    v_add_f32 v81, v81, v85
    v_add_f32 v89, v89, v93
    v_add_f32 v82, v82, v86
    v_add_f32 v90, v90, v94
    v_add_f32 v83, v83, v87
    v_add_f32 v91, v91, v95
    v_add_f32 v80, v80, v88
    v_add_f32 v81, v81, v89
    v_add_f32 v82, v82, v90
    v_add_f32 v83, v83, v91
    v_cvt_pk_bf16_f32 v80, v80, v81
    v_cvt_pk_bf16_f32 v81, v82, v83
    s_add_u32 s54, s24, 16
    s_mul_i32 s55, s54, 52
    s_lshr_b32 s55, s55, 8
    s_mul_i32 s56, s55, 5
    s_sub_u32 s54, s54, s56
    s_lshl_b32 s54, s54, 5
    s_mul_i32 s55, s55, 40960
    s_add_u32 s54, s54, s55
    buffer_store_dwordx2 v[80:81], v253, s[12:15], s54 offen
    s_waitcnt lgkmcnt(4)
    v_add_f32 v96, v96, v100
    v_add_f32 v104, v104, v108
    v_add_f32 v97, v97, v101
    v_add_f32 v105, v105, v109
    v_add_f32 v98, v98, v102
    v_add_f32 v106, v106, v110
    v_add_f32 v99, v99, v103
    v_add_f32 v107, v107, v111
    v_add_f32 v96, v96, v104
    v_add_f32 v97, v97, v105
    v_add_f32 v98, v98, v106
    v_add_f32 v99, v99, v107
    v_cvt_pk_bf16_f32 v96, v96, v97
    v_cvt_pk_bf16_f32 v97, v98, v99
    s_add_u32 s54, s24, 20
    s_mul_i32 s55, s54, 52
    s_lshr_b32 s55, s55, 8
    s_mul_i32 s56, s55, 5
    s_sub_u32 s54, s54, s56
    s_lshl_b32 s54, s54, 5
    s_mul_i32 s55, s55, 40960
    s_add_u32 s54, s54, s55
    buffer_store_dwordx2 v[96:97], v253, s[12:15], s54 offen
    s_waitcnt lgkmcnt(0)
    v_add_f32 v112, v112, v116
    v_add_f32 v120, v120, v124
    v_add_f32 v113, v113, v117
    v_add_f32 v121, v121, v125
    v_add_f32 v114, v114, v118
    v_add_f32 v122, v122, v126
    v_add_f32 v115, v115, v119
    v_add_f32 v123, v123, v127
    v_add_f32 v112, v112, v120
    v_add_f32 v113, v113, v121
    v_add_f32 v114, v114, v122
    v_add_f32 v115, v115, v123
    v_cvt_pk_bf16_f32 v112, v112, v113
    v_cvt_pk_bf16_f32 v113, v114, v115
    s_add_u32 s54, s24, 24
    s_mul_i32 s55, s54, 52
    s_lshr_b32 s55, s55, 8
    s_mul_i32 s56, s55, 5
    s_sub_u32 s54, s54, s56
    s_lshl_b32 s54, s54, 5
    s_mul_i32 s55, s55, 40960
    s_add_u32 s54, s54, s55
    buffer_store_dwordx2 v[112:113], v253, s[12:15], s54 offen
    s_cmp_ge_u32 s24, 2
    s_cbranch_scc1 K2_fin
    ds_read_b128 v[128:131], v5 offset:28672
    ds_read_b128 v[132:135], v5 offset:59392
    ds_read_b128 v[136:139], v6 offset:28672
    ds_read_b128 v[140:143], v6 offset:59392
    s_waitcnt lgkmcnt(0)
    v_add_f32 v128, v128, v132
    v_add_f32 v136, v136, v140
    v_add_f32 v129, v129, v133
    v_add_f32 v137, v137, v141
    v_add_f32 v130, v130, v134
    v_add_f32 v138, v138, v142
    v_add_f32 v131, v131, v135
    v_add_f32 v139, v139, v143
    v_add_f32 v128, v128, v136
    v_add_f32 v129, v129, v137
    v_add_f32 v130, v130, v138
    v_add_f32 v131, v131, v139
    v_cvt_pk_bf16_f32 v128, v128, v129
    v_cvt_pk_bf16_f32 v129, v130, v131
    s_add_u32 s54, s24, 28
    s_mul_i32 s55, s54, 52
    s_lshr_b32 s55, s55, 8
    s_mul_i32 s56, s55, 5
    s_sub_u32 s54, s54, s56
    s_lshl_b32 s54, s54, 5
    s_mul_i32 s55, s55, 40960
    s_add_u32 s54, s54, s55
    buffer_store_dwordx2 v[128:129], v253, s[12:15], s54 offen
K2_fin:
K2_end:
    s_endpgm
.section .rodata,"a"
.p2align 6
.amdhsa_kernel concat_heads__gqa_block_cached__gqa_block_cached__near_ridge_kernel
  .amdhsa_next_free_vgpr 256
  .amdhsa_next_free_sgpr 100
  .amdhsa_accum_offset 256
  .amdhsa_group_segment_fixed_size 0
  .amdhsa_kernarg_size 104
  .amdhsa_user_sgpr_count 2
  .amdhsa_user_sgpr_kernarg_segment_ptr 1
  .amdhsa_system_sgpr_workgroup_id_x 1
.end_amdhsa_kernel
.p2align 6
.amdhsa_kernel oproj_kernel
  .amdhsa_next_free_vgpr 376
  .amdhsa_next_free_sgpr 100
  .amdhsa_accum_offset 256
  .amdhsa_group_segment_fixed_size 0
  .amdhsa_kernarg_size 104
  .amdhsa_user_sgpr_count 2
  .amdhsa_user_sgpr_kernarg_segment_ptr 1
  .amdhsa_system_sgpr_workgroup_id_x 1
.end_amdhsa_kernel
```
